```python
import torch

def _softmax(x, axis=-1):
    return torch.softmax(x, dim=axis)
def _gelu(x):
    return torch.nn.functional.gelu(x, approximate="tanh")
def _silu(x):
    return torch.nn.functional.silu(x)
def _sigmoid(x):
    return torch.sigmoid(x)
def _layernorm(x, axis=-1, eps=1e-5):
    m = x.mean(dim=axis, keepdim=True)
    v = x.var(dim=axis, keepdim=True, unbiased=False)
    return (x - m) / torch.sqrt(v + eps)
def _scatter_add(tgt, idx, src, axis=0):
    return tgt.clone().index_add_(axis, idx, src)
def _segment_sum(src, seg, n):
    out = torch.zeros((n,) + src.shape[1:], dtype=src.dtype)
    return out.index_add_(0, seg, src)
def _pad(x, pw):
    flat = tuple(v for pair in reversed(pw) for v in pair)
    return torch.nn.functional.pad(x, flat)

kernel_name = 'interleave_layers__linear_kernel_hedgehog__mha_block__prompt'

def setup_inputs():

    _w = (lambda a: (lambda t: t.to(torch.bfloat16) if t.is_floating_point() else t)(torch.as_tensor(a)))
    def _A_setup():
        B, S, D, H = 1, 2048, 448, 16
        Dh = D // H
        return {
            "x": _w((lambda *s: torch.randn(*s, dtype=torch.bfloat16) * 0.05)(B, S, D)),
            "wqkv": _w((lambda *s: torch.randn(*s, dtype=torch.bfloat16) * 0.4)(D, 3 * D)),
            "w_phi": _w((lambda *s: torch.randn(*s, dtype=torch.bfloat16) * 0.4)(H, Dh, Dh) * (Dh ** -0.5)),
            "wo": _w((lambda *s: torch.randn(*s, dtype=torch.bfloat16) * 0.05)(D, D)),
        }
    _A_in = _A_setup()

    def _B_setup():
        B, S, D, H = 1, 2048, 448, 16
        return {
            "x": _w((lambda *s: torch.randn(*s, dtype=torch.bfloat16) * 0.05)(B, S, D)),
            "wqkv": _w((lambda *s: torch.randn(*s, dtype=torch.bfloat16) * 0.1)(D, 3 * D)),
            "wo": _w((lambda *s: torch.randn(*s, dtype=torch.bfloat16) * 0.05)(D, D)),
        }
    _B_in = _B_setup()

    return {
        "A_x": _A_in["x"],
        "A_wqkv": _A_in["wqkv"],
        "A_w_phi": _A_in["w_phi"],
        "A_wo": _A_in["wo"],
        "B_x": _B_in["x"],
        "B_wqkv": _B_in["wqkv"],
        "B_wo": _B_in["wo"],
    }

def reference(A_x, A_wqkv, A_w_phi, A_wo, B_x, B_wqkv, B_wo):
    def _A_ref(x, wqkv, w_phi, wo):
        B, S, D = x.shape
        H = 16; Dh = D // H
        qkv = (lambda x, *d: x.permute(*d))((x @ wqkv).reshape(B, S, 3, H, Dh), 2, 0, 3, 1, 4)
        q, k, v = qkv[0], qkv[1], qkv[2]
        pq = torch.einsum("bhsd,hdf->bhsf", q, w_phi)
        pk = torch.einsum("bhsd,hdf->bhsf", k, w_phi)
        phi_q = torch.concatenate([_softmax(pq, axis=-1), _softmax(-pq, axis=-1)], axis=-1)
        phi_k = torch.concatenate([_softmax(pk, axis=-1), _softmax(-pk, axis=-1)], axis=-1)
        kv = torch.einsum("bhsf,bhsd->bhfd", phi_k, v)
        z  = torch.einsum("bhsf->bhf", phi_k)
        num = torch.einsum("bhqf,bhfd->bhqd", phi_q, kv)
        den = torch.einsum("bhqf,bhf->bhq", phi_q, z)[..., None] + 1e-6
        o = num / den
        return (lambda x, *d: x.permute(*d))(o, 0, 2, 1, 3).reshape(B, S, D) @ wo

    def _B_ref(x, wqkv, wo):
        B, S, D = x.shape
        H = 16
        Dh = D // H
        qkv = (lambda x, *d: x.permute(*d))((x @ wqkv).reshape(B, S, 3, H, Dh), 2, 0, 3, 1, 4)
        q, k, v = qkv[0], qkv[1], qkv[2]
        scores = torch.einsum("bhqd,bhkd->bhqk", q, k) * (Dh ** -0.5)
        p = _softmax(scores, axis=-1)
        o = torch.einsum("bhqk,bhkd->bhqd", p, v)
        return (lambda x, *d: x.permute(*d))(o, 0, 2, 1, 3).reshape(B, S, D) @ wo

    x = A_x
    x = x + _A_ref(_layernorm(x, axis=-1), A_wqkv, A_w_phi, A_wo)
    x = x + _B_ref(_layernorm(x, axis=-1), B_wqkv, B_wo)
    x = x + _A_ref(_layernorm(x, axis=-1), A_wqkv, A_w_phi, A_wo)
    x = x + _B_ref(_layernorm(x, axis=-1), B_wqkv, B_wo)
    return x
```

```asm
; @launch grid=(256,1,1) block=(256,1,1) lds=163840
.amdgcn_target "amdgcn-amd-amdhsa--gfx950"
.text
.globl interleave_layers__linear_kernel_hedgehog__mha_block__prompt_kernel
.p2align 8
.type interleave_layers__linear_kernel_hedgehog__mha_block__prompt_kernel,@function
interleave_layers__linear_kernel_hedgehog__mha_block__prompt_kernel:
    s_cmp_ge_u32 s2, 256
    s_cbranch_scc1 interleave_layers__linear_kernel_hedgehog__mha_block__prompt_kernel_end
    s_load_dwordx8 s[72:79], s[0:1], 0
    s_load_dwordx4 s[80:83], s[0:1], 40
    s_load_dwordx2 s[84:85], s[0:1], 56
    s_load_dwordx2 s[86:87], s[0:1], 72
    s_getpc_b64 s[28:29]
interleave_layers__linear_kernel_hedgehog__mha_block__prompt_kernel_pc:
    s_lshr_b32 s17, s2, 3
    v_lshrrev_b32 v2, 4, v0
    v_lshl_add_u32 v2, v2, 5, s17
    v_lshlrev_b32_e64 v2, 7, v2
    v_min_u32 v2, interleave_layers__linear_kernel_hedgehog__mha_block__prompt_kernel_last-interleave_layers__linear_kernel_hedgehog__mha_block__prompt_kernel_pc-4, v2
    global_load_dword v6, v2, s[28:29]
    v_lshrrev_b32 v2, 6, v0
    v_and_b32 v0, 63, v0
    v_readfirstlane_b32 s14, v2
    v_lshlrev_b32 v1, 4, v0
    v_and_b32 v12, 31, v0
    v_lshrrev_b32 v13, 5, v0
    v_lshrrev_b32_e64 v3, 2, v0
    v_mul_u32_u24 v14, 896, v3
    v_lshrrev_b32 v3, 4, v0
    v_xor_b32 v3, v3, v0
    v_and_b32_e64 v3, 3, v3
    v_lshl_add_u32 v14, v3, 4, v14
    s_and_b32 s12, s2, 7
    s_lshl_b32 s12, s12, 1
    s_bfe_u32 s17, s2, 0x10003
    s_or_b32 s12, s12, s17
    s_lshr_b32 s13, s2, 4
    s_lshl_b32 s50, s14, 10
    s_lshl_b32 s17, s12, 2
    s_add_u32 s18, s17, s14
    s_lshr_b32 s19, s13, 2
    s_add_u32 s19, s19, s17
    s_and_b32 s60, s13, 3
    s_lshl_b32 s60, s60, 2
    s_add_u32 s60, s60, s14
    s_mov_b32 s36, s60
    s_min_u32 s60, s60, 13
    s_mul_i32 s65, s19, 28672
    s_lshl_b32 s20, s60, 6
    s_add_u32 s65, s65, s20
    s_mov_b32 s6, 33554432
    s_mov_b32 s7, 0x00020000
    s_mov_b32 s10, 1835008
    s_mov_b32 s11, 0x00020000
    s_mov_b32 s91, 0x00020000
    s_mov_b32 s94, 1835008
    s_mov_b32 s95, 0x00020000
    s_mov_b32 s54, 0
    s_mov_b32 s55, -1
    s_mov_b32 s51, 0x400000
    s_mul_i32 s30, s18, 28672
    s_add_u32 s30, s30, 4194304
    s_lshl_b32 s59, s18, 12
    s_add_u32 s59, s59, 3407872
    s_mul_i32 s33, s18, 28672
    s_add_u32 s33, s33, 6291456
    s_lshl_b32 s44, s18, 7
    s_add_u32 s47, s44, 32768
    s_lshl_b32 s20, s13, 2
    s_add_u32 s44, s44, s20
    s_add_u32 s44, s44, 24576
    s_mul_i32 s34, s19, 28672
    s_mul_i32 s20, s14, 7168
    s_add_u32 s34, s34, s20
    s_add_u32 s34, s34, 6291456
    s_lshl_b32 s45, s19, 7
    s_add_u32 s46, s45, 32768
    s_lshl_b32 s20, s14, 4
    s_add_u32 s45, s45, s20
    s_add_u32 s45, s45, 24576
    s_mul_i32 s35, s19, 28672
    s_lshl_b32 s20, s60, 11
    s_add_u32 s35, s35, s20
    s_add_u32 s35, s35, 4194304
    s_lshl_b32 s58, s19, 12
    s_and_b32 s20, s60, 1
    s_lshl_b32 s20, s20, 3
    s_add_u32 s58, s58, s20
    s_lshr_b32 s20, s60, 1
    s_lshl_b32 s20, s20, 9
    s_add_u32 s58, s58, s20
    s_add_u32 s58, s58, 3407872
    s_lshl_b32 s20, s60, 2
    s_add_u32 s46, s46, s20
    s_mul_i32 s20, s60, 28672
    s_add_u32 s48, s20, 2490368
    s_add_u32 s49, s20, 2949120
    s_mul_i32 s17, s13, 75264
    s_mul_i32 s20, s14, 896
    s_add_u32 s17, s17, s20
    s_add_u32 s31, s17, 65536
    s_add_u32 s32, s17, 1269760
    s_lshl_b32 s21, s14, 11
    s_add_u32 s27, s21, 139264
    s_add_u32 s21, s21, 114688
    s_lshl_b32 s3, s14, 12
    s_add_u32 s3, s3, 122880
    s_lshl_b32 s15, s12, 2
    s_add_u32 s15, s15, s14
    s_add_u32 s23, s15, 22
    s_lshr_b32 s23, s23, 6
    s_mul_i32 s22, s23, 42
    s_sub_u32 s22, s15, s22
    s_mov_b32 s90, 1204224
    v_lshrrev_b32_e64 v2, 2, v0
    v_mul_u32_u24 v2, 1792, v2
    v_add_u32 v188, v2, v14
    v_mul_u32_u24 v2, 28, v13
    v_add_lshl_u32 v2, v2, v12, 4
    v_mov_b32 v3, 0x10000000
    v_cmp_gt_u32 vcc, 28, v12
    s_nop 1
    v_cndmask_b32 v15, v3, v2, vcc
    s_mov_b32 s69, s13
    s_mul_i32 s24, s22, 37
    s_lshr_b32 s24, s24, 9
    s_mul_i32 s25, s24, 14
    s_sub_u32 s25, s22, s25
    s_mul_i32 s26, s25, 86016
    s_mul_i32 s96, s13, 56
    s_add_u32 s26, s26, s96
    s_add_u32 s96, s24, 1
    s_cmp_eq_u32 s96, 3
    s_cselect_b32 s96, 0, s96
    s_mul_i32 s96, s96, 896
    s_add_u32 s26, s26, s96
    s_lshl_b32 s97, s23, 4
    s_add_u32 s97, s97, s13
    s_mul_i32 s97, s97, 3
    s_add_u32 s97, s97, s24
    s_mul_i32 s96, s97, 25088
    s_lshl_b32 s97, s97, 4
    s_add_u32 s97, s97, s25
    s_lshl_b32 s97, s97, 7
    s_add_u32 s97, s97, 3670016
    s_mul_i32 s25, s25, 1792
    s_add_u32 s96, s96, s25
    s_add_u32 s96, s96, 65536
    s_add_u32 s101, s96, 896
    s_cmp_eq_u32 s23, 0
    s_mov_b32 s100, 1065353216
    s_cmov_b32 s100, 1069066811
    s_mov_b32 s25, 1049335798
    s_cmov_b32 s25, 1069066811
    s_cmp_eq_u32 s24, 2
    s_cselect_b32 s100, s25, s100
    s_cmp_eq_u32 s24, 1
    s_cmov_b32 s100, 1065353216
    s_and_b32 s53, s24, 1
    s_or_b32 s53, s53, s23
    s_cmp_eq_u32 s53, 0
    s_cselect_b32 s10, 1568, 0
    s_mul_i32 s70, s13, 1568
    s_mov_b32 s66, s13
    s_mov_b32 s13, s69
    s_add_u32 s22, s26, 43008
    s_add_u32 s24, s65, 14336
    s_mov_b32 s25, 0
    s_cmp_eq_u32 s23, 1
    s_waitcnt lgkmcnt(0)
    s_cselect_b32 s88, s80, s74
    s_cselect_b32 s89, s81, s75
    s_add_u32 s8, s76, s70
    s_addc_u32 s9, s77, 0
    s_mov_b32 s92, s72
    s_mov_b32 s93, s73
    s_add_u32 m0, s3, 0
    s_nop 0
    buffer_load_dwordx4 v188, s[88:91], s26 offen lds
    s_add_u32 m0, s3, 1024
    s_nop 0
    buffer_load_dwordx4 v188, s[88:91], s22 offen lds
    s_mov_b32 m0, s27
    s_load_dword s56, s[86:87], 61440
    buffer_load_dwordx4 v1, s[8:11], s25 offen lds
    buffer_load_dwordx4 v1, s[8:11], s25 offen offset:1024 lds
    s_add_u32 m0, s21, 0
    s_nop 0
    buffer_load_dwordx4 v14, s[92:95], s65 offen lds
    s_add_u32 m0, s21, 1024
    s_nop 0
    buffer_load_dwordx4 v14, s[92:95], s24 offen lds
    s_mov_b32 s4, s86
    s_mov_b32 s5, s87
    s_mov_b32 s88, s80
    s_mov_b32 s89, s81
    s_mov_b32 s69, 28
    s_cmp_ge_u32 s15, 20
    s_cbranch_scc1 interleave_layers__linear_kernel_hedgehog__mha_block__prompt_kernel_u2o
    s_add_u32 s22, s15, 22
    s_mov_b32 s23, 1
    s_mul_i32 s24, s22, 37
    s_lshr_b32 s24, s24, 9
    s_mul_i32 s25, s24, 14
    s_sub_u32 s25, s22, s25
    s_mul_i32 s71, s25, 86016
    s_mul_i32 s98, s13, 56
    s_add_u32 s71, s71, s98
    s_add_u32 s98, s24, 1
    s_cmp_eq_u32 s98, 3
    s_cselect_b32 s98, 0, s98
    s_mul_i32 s98, s98, 896
    s_add_u32 s71, s71, s98
    s_lshl_b32 s99, s23, 4
    s_add_u32 s99, s99, s13
    s_mul_i32 s99, s99, 3
    s_add_u32 s99, s99, s24
    s_mul_i32 s98, s99, 25088
    s_lshl_b32 s99, s99, 4
    s_add_u32 s99, s99, s25
    s_lshl_b32 s99, s99, 7
    s_add_u32 s99, s99, 3670016
    s_mul_i32 s25, s25, 1792
    s_add_u32 s98, s98, s25
    s_add_u32 s98, s98, 65536
    s_add_u32 s64, s98, 896
    s_cmp_eq_u32 s23, 0
    s_mov_b32 s61, 1065353216
    s_cmov_b32 s61, 1069066811
    s_mov_b32 s25, 1049335798
    s_cmov_b32 s25, 1069066811
    s_cmp_eq_u32 s24, 2
    s_cselect_b32 s61, s25, s61
    s_cmp_eq_u32 s24, 1
    s_cmov_b32 s61, 1065353216
    s_add_u32 s70, s71, 43008
    v_mov_b32 v189, v188
    v_mov_b32 v190, v15
    s_branch interleave_layers__linear_kernel_hedgehog__mha_block__prompt_kernel_u2j
interleave_layers__linear_kernel_hedgehog__mha_block__prompt_kernel_u2o:
    s_sub_u32 s22, s15, 20
    s_cmp_ge_u32 s22, 14
    s_cselect_b32 s88, s82, s78
    s_cselect_b32 s89, s83, s79
    s_cselect_b32 s23, 14, 0
    s_mov_b32 s98, 2490368
    s_cmov_b32 s98, 2949120
    s_sub_u32 s22, s22, s23
    s_mov_b32 s90, 401408
    s_mul_i32 s71, s13, 28672
    s_lshl_b32 s25, s22, 6
    s_add_u32 s71, s71, s25
    s_add_u32 s70, s71, 14336
    s_mul_i32 s25, s22, 28672
    s_add_u32 s98, s98, s25
    s_lshl_b32 s25, s13, 11
    s_add_u32 s98, s98, s25
    s_mov_b32 s99, 33554432
    s_mov_b32 s61, 1065353216
    s_mov_b32 s69, 32
    s_cmp_ge_u32 s15, 48
    s_cmov_b32 s98, 33554432
    s_cmov_b32 s90, 0
    s_cmp_ge_u32 s13, 14
    s_cmov_b32 s98, 33554432
    s_add_u32 s64, s98, 1024
    v_mov_b32 v188, v14
    v_mov_b32 v190, v1
    v_mov_b32 v189, v14
interleave_layers__linear_kernel_hedgehog__mha_block__prompt_kernel_u2j:
    v_bfe_u32 v2, v0, 2, 2
    v_xor_b32 v2, v2, v13
    v_lshlrev_b32 v2, 4, v2
    v_lshl_add_u32 v184, v12, 6, v2
    v_xor_b32 v185, 32, v184
    s_lshl_b32 s17, s13, 16
    s_lshl_b32 s18, s12, 12
    s_add_u32 s37, s17, s18
    s_add_u32 s37, s37, 8388608
    s_andn2_b32 s38, s37, 4096
    s_add_u32 s38, s38, s50
    s_lshl_b32 s17, s13, 18
    s_lshl_b32 s18, s12, 14
    s_add_u32 s39, s17, s18
    s_lshl_b32 s18, s14, 12
    s_add_u32 s39, s39, s18
    s_add_u32 s39, s39, 10485760
    s_lshl_b32 s17, s13, 1
    s_lshr_b32 s18, s14, 1
    s_add_u32 s17, s17, s18
    s_lshl_b32 s17, s17, 12
    s_add_u32 s41, s17, 18874368
    s_lshl_b32 s17, s12, 1
    s_and_b32 s18, s14, 1
    s_add_u32 s17, s17, s18
    s_lshl_b32 s17, s17, 7
    s_add_u32 s40, s41, s17
    s_lshl_b32 s17, s13, 2
    s_add_u32 s17, s17, s14
    s_lshl_b32 s17, s17, 11
    s_add_u32 s43, s17, 19136512
    s_lshl_b32 s17, s12, 7
    s_add_u32 s42, s43, s17
    s_waitcnt lgkmcnt(0)
    s_mul_i32 s56, s56, 0x9E3779C1
    s_add_u32 s56, s56, 0x7F4A7C20
    v_lshlrev_b32_e64 v2, 3, v13
    v_sub_u32 v2, v12, v2
    v_mov_b32 v10, 0x3f80
    v_mov_b32 v11, 0x3f800000
    v_cmp_eq_u32 vcc, 0, v2
    v_cmp_eq_u32 s[28:29], 1, v2
    s_nop 0
    v_cndmask_b32 v168, 0, v10, vcc
    v_cndmask_b32 v168, v168, v11, s[28:29]
    v_cmp_eq_u32 vcc, 2, v2
    v_cmp_eq_u32 s[28:29], 3, v2
    s_nop 0
    v_cndmask_b32 v169, 0, v10, vcc
    v_cndmask_b32 v169, v169, v11, s[28:29]
    v_cmp_eq_u32 vcc, 4, v2
    v_cmp_eq_u32 s[28:29], 5, v2
    s_nop 0
    v_cndmask_b32 v170, 0, v10, vcc
    v_cndmask_b32 v170, v170, v11, s[28:29]
    v_cmp_eq_u32 vcc, 6, v2
    v_cmp_eq_u32 s[28:29], 7, v2
    s_nop 0
    v_cndmask_b32 v171, 0, v10, vcc
    v_cndmask_b32 v171, v171, v11, s[28:29]
    v_cmp_eq_u32 vcc, 16, v2
    v_cmp_eq_u32 s[28:29], 17, v2
    s_nop 0
    v_cndmask_b32 v172, 0, v10, vcc
    v_cndmask_b32 v172, v172, v11, s[28:29]
    v_cmp_eq_u32 vcc, 18, v2
    v_cmp_eq_u32 s[28:29], 19, v2
    s_nop 0
    v_cndmask_b32 v173, 0, v10, vcc
    v_cndmask_b32 v173, v173, v11, s[28:29]
    v_cmp_eq_u32 vcc, 20, v2
    v_cmp_eq_u32 s[28:29], 21, v2
    s_nop 0
    v_cndmask_b32 v174, 0, v10, vcc
    v_cndmask_b32 v174, v174, v11, s[28:29]
    v_cmp_eq_u32 vcc, 22, v2
    v_cmp_eq_u32 s[28:29], 23, v2
    s_nop 0
    v_cndmask_b32 v175, 0, v10, vcc
    v_cndmask_b32 v175, v175, v11, s[28:29]
    v_bfe_u32 v2, v0, 2, 2
    v_lshl_add_u32 v2, v13, 3, v2
    v_mul_u32_u24 v2, 56, v2
    v_bfe_u32 v3, v0, 4, 1
    v_lshl_add_u32 v2, v3, 5, v2
    v_and_b32_e64 v3, 3, v0
    v_lshl_add_u32 v2, v3, 3, v2
    v_add_u32 v2, s27, v2
    v_add_u32 v186, s3, v184
    v_add_u32 v187, s3, v185
    s_lshl_b32 s17, s66, 6
    s_add_u32 s17, s17, s15
    s_lshl_b32 s17, s17, 7
    s_add_u32 s27, s17, 3866624
    s_mul_i32 s24, s15, 28672
    s_add_u32 s25, s24, 14336
    s_mul_i32 s26, s14, 28672
    v_mov_b32 v9, s56
    s_waitcnt vmcnt(2)
    s_add_u32 m0, s3, 2048
    s_nop 0
    buffer_load_dwordx4 v188, s[88:91], s71 offen lds
    s_add_u32 m0, s3, 3072
    s_nop 0
    buffer_load_dwordx4 v189, s[88:91], s70 offen lds
    ds_read_b128 v[32:35], v186
    ds_read_b128 v[36:39], v187
    ds_read_b64_tr_b16 v[160:161], v2 offset:0
    ds_read_b64_tr_b16 v[162:163], v2 offset:224
    ds_read_b64_tr_b16 v[164:165], v2 offset:896
    ds_read_b64_tr_b16 v[166:167], v2 offset:1120
    s_waitcnt lgkmcnt(0)
    s_cmp_lg_u32 s53, 0
    s_cbranch_scc1 interleave_layers__linear_kernel_hedgehog__mha_block__prompt_kernel_tid
interleave_layers__linear_kernel_hedgehog__mha_block__prompt_kernel_tb:
    v_mfma_f32_32x32x16_bf16 v[64:79], v[32:35], v[160:163], 0
    v_mfma_f32_32x32x16_bf16 v[64:79], v[36:39], v[164:167], v[64:79]
    v_mov_b32 v10, s100
    v_cmp_gt_u32 vcc, 28, v12
    s_nop 1
    v_cndmask_b32 v10, 0, v10, vcc
    v_lshlrev_b32_e64 v4, 2, v12
    s_nop 5
    v_pk_mul_f32 v[64:65], v[64:65], v[10:11] op_sel_hi:[1,0]
    v_pk_mul_f32 v[66:67], v[66:67], v[10:11] op_sel_hi:[1,0]
    v_pk_mul_f32 v[68:69], v[68:69], v[10:11] op_sel_hi:[1,0]
    v_pk_mul_f32 v[70:71], v[70:71], v[10:11] op_sel_hi:[1,0]
    v_pk_mul_f32 v[72:73], v[72:73], v[10:11] op_sel_hi:[1,0]
    v_pk_mul_f32 v[74:75], v[74:75], v[10:11] op_sel_hi:[1,0]
    v_pk_mul_f32 v[76:77], v[76:77], v[10:11] op_sel_hi:[1,0]
    v_pk_mul_f32 v[78:79], v[78:79], v[10:11] op_sel_hi:[1,0]
    v_cvt_pk_bf16_f32 v128, v64, v65
    v_cvt_pk_bf16_f32 v129, v66, v67
    v_cvt_pk_bf16_f32 v130, v68, v69
    v_cvt_pk_bf16_f32 v131, v70, v71
    v_cvt_pk_bf16_f32 v132, v72, v73
    v_cvt_pk_bf16_f32 v133, v74, v75
    v_cvt_pk_bf16_f32 v134, v76, v77
    v_cvt_pk_bf16_f32 v135, v78, v79
    buffer_store_dwordx4 v[128:131], v15, s[4:7], s96 offen sc1
    buffer_store_dwordx4 v[132:135], v15, s[4:7], s101 offen sc1
    v_pk_add_f32 v[64:65], v[64:65], v[72:73]
    v_pk_add_f32 v[66:67], v[66:67], v[74:75]
    v_pk_add_f32 v[68:69], v[68:69], v[76:77]
    v_pk_add_f32 v[70:71], v[70:71], v[78:79]
    v_pk_add_f32 v[64:65], v[64:65], v[68:69]
    v_pk_add_f32 v[66:67], v[66:67], v[70:71]
    v_pk_add_f32 v[64:65], v[64:65], v[66:67]
    v_add_f32 v2, v64, v65
    v_mov_b32 v3, v2
    s_nop 1
    v_permlane32_swap_b32 v2, v3
    v_add_f32_e64 v2, v2, v3
    buffer_store_dword v2, v4, s[4:7], s97 offen sc1
    s_add_u32 m0, s26, 0
    s_nop 0
    buffer_load_dwordx4 v14, s[92:95], s24 offen offset:0 lds
    s_add_u32 m0, s26, 1024
    s_nop 0
    buffer_load_dwordx4 v14, s[92:95], s25 offen offset:0 lds
    s_add_u32 m0, s26, 1984
    s_nop 0
    buffer_load_dwordx4 v14, s[92:95], s24 offen offset:64 lds
    s_add_u32 m0, s26, 3008
    s_nop 0
    buffer_load_dwordx4 v14, s[92:95], s25 offen offset:64 lds
    s_add_u32 m0, s26, 3968
    s_nop 0
    buffer_load_dwordx4 v14, s[92:95], s24 offen offset:128 lds
    s_add_u32 m0, s26, 4992
    s_nop 0
    buffer_load_dwordx4 v14, s[92:95], s25 offen offset:128 lds
    v_add_u32 v2, s21, v184
    v_add_u32 v3, s21, v185
    s_waitcnt vmcnt(11)
    ds_read_b128 v[208:211], v2
    ds_read_b128 v[212:215], v3
    s_waitcnt lgkmcnt(0)
    v_permlane32_swap_b32 v208, v210
    v_permlane32_swap_b32 v209, v211
    v_permlane32_swap_b32 v212, v214
    v_permlane32_swap_b32 v213, v215
    v_lshlrev_b32 v16, 16, v208
    v_and_b32 v17, 0xffff0000, v208
    v_lshlrev_b32_e64 v18, 16, v209
    v_and_b32 v19, 0xffff0000, v209
    v_lshlrev_b32_e64 v20, 16, v210
    v_and_b32 v21, 0xffff0000, v210
    v_lshlrev_b32_e64 v22, 16, v211
    v_and_b32 v23, 0xffff0000, v211
    v_lshlrev_b32_e64 v24, 16, v212
    v_and_b32 v25, 0xffff0000, v212
    v_lshlrev_b32_e64 v26, 16, v213
    v_and_b32 v27, 0xffff0000, v213
    v_lshlrev_b32_e64 v28, 16, v214
    v_and_b32 v29, 0xffff0000, v214
    v_lshlrev_b32_e64 v30, 16, v215
    v_and_b32 v31, 0xffff0000, v215
    s_waitcnt vmcnt(6)
    s_mov_b64 exec, 1
    buffer_store_dword v9, off, s[4:7], s27 sc1
    s_mov_b64 exec, -1
    s_lshl_b32 s17, s13, 13
    s_add_u32 s27, s17, 3866624
    v_min_u32 v191, 41, v0
    v_lshlrev_b32 v191, 7, v191
    v_add_u32 v184, s26, v184
    v_add_u32 v185, s26, v185
    v_mov_b32 v206, 0
    v_mov_b32 v207, 0
    v_mov_b32 v204, 0
    v_mov_b32 v205, 0
    v_mov_b32 v8, 0x3f803f80
    s_add_u32 m0, s26, 5952
    s_nop 0
    buffer_load_dwordx4 v14, s[92:95], s24 offen offset:192 lds
    s_add_u32 m0, s26, 6976
    s_nop 0
    buffer_load_dwordx4 v14, s[92:95], s25 offen offset:192 lds
    s_waitcnt vmcnt(7)
    ds_read_b128 v[32:35], v184 offset:0
    ds_read_b128 v[36:39], v185 offset:0
    ds_read_b128 v[144:147], v186 offset:2048
    ds_read_b128 v[148:151], v187 offset:2048
    s_waitcnt lgkmcnt(0)
    v_mfma_f32_32x32x16_bf16 v[208:223], v[144:147], v[168:171], 0
    v_mfma_f32_32x32x16_bf16 v[208:223], v[148:151], v[172:175], v[208:223]
    v_mov_b32 v10, s61
    v_cmp_gt_u32 vcc, s69, v12
    s_nop 1
    v_cndmask_b32 v10, 0, v10, vcc
    v_lshlrev_b32 v4, 2, v12
    s_nop 5
    v_pk_mul_f32 v[208:209], v[208:209], v[10:11] op_sel_hi:[1,0]
    v_pk_mul_f32 v[210:211], v[210:211], v[10:11] op_sel_hi:[1,0]
    v_pk_mul_f32 v[212:213], v[212:213], v[10:11] op_sel_hi:[1,0]
    v_pk_mul_f32 v[214:215], v[214:215], v[10:11] op_sel_hi:[1,0]
    v_pk_mul_f32 v[216:217], v[216:217], v[10:11] op_sel_hi:[1,0]
    v_pk_mul_f32 v[218:219], v[218:219], v[10:11] op_sel_hi:[1,0]
    v_pk_mul_f32 v[220:221], v[220:221], v[10:11] op_sel_hi:[1,0]
    v_pk_mul_f32 v[222:223], v[222:223], v[10:11] op_sel_hi:[1,0]
    v_cvt_pk_bf16_f32 v224, v208, v209
    v_cvt_pk_bf16_f32 v225, v210, v211
    v_cvt_pk_bf16_f32 v226, v212, v213
    v_cvt_pk_bf16_f32 v227, v214, v215
    v_cvt_pk_bf16_f32 v228, v216, v217
    v_cvt_pk_bf16_f32 v229, v218, v219
    v_cvt_pk_bf16_f32 v230, v220, v221
    v_cvt_pk_bf16_f32 v231, v222, v223
    buffer_store_dwordx4 v[224:227], v190, s[4:7], s98 offen sc1
    buffer_store_dwordx4 v[228:231], v190, s[4:7], s64 offen sc1
    v_pk_add_f32 v[208:209], v[208:209], v[216:217]
    v_pk_add_f32 v[210:211], v[210:211], v[218:219]
    v_pk_add_f32 v[212:213], v[212:213], v[220:221]
    v_pk_add_f32 v[214:215], v[214:215], v[222:223]
    v_pk_add_f32 v[208:209], v[208:209], v[212:213]
    v_pk_add_f32 v[210:211], v[210:211], v[214:215]
    v_pk_add_f32 v[208:209], v[208:209], v[210:211]
    v_add_f32 v2, v208, v209
    v_mov_b32 v3, v2
    s_nop 1
    v_permlane32_swap_b32 v2, v3
    v_add_f32_e64 v2, v2, v3
    buffer_store_dword v2, v4, s[4:7], s99 offen sc1
    s_add_u32 m0, s26, 7936
    s_nop 0
    buffer_load_dwordx4 v14, s[92:95], s24 offen offset:256 lds
    s_add_u32 m0, s26, 8960
    s_nop 0
    buffer_load_dwordx4 v14, s[92:95], s25 offen offset:256 lds
    s_waitcnt vmcnt(10)
    ds_read_b128 v[40:43], v184 offset:2048
    ds_read_b128 v[44:47], v185 offset:2048
    v_dot2c_f32_bf16 v207, v32, v32
    v_dot2c_f32_bf16 v206, v32, v8
    v_dot2c_f32_bf16 v205, v33, v33
    v_dot2c_f32_bf16 v204, v33, v8
    v_dot2c_f32_bf16 v207, v34, v34
    v_dot2c_f32_bf16 v206, v34, v8
    v_dot2c_f32_bf16 v205, v35, v35
    v_dot2c_f32_bf16 v204, v35, v8
    v_dot2c_f32_bf16 v207, v36, v36
    v_dot2c_f32_bf16 v206, v36, v8
    v_dot2c_f32_bf16 v205, v37, v37
    v_dot2c_f32_bf16 v204, v37, v8
    v_dot2c_f32_bf16 v207, v38, v38
    v_dot2c_f32_bf16 v206, v38, v8
    v_dot2c_f32_bf16 v205, v39, v39
    v_dot2c_f32_bf16 v204, v39, v8
    v_permlane32_swap_b32 v32, v34
    v_permlane32_swap_b32 v33, v35
    v_permlane32_swap_b32 v36, v38
    v_permlane32_swap_b32 v37, v39
    s_add_u32 m0, s26, 9920
    s_nop 0
    buffer_load_dwordx4 v14, s[92:95], s24 offen offset:320 lds
    s_add_u32 m0, s26, 10944
    s_nop 0
    buffer_load_dwordx4 v14, s[92:95], s25 offen offset:320 lds
    s_waitcnt vmcnt(10)
    ds_read_b128 v[48:51], v184 offset:4096
    ds_read_b128 v[52:55], v185 offset:4096
    s_waitcnt lgkmcnt(2)
    v_dot2c_f32_bf16 v207, v40, v40
    v_dot2c_f32_bf16 v206, v40, v8
    v_dot2c_f32_bf16 v205, v41, v41
    v_dot2c_f32_bf16 v204, v41, v8
    v_dot2c_f32_bf16 v207, v42, v42
    v_dot2c_f32_bf16 v206, v42, v8
    v_dot2c_f32_bf16 v205, v43, v43
    v_dot2c_f32_bf16 v204, v43, v8
    v_dot2c_f32_bf16 v207, v44, v44
    v_dot2c_f32_bf16 v206, v44, v8
    v_dot2c_f32_bf16 v205, v45, v45
    v_dot2c_f32_bf16 v204, v45, v8
    v_dot2c_f32_bf16 v207, v46, v46
    v_dot2c_f32_bf16 v206, v46, v8
    v_dot2c_f32_bf16 v205, v47, v47
    v_dot2c_f32_bf16 v204, v47, v8
    v_permlane32_swap_b32 v40, v42
    v_permlane32_swap_b32 v41, v43
    v_permlane32_swap_b32 v44, v46
    v_permlane32_swap_b32 v45, v47
    s_add_u32 m0, s26, 11904
    s_nop 0
    buffer_load_dwordx4 v14, s[92:95], s24 offen offset:384 lds
    s_add_u32 m0, s26, 12928
    s_nop 0
    buffer_load_dwordx4 v14, s[92:95], s25 offen offset:384 lds
    s_waitcnt vmcnt(9)
    ds_read_b128 v[56:59], v184 offset:6144
    ds_read_b128 v[60:63], v185 offset:6144
    s_waitcnt lgkmcnt(2)
    v_dot2c_f32_bf16 v207, v48, v48
    v_dot2c_f32_bf16 v206, v48, v8
    v_dot2c_f32_bf16 v205, v49, v49
    v_dot2c_f32_bf16 v204, v49, v8
    v_dot2c_f32_bf16 v207, v50, v50
    v_dot2c_f32_bf16 v206, v50, v8
    v_dot2c_f32_bf16 v205, v51, v51
    v_dot2c_f32_bf16 v204, v51, v8
    v_dot2c_f32_bf16 v207, v52, v52
    v_dot2c_f32_bf16 v206, v52, v8
    v_dot2c_f32_bf16 v205, v53, v53
    v_dot2c_f32_bf16 v204, v53, v8
    v_dot2c_f32_bf16 v207, v54, v54
    v_dot2c_f32_bf16 v206, v54, v8
    v_dot2c_f32_bf16 v205, v55, v55
    v_dot2c_f32_bf16 v204, v55, v8
    v_permlane32_swap_b32 v48, v50
    v_permlane32_swap_b32 v49, v51
    v_permlane32_swap_b32 v52, v54
    v_permlane32_swap_b32 v53, v55
    s_add_u32 m0, s26, 13888
    s_nop 0
    buffer_load_dwordx4 v14, s[92:95], s24 offen offset:448 lds
    s_add_u32 m0, s26, 14912
    s_nop 0
    buffer_load_dwordx4 v14, s[92:95], s25 offen offset:448 lds
    s_waitcnt vmcnt(6)
    ds_read_b128 v[64:67], v184 offset:8192
    ds_read_b128 v[68:71], v185 offset:8192
    s_waitcnt lgkmcnt(2)
    v_dot2c_f32_bf16 v207, v56, v56
    v_dot2c_f32_bf16 v206, v56, v8
    v_dot2c_f32_bf16 v205, v57, v57
    v_dot2c_f32_bf16 v204, v57, v8
    v_dot2c_f32_bf16 v207, v58, v58
    v_dot2c_f32_bf16 v206, v58, v8
    v_dot2c_f32_bf16 v205, v59, v59
    v_dot2c_f32_bf16 v204, v59, v8
    v_dot2c_f32_bf16 v207, v60, v60
    v_dot2c_f32_bf16 v206, v60, v8
    v_dot2c_f32_bf16 v205, v61, v61
    v_dot2c_f32_bf16 v204, v61, v8
    v_dot2c_f32_bf16 v207, v62, v62
    v_dot2c_f32_bf16 v206, v62, v8
    v_dot2c_f32_bf16 v205, v63, v63
    v_dot2c_f32_bf16 v204, v63, v8
    v_permlane32_swap_b32 v56, v58
    v_permlane32_swap_b32 v57, v59
    v_permlane32_swap_b32 v60, v62
    v_permlane32_swap_b32 v61, v63
    s_add_u32 m0, s26, 15872
    s_nop 0
    buffer_load_dwordx4 v14, s[92:95], s24 offen offset:512 lds
    s_add_u32 m0, s26, 16896
    s_nop 0
    buffer_load_dwordx4 v14, s[92:95], s25 offen offset:512 lds
    s_waitcnt vmcnt(6)
    ds_read_b128 v[72:75], v184 offset:10240
    ds_read_b128 v[76:79], v185 offset:10240
    s_waitcnt lgkmcnt(2)
    v_dot2c_f32_bf16 v207, v64, v64
    v_dot2c_f32_bf16 v206, v64, v8
    v_dot2c_f32_bf16 v205, v65, v65
    v_dot2c_f32_bf16 v204, v65, v8
    v_dot2c_f32_bf16 v207, v66, v66
    v_dot2c_f32_bf16 v206, v66, v8
    v_dot2c_f32_bf16 v205, v67, v67
    v_dot2c_f32_bf16 v204, v67, v8
    v_dot2c_f32_bf16 v207, v68, v68
    v_dot2c_f32_bf16 v206, v68, v8
    v_dot2c_f32_bf16 v205, v69, v69
    v_dot2c_f32_bf16 v204, v69, v8
    v_dot2c_f32_bf16 v207, v70, v70
    v_dot2c_f32_bf16 v206, v70, v8
    v_dot2c_f32_bf16 v205, v71, v71
    v_dot2c_f32_bf16 v204, v71, v8
    v_permlane32_swap_b32 v64, v66
    v_permlane32_swap_b32 v65, v67
    v_permlane32_swap_b32 v68, v70
    v_permlane32_swap_b32 v69, v71
    s_add_u32 m0, s26, 17856
    s_nop 0
    buffer_load_dwordx4 v14, s[92:95], s24 offen offset:576 lds
    s_add_u32 m0, s26, 18880
    s_nop 0
    buffer_load_dwordx4 v14, s[92:95], s25 offen offset:576 lds
    s_waitcnt vmcnt(6)
    ds_read_b128 v[80:83], v184 offset:12288
    ds_read_b128 v[84:87], v185 offset:12288
    s_waitcnt lgkmcnt(2)
    v_dot2c_f32_bf16 v207, v72, v72
    v_dot2c_f32_bf16 v206, v72, v8
    v_dot2c_f32_bf16 v205, v73, v73
    v_dot2c_f32_bf16 v204, v73, v8
    v_dot2c_f32_bf16 v207, v74, v74
    v_dot2c_f32_bf16 v206, v74, v8
    v_dot2c_f32_bf16 v205, v75, v75
    v_dot2c_f32_bf16 v204, v75, v8
    v_dot2c_f32_bf16 v207, v76, v76
    v_dot2c_f32_bf16 v206, v76, v8
    v_dot2c_f32_bf16 v205, v77, v77
    v_dot2c_f32_bf16 v204, v77, v8
    v_dot2c_f32_bf16 v207, v78, v78
    v_dot2c_f32_bf16 v206, v78, v8
    v_dot2c_f32_bf16 v205, v79, v79
    v_dot2c_f32_bf16 v204, v79, v8
    v_permlane32_swap_b32 v72, v74
    v_permlane32_swap_b32 v73, v75
    v_permlane32_swap_b32 v76, v78
    v_permlane32_swap_b32 v77, v79
    s_add_u32 m0, s26, 19840
    s_nop 0
    buffer_load_dwordx4 v14, s[92:95], s24 offen offset:640 lds
    s_add_u32 m0, s26, 20864
    s_nop 0
    buffer_load_dwordx4 v14, s[92:95], s25 offen offset:640 lds
    s_waitcnt vmcnt(6)
    ds_read_b128 v[88:91], v184 offset:14336
    ds_read_b128 v[92:95], v185 offset:14336
    s_waitcnt lgkmcnt(2)
    v_dot2c_f32_bf16 v207, v80, v80
    v_dot2c_f32_bf16 v206, v80, v8
    v_dot2c_f32_bf16 v205, v81, v81
    v_dot2c_f32_bf16 v204, v81, v8
    v_dot2c_f32_bf16 v207, v82, v82
    v_dot2c_f32_bf16 v206, v82, v8
    v_dot2c_f32_bf16 v205, v83, v83
    v_dot2c_f32_bf16 v204, v83, v8
    v_dot2c_f32_bf16 v207, v84, v84
    v_dot2c_f32_bf16 v206, v84, v8
    v_dot2c_f32_bf16 v205, v85, v85
    v_dot2c_f32_bf16 v204, v85, v8
    v_dot2c_f32_bf16 v207, v86, v86
    v_dot2c_f32_bf16 v206, v86, v8
    v_dot2c_f32_bf16 v205, v87, v87
    v_dot2c_f32_bf16 v204, v87, v8
    v_permlane32_swap_b32 v80, v82
    v_permlane32_swap_b32 v81, v83
    v_permlane32_swap_b32 v84, v86
    v_permlane32_swap_b32 v85, v87
    s_add_u32 m0, s26, 21824
    s_nop 0
    buffer_load_dwordx4 v14, s[92:95], s24 offen offset:704 lds
    s_add_u32 m0, s26, 22848
    s_nop 0
    buffer_load_dwordx4 v14, s[92:95], s25 offen offset:704 lds
    s_waitcnt vmcnt(6)
    ds_read_b128 v[96:99], v184 offset:16384
    ds_read_b128 v[100:103], v185 offset:16384
    s_waitcnt lgkmcnt(2)
    v_dot2c_f32_bf16 v207, v88, v88
    v_dot2c_f32_bf16 v206, v88, v8
    v_dot2c_f32_bf16 v205, v89, v89
    v_dot2c_f32_bf16 v204, v89, v8
    v_dot2c_f32_bf16 v207, v90, v90
    v_dot2c_f32_bf16 v206, v90, v8
    v_dot2c_f32_bf16 v205, v91, v91
    v_dot2c_f32_bf16 v204, v91, v8
    v_dot2c_f32_bf16 v207, v92, v92
    v_dot2c_f32_bf16 v206, v92, v8
    v_dot2c_f32_bf16 v205, v93, v93
    v_dot2c_f32_bf16 v204, v93, v8
    v_dot2c_f32_bf16 v207, v94, v94
    v_dot2c_f32_bf16 v206, v94, v8
    v_dot2c_f32_bf16 v205, v95, v95
    v_dot2c_f32_bf16 v204, v95, v8
    v_permlane32_swap_b32 v88, v90
    v_permlane32_swap_b32 v89, v91
    v_permlane32_swap_b32 v92, v94
    v_permlane32_swap_b32 v93, v95
    s_add_u32 m0, s26, 23808
    s_nop 0
    buffer_load_dwordx4 v14, s[92:95], s24 offen offset:768 lds
    s_add_u32 m0, s26, 24832
    s_nop 0
    buffer_load_dwordx4 v14, s[92:95], s25 offen offset:768 lds
    s_waitcnt vmcnt(6)
    ds_read_b128 v[104:107], v184 offset:18432
    ds_read_b128 v[108:111], v185 offset:18432
    s_waitcnt lgkmcnt(2)
    v_dot2c_f32_bf16 v207, v96, v96
    v_dot2c_f32_bf16 v206, v96, v8
    v_dot2c_f32_bf16 v205, v97, v97
    v_dot2c_f32_bf16 v204, v97, v8
    v_dot2c_f32_bf16 v207, v98, v98
    v_dot2c_f32_bf16 v206, v98, v8
    v_dot2c_f32_bf16 v205, v99, v99
    v_dot2c_f32_bf16 v204, v99, v8
    v_dot2c_f32_bf16 v207, v100, v100
    v_dot2c_f32_bf16 v206, v100, v8
    v_dot2c_f32_bf16 v205, v101, v101
    v_dot2c_f32_bf16 v204, v101, v8
    v_dot2c_f32_bf16 v207, v102, v102
    v_dot2c_f32_bf16 v206, v102, v8
    v_dot2c_f32_bf16 v205, v103, v103
    v_dot2c_f32_bf16 v204, v103, v8
    v_permlane32_swap_b32 v96, v98
    v_permlane32_swap_b32 v97, v99
    v_permlane32_swap_b32 v100, v102
    v_permlane32_swap_b32 v101, v103
    s_add_u32 m0, s26, 25792
    s_nop 0
    buffer_load_dwordx4 v14, s[92:95], s24 offen offset:832 lds
    s_add_u32 m0, s26, 26816
    s_nop 0
    buffer_load_dwordx4 v14, s[92:95], s25 offen offset:832 lds
    s_waitcnt vmcnt(6)
    ds_read_b128 v[112:115], v184 offset:20480
    ds_read_b128 v[116:119], v185 offset:20480
    s_waitcnt lgkmcnt(2)
    v_dot2c_f32_bf16 v207, v104, v104
    v_dot2c_f32_bf16 v206, v104, v8
    v_dot2c_f32_bf16 v205, v105, v105
    v_dot2c_f32_bf16 v204, v105, v8
    v_dot2c_f32_bf16 v207, v106, v106
    v_dot2c_f32_bf16 v206, v106, v8
    v_dot2c_f32_bf16 v205, v107, v107
    v_dot2c_f32_bf16 v204, v107, v8
    v_dot2c_f32_bf16 v207, v108, v108
    v_dot2c_f32_bf16 v206, v108, v8
    v_dot2c_f32_bf16 v205, v109, v109
    v_dot2c_f32_bf16 v204, v109, v8
    v_dot2c_f32_bf16 v207, v110, v110
    v_dot2c_f32_bf16 v206, v110, v8
    v_dot2c_f32_bf16 v205, v111, v111
    v_dot2c_f32_bf16 v204, v111, v8
    v_permlane32_swap_b32 v104, v106
    v_permlane32_swap_b32 v105, v107
    v_permlane32_swap_b32 v108, v110
    v_permlane32_swap_b32 v109, v111
    s_waitcnt vmcnt(4)
    ds_read_b128 v[120:123], v184 offset:22528
    ds_read_b128 v[124:127], v185 offset:22528
    s_waitcnt lgkmcnt(2)
    v_dot2c_f32_bf16 v207, v112, v112
    v_dot2c_f32_bf16 v206, v112, v8
    v_dot2c_f32_bf16 v205, v113, v113
    v_dot2c_f32_bf16 v204, v113, v8
    v_dot2c_f32_bf16 v207, v114, v114
    v_dot2c_f32_bf16 v206, v114, v8
    v_dot2c_f32_bf16 v205, v115, v115
    v_dot2c_f32_bf16 v204, v115, v8
    v_dot2c_f32_bf16 v207, v116, v116
    v_dot2c_f32_bf16 v206, v116, v8
    v_dot2c_f32_bf16 v205, v117, v117
    v_dot2c_f32_bf16 v204, v117, v8
    v_dot2c_f32_bf16 v207, v118, v118
    v_dot2c_f32_bf16 v206, v118, v8
    v_dot2c_f32_bf16 v205, v119, v119
    v_dot2c_f32_bf16 v204, v119, v8
    v_permlane32_swap_b32 v112, v114
    v_permlane32_swap_b32 v113, v115
    v_permlane32_swap_b32 v116, v118
    v_permlane32_swap_b32 v117, v119
    s_waitcnt vmcnt(2)
    ds_read_b128 v[128:131], v184 offset:24576
    ds_read_b128 v[132:135], v185 offset:24576
    s_waitcnt lgkmcnt(2)
    v_dot2c_f32_bf16 v207, v120, v120
    v_dot2c_f32_bf16 v206, v120, v8
    v_dot2c_f32_bf16 v205, v121, v121
    v_dot2c_f32_bf16 v204, v121, v8
    v_dot2c_f32_bf16 v207, v122, v122
    v_dot2c_f32_bf16 v206, v122, v8
    v_dot2c_f32_bf16 v205, v123, v123
    v_dot2c_f32_bf16 v204, v123, v8
    v_dot2c_f32_bf16 v207, v124, v124
    v_dot2c_f32_bf16 v206, v124, v8
    v_dot2c_f32_bf16 v205, v125, v125
    v_dot2c_f32_bf16 v204, v125, v8
    v_dot2c_f32_bf16 v207, v126, v126
    v_dot2c_f32_bf16 v206, v126, v8
    v_dot2c_f32_bf16 v205, v127, v127
    v_dot2c_f32_bf16 v204, v127, v8
    v_permlane32_swap_b32 v120, v122
    v_permlane32_swap_b32 v121, v123
    v_permlane32_swap_b32 v124, v126
    v_permlane32_swap_b32 v125, v127
    s_waitcnt vmcnt(0)
    ds_read_b128 v[136:139], v184 offset:26624
    ds_read_b128 v[140:143], v185 offset:26624
    buffer_load_dword v5, v191, s[4:7], s27 offen sc1
    s_waitcnt lgkmcnt(2)
    v_dot2c_f32_bf16 v207, v128, v128
    v_dot2c_f32_bf16 v206, v128, v8
    v_dot2c_f32_bf16 v205, v129, v129
    v_dot2c_f32_bf16 v204, v129, v8
    v_dot2c_f32_bf16 v207, v130, v130
    v_dot2c_f32_bf16 v206, v130, v8
    v_dot2c_f32_bf16 v205, v131, v131
    v_dot2c_f32_bf16 v204, v131, v8
    v_dot2c_f32_bf16 v207, v132, v132
    v_dot2c_f32_bf16 v206, v132, v8
    v_dot2c_f32_bf16 v205, v133, v133
    v_dot2c_f32_bf16 v204, v133, v8
    v_dot2c_f32_bf16 v207, v134, v134
    v_dot2c_f32_bf16 v206, v134, v8
    v_dot2c_f32_bf16 v205, v135, v135
    v_dot2c_f32_bf16 v204, v135, v8
    v_permlane32_swap_b32 v128, v130
    v_permlane32_swap_b32 v129, v131
    v_permlane32_swap_b32 v132, v134
    v_permlane32_swap_b32 v133, v135
    s_getreg_b32 s52, hwreg(HW_REG_XCC_ID, 0, 4)
    s_add_u32 s52, s52, s56
    s_add_u32 s52, s52, 1
    s_lshl_b32 s17, s13, 4
    s_add_u32 s17, s17, s12
    s_lshl_b32 s17, s17, 7
    s_add_u32 s22, s17, 3997696
    s_waitcnt lgkmcnt(0)
    v_dot2c_f32_bf16 v207, v136, v136
    v_dot2c_f32_bf16 v206, v136, v8
    v_dot2c_f32_bf16 v205, v137, v137
    v_dot2c_f32_bf16 v204, v137, v8
    v_dot2c_f32_bf16 v207, v138, v138
    v_dot2c_f32_bf16 v206, v138, v8
    v_dot2c_f32_bf16 v205, v139, v139
    v_dot2c_f32_bf16 v204, v139, v8
    v_dot2c_f32_bf16 v207, v140, v140
    v_dot2c_f32_bf16 v206, v140, v8
    v_dot2c_f32_bf16 v205, v141, v141
    v_dot2c_f32_bf16 v204, v141, v8
    v_dot2c_f32_bf16 v207, v142, v142
    v_dot2c_f32_bf16 v206, v142, v8
    v_dot2c_f32_bf16 v205, v143, v143
    v_dot2c_f32_bf16 v204, v143, v8
    v_permlane32_swap_b32 v136, v138
    v_permlane32_swap_b32 v137, v139
    v_permlane32_swap_b32 v140, v142
    v_permlane32_swap_b32 v141, v143
    s_barrier
    s_waitcnt vmcnt(0)
    v_cmp_ne_u32 vcc, s56, v5
    s_cbranch_vccnz L_g1wait_1
L_g1ok_2:
    s_add_u32 m0, s50, 0
    s_add_u32 s67, s31, 0
    buffer_load_dwordx4 v15, s[4:7], s67 offen sc1 lds
    s_add_u32 m0, s50, 28672
    s_add_u32 s67, s31, 25088
    buffer_load_dwordx4 v15, s[4:7], s67 offen sc1 lds
    s_add_u32 m0, s50, 4096
    s_add_u32 s67, s31, 3584
    buffer_load_dwordx4 v15, s[4:7], s67 offen sc1 lds
    s_add_u32 m0, s50, 32768
    s_add_u32 s67, s31, 28672
    buffer_load_dwordx4 v15, s[4:7], s67 offen sc1 lds
    s_add_u32 s17, s13, 0
    s_mul_i32 s17, s17, 3
    s_min_u32 s18, s14, 2
    s_add_u32 s17, s17, s18
    s_lshl_b32 s17, s17, 11
    s_add_u32 s17, s17, 3670016
    v_lshrrev_b32 v2, 5, v0
    v_mul_u32_u24 v2, 896, v2
    v_and_b32_e64 v3, 31, v0
    v_lshl_add_u32 v2, v3, 2, v2
    buffer_load_dword v240, v2, s[4:7], s17 offen offset:0 sc1
    buffer_load_dword v241, v2, s[4:7], s17 offen offset:128 sc1
    buffer_load_dword v242, v2, s[4:7], s17 offen offset:256 sc1
    buffer_load_dword v243, v2, s[4:7], s17 offen offset:384 sc1
    buffer_load_dword v244, v2, s[4:7], s17 offen offset:512 sc1
    buffer_load_dword v245, v2, s[4:7], s17 offen offset:640 sc1
    buffer_load_dword v246, v2, s[4:7], s17 offen offset:768 sc1
    s_add_u32 m0, s50, 8192
    s_add_u32 s67, s31, 7168
    buffer_load_dwordx4 v15, s[4:7], s67 offen sc1 lds
    s_add_u32 m0, s50, 36864
    s_add_u32 s67, s31, 32256
    buffer_load_dwordx4 v15, s[4:7], s67 offen sc1 lds
    s_cmp_lg_u32 s14, 3
    s_cbranch_scc1 L_g2skip_3
    v_mov_b32 v10, s56
    v_mov_b32_e64 v11, s52
    s_mov_b64 exec, 1
    buffer_store_dwordx2 v[10:11], off, s[4:7], s22 sc1
    s_mov_b64 exec, -1
L_g2skip_3:
    v_pk_add_f32 v[204:205], v[204:205], v[206:207]
    v_mov_b32 v206, v204
    v_mov_b32 v207, v205
    s_nop 0
    v_permlane32_swap_b32 v204, v206
    v_permlane32_swap_b32 v205, v207
    v_pk_add_f32 v[206:207], v[206:207], v[204:205]
    v_and_b32 v2, 31, v0
    v_lshrrev_b32 v3, 5, v0
    s_lshl_b32 s17, s14, 5
    v_add_u32 v4, s17, v2
    v_and_b32_e64 v5, 9, v0
    v_bfe_u32 v12, v0, 1, 1
    v_lshl_or_b32 v5, v12, 2, v5
    v_bfe_u32 v12, v0, 2, 1
    v_lshl_or_b32 v5, v12, 1, v5
    v_xor_b32 v5, v5, v3
    v_lshlrev_b32 v5, 3, v5
    v_lshl_add_u32 v5, v4, 7, v5
    v_add_u32 v248, 86016, v5
    v_bfe_u32 v5, v0, 1, 3
    v_xor_b32 v5, v5, v3
    v_lshlrev_b32 v5, 3, v5
    v_lshl_add_u32 v5, v4, 6, v5
    v_add_u32 v249, 102400, v5
    v_bfe_u32 v2, v0, 2, 2
    v_lshrrev_b32_e64 v3, 4, v0
    v_lshl_add_u32 v4, v3, 3, v2
    v_bfe_u32 v5, v0, 4, 1
    v_lshlrev_b32_e64 v5, 3, v5
    v_bfe_u32 v12, v0, 3, 1
    v_lshl_or_b32 v5, v12, 2, v5
    v_bfe_u32 v12, v0, 2, 1
    v_or_b32 v5, v5, v12
    v_and_b32 v12, 3, v0
    s_lshr_b32 s17, s14, 1
    s_lshl_b32 s17, s17, 3
    v_or_b32 v12, s17, v12
    v_xor_b32 v5, v5, v12
    v_lshlrev_b32_e64 v5, 3, v5
    v_lshl_add_u32 v5, v4, 7, v5
    v_add_u32 v250, 86016, v5
    v_xor_b32_e64 v251, 16, v250
    v_add_u32 v251, 512, v251
    v_xor_b32 v252, 32, v250
    v_xor_b32 v253, 32, v251
    v_bfe_u32 v5, v0, 4, 1
    v_lshlrev_b32_e64 v5, 2, v5
    v_bfe_u32 v12, v0, 3, 1
    v_or_b32 v5, v5, v12
    v_and_b32 v12, 3, v0
    s_and_b32 s17, s14, 1
    s_lshl_b32 s17, s17, 2
    v_or_b32 v12, s17, v12
    v_xor_b32 v5, v5, v12
    v_lshlrev_b32_e64 v5, 3, v5
    v_lshl_add_u32 v5, v4, 6, v5
    v_add_u32 v254, 102400, v5
    v_xor_b32_e64 v255, 16, v254
    v_add_u32 v255, 256, v255
    s_waitcnt vmcnt(11)
    s_barrier
    ds_read_b128 v[176:179], v1 offset:0
    ds_read_b128 v[180:183], v1 offset:28672
    ds_read_b128 v[184:187], v1 offset:1024
    ds_read_b128 v[188:191], v1 offset:29696
    s_waitcnt lgkmcnt(2)
    v_mfma_f32_32x32x16_bf16 v[144:159], v[176:179], v[32:35], 0
    s_add_u32 m0, s50, 12288
    s_add_u32 s67, s31, 10752
    buffer_load_dwordx4 v15, s[4:7], s67 offen sc1 lds
    ds_read_b128 v[192:195], v1 offset:2048
    v_mfma_f32_32x32x16_bf16 v[160:175], v[180:183], v[32:35], 0
    ds_read_b128 v[196:199], v1 offset:30720
    s_waitcnt lgkmcnt(2)
    v_mfma_f32_32x32x16_bf16 v[144:159], v[184:187], v[36:39], v[144:159]
    s_add_u32 m0, s50, 40960
    s_add_u32 s67, s31, 35840
    buffer_load_dwordx4 v15, s[4:7], s67 offen sc1 lds
    ds_read_b128 v[176:179], v1 offset:3072
    v_mfma_f32_32x32x16_bf16 v[160:175], v[188:191], v[36:39], v[160:175]
    ds_read_b128 v[180:183], v1 offset:31744
    s_waitcnt lgkmcnt(2)
    v_mfma_f32_32x32x16_bf16 v[144:159], v[192:195], v[40:43], v[144:159]
    s_waitcnt vmcnt(11)
    s_barrier
    ds_read_b128 v[184:187], v1 offset:4096
    v_mfma_f32_32x32x16_bf16 v[160:175], v[196:199], v[40:43], v[160:175]
    ds_read_b128 v[188:191], v1 offset:32768
    s_waitcnt lgkmcnt(2)
    v_mfma_f32_32x32x16_bf16 v[144:159], v[176:179], v[44:47], v[144:159]
    ds_read_b128 v[192:195], v1 offset:5120
    v_mul_f32 v5, 991054117, v206
    v_mul_f32 v2, 991054117, v207
    v_mfma_f32_32x32x16_bf16 v[160:175], v[180:183], v[44:47], v[160:175]
    ds_read_b128 v[196:199], v1 offset:33792
    v_fma_f32 v2, -v5, v5, v2
    v_max_f32 v2, 0, v2
    s_waitcnt lgkmcnt(2)
    v_mfma_f32_32x32x16_bf16 v[144:159], v[184:187], v[48:51], v[144:159]
    s_add_u32 m0, s50, 16384
    s_add_u32 s67, s31, 14336
    buffer_load_dwordx4 v15, s[4:7], s67 offen sc1 lds
    ds_read_b128 v[176:179], v1 offset:6144
    v_add_f32 v2, 925353388, v2
    v_rsq_f32_e64 v8, v2
    v_mfma_f32_32x32x16_bf16 v[160:175], v[188:191], v[48:51], v[160:175]
    ds_read_b128 v[180:183], v1 offset:34816
    s_waitcnt lgkmcnt(2)
    v_mfma_f32_32x32x16_bf16 v[144:159], v[192:195], v[52:55], v[144:159]
    s_add_u32 m0, s50, 45056
    s_add_u32 s67, s31, 39424
    buffer_load_dwordx4 v15, s[4:7], s67 offen sc1 lds
    ds_read_b128 v[184:187], v1 offset:7168
    v_mul_f32 v206, v206, v8
    v_mfma_f32_32x32x16_bf16 v[160:175], v[196:199], v[52:55], v[160:175]
    ds_read_b128 v[188:191], v1 offset:35840
    s_waitcnt lgkmcnt(2)
    v_mfma_f32_32x32x16_bf16 v[144:159], v[176:179], v[56:59], v[144:159]
    s_waitcnt vmcnt(4)
    s_barrier
    ds_read_b128 v[192:195], v1 offset:8192
    v_mfma_f32_32x32x16_bf16 v[160:175], v[180:183], v[56:59], v[160:175]
    ds_read_b128 v[196:199], v1 offset:36864
    s_waitcnt lgkmcnt(2)
    v_mfma_f32_32x32x16_bf16 v[144:159], v[184:187], v[60:63], v[144:159]
    ds_read_b128 v[176:179], v1 offset:9216
    v_mfma_f32_32x32x16_bf16 v[160:175], v[188:191], v[60:63], v[160:175]
    ds_read_b128 v[180:183], v1 offset:37888
    s_waitcnt lgkmcnt(2)
    v_mfma_f32_32x32x16_bf16 v[144:159], v[192:195], v[64:67], v[144:159]
    s_add_u32 m0, s50, 20480
    s_add_u32 s67, s31, 17920
    buffer_load_dwordx4 v15, s[4:7], s67 offen sc1 lds
    ds_read_b128 v[184:187], v1 offset:10240
    v_mfma_f32_32x32x16_bf16 v[160:175], v[196:199], v[64:67], v[160:175]
    ds_read_b128 v[188:191], v1 offset:38912
    s_waitcnt lgkmcnt(2)
    v_mfma_f32_32x32x16_bf16 v[144:159], v[176:179], v[68:71], v[144:159]
    s_add_u32 m0, s50, 49152
    s_add_u32 s67, s31, 43008
    buffer_load_dwordx4 v15, s[4:7], s67 offen sc1 lds
    ds_read_b128 v[192:195], v1 offset:11264
    v_mfma_f32_32x32x16_bf16 v[160:175], v[180:183], v[68:71], v[160:175]
    ds_read_b128 v[196:199], v1 offset:39936
    s_waitcnt lgkmcnt(2)
    v_mfma_f32_32x32x16_bf16 v[144:159], v[184:187], v[72:75], v[144:159]
    v_add_f32 v2, v240, v241
    v_add_f32 v3, v242, v243
    v_add_f32 v2, v2, v244
    v_add_f32 v3, v3, v245
    v_add_f32 v2, v2, v246
    v_add_f32 v2, v2, v3
    v_mov_b32 v3, v2
    s_min_u32 s18, s14, 2
    s_lshl_b32 s18, s18, 7
    s_add_u32 s18, s18, 147456
    v_and_b32 v4, 31, v0
    v_permlane32_swap_b32 v2, v3
    v_add_f32_e64 v2, v2, v3
    v_mul_f32 v2, 3138537765, v2
    v_lshl_add_u32 v4, v4, 2, s18
    ds_write_b32 v4, v2
    s_waitcnt lgkmcnt(0)
    s_waitcnt vmcnt(4)
    s_barrier
    ds_read_b128 v[176:179], v1 offset:12288
    v_mfma_f32_32x32x16_bf16 v[160:175], v[188:191], v[72:75], v[160:175]
    ds_read_b128 v[180:183], v1 offset:40960
    v_mfma_f32_32x32x16_bf16 v[144:159], v[192:195], v[76:79], v[144:159]
    ds_read_b128 v[184:187], v1 offset:13312
    v_lshrrev_b32 v13, 5, v0
    v_lshlrev_b32_e64 v13, 4, v13
    v_add_u32 v13, 147456, v13
    ds_read_b128 v[208:211], v13 offset:0
    v_mfma_f32_32x32x16_bf16 v[160:175], v[196:199], v[76:79], v[160:175]
    ds_read_b128 v[188:191], v1 offset:41984
    ds_read_b128 v[212:215], v13 offset:32
    s_waitcnt lgkmcnt(4)
    v_mfma_f32_32x32x16_bf16 v[144:159], v[176:179], v[80:83], v[144:159]
    s_add_u32 m0, s50, 24576
    s_add_u32 s67, s31, 21504
    buffer_load_dwordx4 v15, s[4:7], s67 offen sc1 lds
    ds_read_b128 v[192:195], v1 offset:14336
    ds_read_b128 v[216:219], v13 offset:64
    v_mfma_f32_32x32x16_bf16 v[160:175], v[180:183], v[80:83], v[160:175]
    ds_read_b128 v[196:199], v1 offset:43008
    ds_read_b128 v[220:223], v13 offset:96
    s_waitcnt lgkmcnt(5)
    v_mfma_f32_32x32x16_bf16 v[144:159], v[184:187], v[84:87], v[144:159]
    s_add_u32 m0, s50, 53248
    s_add_u32 s67, s31, 46592
    buffer_load_dwordx4 v15, s[4:7], s67 offen sc1 lds
    ds_read_b128 v[176:179], v1 offset:15360
    v_lshrrev_b32 v13, 5, v0
    v_lshlrev_b32 v13, 4, v13
    v_add_u32 v13, 147456, v13
    ds_read_b128 v[224:227], v13 offset:128
    v_mfma_f32_32x32x16_bf16 v[160:175], v[188:191], v[84:87], v[160:175]
    ds_read_b128 v[180:183], v1 offset:44032
    ds_read_b128 v[228:231], v13 offset:160
    s_waitcnt lgkmcnt(5)
    v_mfma_f32_32x32x16_bf16 v[144:159], v[192:195], v[88:91], v[144:159]
    s_waitcnt vmcnt(4)
    s_barrier
    ds_read_b128 v[184:187], v1 offset:16384
    ds_read_b128 v[232:235], v13 offset:192
    v_mfma_f32_32x32x16_bf16 v[160:175], v[196:199], v[88:91], v[160:175]
    ds_read_b128 v[188:191], v1 offset:45056
    ds_read_b128 v[236:239], v13 offset:224
    s_waitcnt lgkmcnt(5)
    v_mfma_f32_32x32x16_bf16 v[144:159], v[176:179], v[92:95], v[144:159]
    ds_read_b128 v[192:195], v1 offset:17408
    v_mfma_f32_32x32x16_bf16 v[160:175], v[180:183], v[92:95], v[160:175]
    ds_read_b128 v[196:199], v1 offset:46080
    s_waitcnt lgkmcnt(3)
    v_mfma_f32_32x32x16_bf16 v[144:159], v[184:187], v[96:99], v[144:159]
    ds_read_b128 v[176:179], v1 offset:18432
    v_mul_f32 v208, v208, v206
    v_mul_f32_e64 v209, v209, v206
    v_mfma_f32_32x32x16_bf16 v[160:175], v[188:191], v[96:99], v[160:175]
    ds_read_b128 v[180:183], v1 offset:47104
    v_mul_f32 v210, v210, v206
    v_mul_f32_e64 v211, v211, v206
    s_waitcnt lgkmcnt(2)
    v_mfma_f32_32x32x16_bf16 v[144:159], v[192:195], v[100:103], v[144:159]
    ds_read_b128 v[184:187], v1 offset:19456
    v_mul_f32 v212, v212, v206
    v_mul_f32 v213, v213, v206
    v_mfma_f32_32x32x16_bf16 v[160:175], v[196:199], v[100:103], v[160:175]
    ds_read_b128 v[188:191], v1 offset:48128
    v_mul_f32 v214, v214, v206
    v_mul_f32_e64 v215, v215, v206
    s_waitcnt lgkmcnt(2)
    v_mfma_f32_32x32x16_bf16 v[144:159], v[176:179], v[104:107], v[144:159]
    s_waitcnt vmcnt(2)
    s_barrier
    ds_read_b128 v[192:195], v1 offset:20480
    v_mul_f32 v216, v216, v206
    v_mul_f32 v217, v217, v206
    v_mfma_f32_32x32x16_bf16 v[160:175], v[180:183], v[104:107], v[160:175]
    ds_read_b128 v[196:199], v1 offset:49152
    v_mul_f32 v218, v218, v206
    v_mul_f32_e64 v219, v219, v206
    s_waitcnt lgkmcnt(2)
    v_mfma_f32_32x32x16_bf16 v[144:159], v[184:187], v[108:111], v[144:159]
    ds_read_b128 v[176:179], v1 offset:21504
    v_mul_f32 v220, v220, v206
    v_mul_f32 v221, v221, v206
    v_mfma_f32_32x32x16_bf16 v[160:175], v[188:191], v[108:111], v[160:175]
    ds_read_b128 v[180:183], v1 offset:50176
    v_mul_f32 v222, v222, v206
    v_mul_f32_e64 v223, v223, v206
    s_waitcnt lgkmcnt(2)
    v_mfma_f32_32x32x16_bf16 v[144:159], v[192:195], v[112:115], v[144:159]
    s_add_u32 m0, s50, 57344
    s_add_u32 s67, s31, 50176
    buffer_load_dwordx4 v15, s[4:7], s67 offen sc1 lds
    ds_read_b128 v[184:187], v1 offset:22528
    v_mul_f32 v224, v224, v206
    v_mul_f32 v225, v225, v206
    v_mfma_f32_32x32x16_bf16 v[160:175], v[196:199], v[112:115], v[160:175]
    ds_read_b128 v[188:191], v1 offset:51200
    s_add_u32 m0, s50, 61440
    s_add_u32 s67, s31, 53760
    buffer_load_dwordx4 v15, s[4:7], s67 offen sc1 lds
    v_mul_f32 v226, v226, v206
    v_mul_f32_e64 v227, v227, v206
    s_waitcnt lgkmcnt(2)
    v_mfma_f32_32x32x16_bf16 v[144:159], v[176:179], v[116:119], v[144:159]
    s_add_u32 m0, s50, 65536
    s_add_u32 s67, s31, 57344
    buffer_load_dwordx4 v15, s[4:7], s67 offen sc1 lds
    ds_read_b128 v[192:195], v1 offset:23552
    v_mul_f32 v228, v228, v206
    v_mul_f32 v229, v229, v206
    v_mfma_f32_32x32x16_bf16 v[160:175], v[180:183], v[116:119], v[160:175]
    ds_read_b128 v[196:199], v1 offset:52224
    s_add_u32 m0, s50, 69632
    s_add_u32 s67, s31, 60928
    buffer_load_dwordx4 v15, s[4:7], s67 offen sc1 lds
    v_mul_f32 v230, v230, v206
    v_mul_f32_e64 v231, v231, v206
    s_waitcnt lgkmcnt(2)
    v_mfma_f32_32x32x16_bf16 v[144:159], v[184:187], v[120:123], v[144:159]
    s_add_u32 m0, s50, 73728
    s_add_u32 s67, s31, 64512
    buffer_load_dwordx4 v15, s[4:7], s67 offen sc1 lds
    s_waitcnt vmcnt(5)
    s_barrier
    ds_read_b128 v[176:179], v1 offset:24576
    v_mul_f32 v232, v232, v206
    v_mul_f32 v233, v233, v206
    v_mfma_f32_32x32x16_bf16 v[160:175], v[188:191], v[120:123], v[160:175]
    ds_read_b128 v[180:183], v1 offset:53248
    s_add_u32 m0, s50, 77824
    s_add_u32 s67, s31, 68096
    buffer_load_dwordx4 v15, s[4:7], s67 offen sc1 lds
    v_mul_f32 v234, v234, v206
    v_mul_f32_e64 v235, v235, v206
    s_waitcnt lgkmcnt(2)
    v_mfma_f32_32x32x16_bf16 v[144:159], v[192:195], v[124:127], v[144:159]
    s_add_u32 m0, s50, 81920
    s_add_u32 s67, s31, 71680
    buffer_load_dwordx4 v15, s[4:7], s67 offen sc1 lds
    ds_read_b128 v[184:187], v1 offset:25600
    v_mul_f32 v236, v236, v206
    v_mul_f32 v237, v237, v206
    v_mfma_f32_32x32x16_bf16 v[160:175], v[196:199], v[124:127], v[160:175]
    ds_read_b128 v[188:191], v1 offset:54272
    v_and_b32 v241, 15, v0
    s_lshl_b32 s67, s13, 4
    v_add_u32 v242, s67, v241
    s_add_u32 s67, s60, 20
    s_lshr_b32 s67, s67, 2
    s_add_u32 s68, s60, 34
    s_lshr_b32 s68, s68, 2
    v_mov_b32 v243, s67
    v_mov_b32 v244, s68
    v_cmp_lt_u32 vcc, 31, v0
    s_nop 1
    v_cndmask_b32 v243, v243, v244, vcc
    v_mov_b32 v244, s12
    v_cmp_lt_u32 vcc, 47, v0
    s_nop 1
    v_cndmask_b32 v243, v243, v244, vcc
    v_lshl_add_u32 v243, v241, 4, v243
    v_cmp_lt_u32 vcc, 15, v0
    s_nop 1
    v_cndmask_b32 v242, v242, v243, vcc
    v_lshlrev_b32 v242, 7, v242
    s_mov_b32 s67, 3997696
    buffer_load_dwordx2 v[240:241], v242, s[4:7], s67 offen sc1
    v_mul_f32 v238, v238, v206
    v_mul_f32_e64 v239, v239, v206
    s_waitcnt lgkmcnt(2)
    v_mfma_f32_32x32x16_bf16 v[144:159], v[176:179], v[128:131], v[144:159]
    ds_read_b128 v[192:195], v1 offset:26624
    v_mfma_f32_32x32x16_bf16 v[160:175], v[180:183], v[128:131], v[160:175]
    ds_read_b128 v[196:199], v1 offset:55296
    s_waitcnt lgkmcnt(2)
    v_mfma_f32_32x32x16_bf16 v[144:159], v[184:187], v[132:135], v[144:159]
    ds_read_b128 v[176:179], v1 offset:27648
    v_mfma_f32_32x32x16_bf16 v[160:175], v[188:191], v[132:135], v[160:175]
    ds_read_b128 v[180:183], v1 offset:56320
    s_waitcnt lgkmcnt(2)
    v_mfma_f32_32x32x16_bf16 v[144:159], v[192:195], v[136:139], v[144:159]
    v_mfma_f32_32x32x16_bf16 v[160:175], v[196:199], v[136:139], v[160:175]
    s_waitcnt lgkmcnt(0)
    v_mfma_f32_32x32x16_bf16 v[144:159], v[176:179], v[140:143], v[144:159]
    v_mfma_f32_32x32x16_bf16 v[160:175], v[180:183], v[140:143], v[160:175]
    s_nop 11
    v_pk_fma_f32 v[160:161], v[160:161], v[8:9], v[224:225] op_sel_hi:[1,0,1]
    v_pk_fma_f32 v[162:163], v[162:163], v[8:9], v[226:227] op_sel_hi:[1,0,1]
    v_pk_fma_f32 v[164:165], v[164:165], v[8:9], v[228:229] op_sel_hi:[1,0,1]
    v_pk_fma_f32 v[166:167], v[166:167], v[8:9], v[230:231] op_sel_hi:[1,0,1]
    v_pk_fma_f32 v[168:169], v[168:169], v[8:9], v[232:233] op_sel_hi:[1,0,1]
    v_pk_fma_f32 v[170:171], v[170:171], v[8:9], v[234:235] op_sel_hi:[1,0,1]
    v_pk_fma_f32 v[172:173], v[172:173], v[8:9], v[236:237] op_sel_hi:[1,0,1]
    v_pk_fma_f32 v[174:175], v[174:175], v[8:9], v[238:239] op_sel_hi:[1,0,1]
    s_mov_b64 exec, s[54:55]
    v_mov_b32_e64 v172, 1.0
    s_mov_b64 exec, -1
    v_cvt_pk_bf16_f32 v176, v160, v161
    v_cvt_pk_bf16_f32 v177, v162, v163
    v_cvt_pk_bf16_f32 v178, v164, v165
    v_cvt_pk_bf16_f32 v179, v166, v167
    v_cvt_pk_bf16_f32 v180, v168, v169
    v_cvt_pk_bf16_f32 v181, v170, v171
    v_cvt_pk_bf16_f32 v182, v172, v173
    v_cvt_pk_bf16_f32 v183, v174, v175
    ds_write_b64 v249, v[176:177]
    v_xor_b32_e64 v12, 16, v249
    ds_write_b64 v12, v[178:179]
    v_xor_b32_e64 v12, 32, v249
    ds_write_b64 v12, v[180:181]
    v_xor_b32_e64 v12, 48, v249
    ds_write_b64 v12, v[182:183]
    v_pk_fma_f32 v[144:145], v[144:145], v[8:9], v[208:209] op_sel_hi:[1,0,1]
    v_pk_fma_f32 v[146:147], v[146:147], v[8:9], v[210:211] op_sel_hi:[1,0,1]
    v_pk_fma_f32 v[148:149], v[148:149], v[8:9], v[212:213] op_sel_hi:[1,0,1]
    v_pk_fma_f32 v[150:151], v[150:151], v[8:9], v[214:215] op_sel_hi:[1,0,1]
    v_pk_fma_f32 v[152:153], v[152:153], v[8:9], v[216:217] op_sel_hi:[1,0,1]
    v_pk_fma_f32 v[154:155], v[154:155], v[8:9], v[218:219] op_sel_hi:[1,0,1]
    v_pk_fma_f32 v[156:157], v[156:157], v[8:9], v[220:221] op_sel_hi:[1,0,1]
    v_pk_fma_f32 v[158:159], v[158:159], v[8:9], v[222:223] op_sel_hi:[1,0,1]
    s_mov_b64 exec, s[54:55]
    v_mov_b32 v156, v144
    v_mov_b32 v157, v144
    v_mov_b32 v158, v144
    v_mov_b32 v159, v144
    s_mov_b64 exec, -1
    v_max3_f32 v2, v144, v145, v146
    v_max3_f32 v2, v2, v147, v148
    v_max3_f32 v2, v2, v149, v150
    v_max3_f32 v2, v2, v151, v152
    v_max3_f32 v2, v2, v153, v154
    v_max3_f32 v2, v2, v155, v156
    v_max3_f32 v2, v2, v157, v158
    v_max3_f32 v2, v2, v159, v159
    v_min3_f32 v4, v144, v145, v146
    v_min3_f32 v4, v4, v147, v148
    v_min3_f32 v4, v4, v149, v150
    v_min3_f32 v4, v4, v151, v152
    v_min3_f32 v4, v4, v153, v154
    v_min3_f32 v4, v4, v155, v156
    v_min3_f32 v4, v4, v157, v158
    v_min3_f32 v4, v4, v159, v159
    v_mov_b32 v3, v2
    v_mov_b32 v5, v4
    s_nop 0
    v_permlane32_swap_b32 v2, v3
    v_permlane32_swap_b32 v4, v5
    v_max_f32 v10, v2, v3
    v_min_f32_e64 v11, v4, v5
    v_pk_add_f32 v[208:209], v[144:145], v[10:11] op_sel_hi:[1,0] neg_lo:[0,1] neg_hi:[0,1]
    v_pk_add_f32 v[224:225], v[144:145], v[10:11] op_sel:[0,1] op_sel_hi:[1,1] neg_lo:[1,0] neg_hi:[1,0]
    v_pk_add_f32 v[210:211], v[146:147], v[10:11] op_sel_hi:[1,0] neg_lo:[0,1] neg_hi:[0,1]
    v_pk_add_f32 v[226:227], v[146:147], v[10:11] op_sel:[0,1] op_sel_hi:[1,1] neg_lo:[1,0] neg_hi:[1,0]
    v_pk_add_f32 v[212:213], v[148:149], v[10:11] op_sel_hi:[1,0] neg_lo:[0,1] neg_hi:[0,1]
    v_pk_add_f32 v[228:229], v[148:149], v[10:11] op_sel:[0,1] op_sel_hi:[1,1] neg_lo:[1,0] neg_hi:[1,0]
    v_pk_add_f32 v[214:215], v[150:151], v[10:11] op_sel_hi:[1,0] neg_lo:[0,1] neg_hi:[0,1]
    v_pk_add_f32 v[230:231], v[150:151], v[10:11] op_sel:[0,1] op_sel_hi:[1,1] neg_lo:[1,0] neg_hi:[1,0]
    v_pk_add_f32 v[216:217], v[152:153], v[10:11] op_sel_hi:[1,0] neg_lo:[0,1] neg_hi:[0,1]
    v_pk_add_f32 v[232:233], v[152:153], v[10:11] op_sel:[0,1] op_sel_hi:[1,1] neg_lo:[1,0] neg_hi:[1,0]
    v_pk_add_f32 v[218:219], v[154:155], v[10:11] op_sel_hi:[1,0] neg_lo:[0,1] neg_hi:[0,1]
    v_pk_add_f32 v[234:235], v[154:155], v[10:11] op_sel:[0,1] op_sel_hi:[1,1] neg_lo:[1,0] neg_hi:[1,0]
    v_pk_add_f32 v[220:221], v[156:157], v[10:11] op_sel_hi:[1,0] neg_lo:[0,1] neg_hi:[0,1]
    v_pk_add_f32 v[236:237], v[156:157], v[10:11] op_sel:[0,1] op_sel_hi:[1,1] neg_lo:[1,0] neg_hi:[1,0]
    v_pk_add_f32 v[222:223], v[158:159], v[10:11] op_sel_hi:[1,0] neg_lo:[0,1] neg_hi:[0,1]
    v_pk_add_f32 v[238:239], v[158:159], v[10:11] op_sel:[0,1] op_sel_hi:[1,1] neg_lo:[1,0] neg_hi:[1,0]
    v_exp_f32 v208, v208
    v_exp_f32 v224, v224
    v_exp_f32 v209, v209
    v_exp_f32 v225, v225
    v_exp_f32 v210, v210
    v_exp_f32 v226, v226
    v_exp_f32 v211, v211
    v_exp_f32 v227, v227
    v_exp_f32 v212, v212
    v_exp_f32 v228, v228
    v_exp_f32 v213, v213
    v_exp_f32 v229, v229
    v_exp_f32 v214, v214
    v_exp_f32 v230, v230
    v_exp_f32 v215, v215
    v_exp_f32 v231, v231
    v_exp_f32 v216, v216
    v_exp_f32 v232, v232
    v_exp_f32 v217, v217
    v_exp_f32 v233, v233
    v_exp_f32 v218, v218
    v_exp_f32 v234, v234
    v_exp_f32 v219, v219
    v_exp_f32 v235, v235
    v_exp_f32 v220, v220
    v_exp_f32 v236, v236
    v_exp_f32 v221, v221
    v_exp_f32 v237, v237
    v_exp_f32 v222, v222
    v_exp_f32 v238, v238
    v_exp_f32 v223, v223
    v_exp_f32 v239, v239
    s_mov_b64 exec, s[54:55]
    v_mov_b32 v220, 0
    v_mov_b32 v236, 0
    v_mov_b32 v221, 0
    v_mov_b32 v237, 0
    v_mov_b32 v222, 0
    v_mov_b32 v238, 0
    v_mov_b32 v223, 0
    v_mov_b32 v239, 0
    s_mov_b64 exec, -1
    v_pk_add_f32 v[2:3], v[208:209], v[210:211]
    v_pk_add_f32 v[4:5], v[224:225], v[226:227]
    v_pk_add_f32 v[2:3], v[2:3], v[212:213]
    v_pk_add_f32 v[4:5], v[4:5], v[228:229]
    v_pk_add_f32 v[2:3], v[2:3], v[214:215]
    v_pk_add_f32 v[4:5], v[4:5], v[230:231]
    v_pk_add_f32 v[2:3], v[2:3], v[216:217]
    v_pk_add_f32 v[4:5], v[4:5], v[232:233]
    v_pk_add_f32 v[2:3], v[2:3], v[218:219]
    v_pk_add_f32 v[4:5], v[4:5], v[234:235]
    v_pk_add_f32 v[2:3], v[2:3], v[220:221]
    v_pk_add_f32 v[4:5], v[4:5], v[236:237]
    v_pk_add_f32 v[2:3], v[2:3], v[222:223]
    v_pk_add_f32 v[4:5], v[4:5], v[238:239]
    v_add_f32 v2, v2, v3
    v_add_f32 v4, v4, v5
    v_mov_b32 v3, v2
    v_mov_b32 v5, v4
    s_nop 0
    v_permlane32_swap_b32 v2, v3
    v_permlane32_swap_b32 v4, v5
    v_add_f32 v2, v2, v3
    v_add_f32 v4, v4, v5
    v_rcp_f32 v10, v2
    v_rcp_f32 v11, v4
    s_nop 0
    v_pk_mul_f32 v[208:209], v[208:209], v[10:11] op_sel_hi:[1,0]
    v_pk_mul_f32 v[210:211], v[210:211], v[10:11] op_sel_hi:[1,0]
    v_cvt_pk_bf16_f32 v176, v208, v209
    v_cvt_pk_bf16_f32 v177, v210, v211
    ds_write_b64 v248, v[176:177]
    v_pk_mul_f32 v[212:213], v[212:213], v[10:11] op_sel_hi:[1,0]
    v_pk_mul_f32 v[214:215], v[214:215], v[10:11] op_sel_hi:[1,0]
    v_cvt_pk_bf16_f32 v178, v212, v213
    v_cvt_pk_bf16_f32 v179, v214, v215
    v_xor_b32_e64 v13, 16, v248
    ds_write_b64 v13, v[178:179]
    v_pk_mul_f32 v[216:217], v[216:217], v[10:11] op_sel_hi:[1,0]
    v_pk_mul_f32 v[218:219], v[218:219], v[10:11] op_sel_hi:[1,0]
    v_cvt_pk_bf16_f32 v180, v216, v217
    v_cvt_pk_bf16_f32 v181, v218, v219
    v_xor_b32_e64 v12, 32, v248
    ds_write_b64 v12, v[180:181]
    v_pk_mul_f32 v[220:221], v[220:221], v[10:11] op_sel_hi:[1,0]
    v_pk_mul_f32 v[222:223], v[222:223], v[10:11] op_sel_hi:[1,0]
    v_cvt_pk_bf16_f32 v182, v220, v221
    v_cvt_pk_bf16_f32 v183, v222, v223
    v_xor_b32_e64 v13, 48, v248
    ds_write_b64 v13, v[182:183]
    v_pk_mul_f32 v[224:225], v[224:225], v[10:11] op_sel:[0,1] op_sel_hi:[1,1]
    v_pk_mul_f32 v[226:227], v[226:227], v[10:11] op_sel:[0,1] op_sel_hi:[1,1]
    v_cvt_pk_bf16_f32 v184, v224, v225
    v_cvt_pk_bf16_f32 v185, v226, v227
    v_xor_b32_e64 v12, 64, v248
    ds_write_b64 v12, v[184:185]
    v_pk_mul_f32 v[228:229], v[228:229], v[10:11] op_sel:[0,1] op_sel_hi:[1,1]
    v_pk_mul_f32 v[230:231], v[230:231], v[10:11] op_sel:[0,1] op_sel_hi:[1,1]
    v_cvt_pk_bf16_f32 v186, v228, v229
    v_cvt_pk_bf16_f32 v187, v230, v231
    v_xor_b32 v13, 80, v248
    ds_write_b64 v13, v[186:187]
    v_pk_mul_f32 v[232:233], v[232:233], v[10:11] op_sel:[0,1] op_sel_hi:[1,1]
    v_pk_mul_f32 v[234:235], v[234:235], v[10:11] op_sel:[0,1] op_sel_hi:[1,1]
    v_cvt_pk_bf16_f32 v188, v232, v233
    v_cvt_pk_bf16_f32 v189, v234, v235
    v_xor_b32 v12, 96, v248
    ds_write_b64 v12, v[188:189]
    v_pk_mul_f32 v[236:237], v[236:237], v[10:11] op_sel:[0,1] op_sel_hi:[1,1]
    v_pk_mul_f32 v[238:239], v[238:239], v[10:11] op_sel:[0,1] op_sel_hi:[1,1]
    v_cvt_pk_bf16_f32 v190, v236, v237
    v_cvt_pk_bf16_f32 v191, v238, v239
    v_xor_b32 v13, 112, v248
    ds_write_b64 v13, v[190:191]
    v_lshrrev_b32_e64 v2, 5, v0
    v_bfe_u32 v3, v0, 4, 1
    v_and_b32_e64 v4, 15, v0
    v_lshl_or_b32 v4, v3, 5, v4
    v_lshlrev_b32_e64 v4, 4, v4
    v_lshl_or_b32 v4, v2, 10, v4
    s_lshr_b32 s17, s14, 1
    s_lshl_b32 s17, s17, 11
    s_and_b32 s18, s14, 1
    s_lshl_b32 s18, s18, 8
    s_add_u32 s17, s17, s18
    s_add_u32 s19, s17, s37
    v_mov_b32 v9, s56
    s_waitcnt lgkmcnt(0)
    s_waitcnt vmcnt(1)
    s_barrier
    ds_read_b64_tr_b16 v[208:209], v250 offset:0
    ds_read_b64_tr_b16 v[210:211], v251 offset:0
    ds_read_b64_tr_b16 v[212:213], v252 offset:0
    ds_read_b64_tr_b16 v[214:215], v253 offset:0
    ds_read_b64_tr_b16 v[216:217], v254 offset:0
    ds_read_b64_tr_b16 v[218:219], v255 offset:0
    ds_read_b64_tr_b16 v[220:221], v250 offset:4096
    ds_read_b64_tr_b16 v[222:223], v251 offset:4096
    ds_read_b64_tr_b16 v[224:225], v252 offset:4096
    ds_read_b64_tr_b16 v[226:227], v253 offset:4096
    ds_read_b64_tr_b16 v[228:229], v254 offset:2048
    ds_read_b64_tr_b16 v[230:231], v255 offset:2048
    s_waitcnt lgkmcnt(6)
    v_mfma_f32_16x16x32_bf16 v[160:163], v[208:211], v[216:219], 0
    v_mfma_f32_16x16x32_bf16 v[164:167], v[212:215], v[216:219], 0
    ds_read_b64_tr_b16 v[208:209], v250 offset:8192
    ds_read_b64_tr_b16 v[210:211], v251 offset:8192
    ds_read_b64_tr_b16 v[212:213], v252 offset:8192
    ds_read_b64_tr_b16 v[214:215], v253 offset:8192
    ds_read_b64_tr_b16 v[216:217], v254 offset:4096
    ds_read_b64_tr_b16 v[218:219], v255 offset:4096
    s_waitcnt lgkmcnt(6)
    v_mfma_f32_16x16x32_bf16 v[160:163], v[220:223], v[228:231], v[160:163]
    v_mfma_f32_16x16x32_bf16 v[164:167], v[224:227], v[228:231], v[164:167]
    ds_read_b64_tr_b16 v[220:221], v250 offset:12288
    ds_read_b64_tr_b16 v[222:223], v251 offset:12288
    ds_read_b64_tr_b16 v[224:225], v252 offset:12288
    ds_read_b64_tr_b16 v[226:227], v253 offset:12288
    ds_read_b64_tr_b16 v[228:229], v254 offset:6144
    ds_read_b64_tr_b16 v[230:231], v255 offset:6144
    s_waitcnt lgkmcnt(6)
    v_mfma_f32_16x16x32_bf16 v[160:163], v[208:211], v[216:219], v[160:163]
    v_mfma_f32_16x16x32_bf16 v[164:167], v[212:215], v[216:219], v[164:167]
    s_waitcnt lgkmcnt(0)
    v_mfma_f32_16x16x32_bf16 v[160:163], v[220:223], v[228:231], v[160:163]
    v_mfma_f32_16x16x32_bf16 v[164:167], v[224:227], v[228:231], v[164:167]
    v_add_u32 v12, 32768, v1
    ds_read_b128 v[176:179], v12 offset:24576
    ds_read_b128 v[180:183], v12 offset:25600
    ds_read_b128 v[184:187], v12 offset:26624
    s_nop 2
    v_cvt_pk_bf16_f32 v232, v160, v161
    v_cvt_pk_bf16_f32 v233, v162, v163
    v_cvt_pk_bf16_f32 v234, v164, v165
    v_cvt_pk_bf16_f32 v235, v166, v167
    s_nop 0
    v_permlane32_swap_b32 v232, v234
    v_permlane32_swap_b32 v233, v235
    buffer_store_dwordx4 v[232:235], v4, s[4:7], s19 offen sc1
    s_waitcnt vmcnt(1)
L_g2_4:
    v_cmp_ne_u32 vcc, s56, v240
    s_cbranch_vccnz L_g2again_5
    v_cmp_ne_u32 vcc, s52, v241
    s_nop 0
    s_lshr_b32 s16, vcc_hi, 16
    s_waitcnt lgkmcnt(2)
    v_mfma_f32_32x32x16_bf16 v[144:159], v[176:179], v[32:35], 0
    ds_read_b128 v[188:191], v12 offset:27648
    s_add_u32 m0, s50, 0
    s_add_u32 s67, s32, 0
    buffer_load_dwordx4 v15, s[4:7], s67 offen sc1 lds
    s_waitcnt lgkmcnt(2)
    v_mfma_f32_32x32x16_bf16 v[144:159], v[180:183], v[36:39], v[144:159]
    ds_read_b128 v[176:179], v12 offset:28672
    s_waitcnt lgkmcnt(2)
    v_mfma_f32_32x32x16_bf16 v[144:159], v[184:187], v[40:43], v[144:159]
    ds_read_b128 v[180:183], v12 offset:29696
    s_add_u32 m0, s50, 4096
    s_add_u32 s67, s32, 3584
    buffer_load_dwordx4 v15, s[4:7], s67 offen sc1 lds
    s_waitcnt lgkmcnt(2)
    v_mfma_f32_32x32x16_bf16 v[144:159], v[188:191], v[44:47], v[144:159]
    ds_read_b128 v[184:187], v12 offset:30720
    s_waitcnt lgkmcnt(2)
    v_mfma_f32_32x32x16_bf16 v[144:159], v[176:179], v[48:51], v[144:159]
    ds_read_b128 v[188:191], v12 offset:31744
    s_add_u32 m0, s50, 8192
    s_add_u32 s67, s32, 7168
    buffer_load_dwordx4 v15, s[4:7], s67 offen sc1 lds
    s_waitcnt lgkmcnt(2)
    v_mfma_f32_32x32x16_bf16 v[144:159], v[180:183], v[52:55], v[144:159]
    ds_read_b128 v[176:179], v12 offset:32768
    v_lshrrev_b32 v13, 5, v0
    v_lshlrev_b32 v13, 4, v13
    v_add_u32 v13, 147456, v13
    ds_read_b128 v[208:211], v13 offset:256
    s_waitcnt lgkmcnt(3)
    v_mfma_f32_32x32x16_bf16 v[144:159], v[184:187], v[56:59], v[144:159]
    ds_read_b128 v[180:183], v12 offset:33792
    s_add_u32 m0, s50, 12288
    s_add_u32 s67, s32, 10752
    buffer_load_dwordx4 v15, s[4:7], s67 offen sc1 lds
    ds_read_b128 v[212:215], v13 offset:288
    s_waitcnt lgkmcnt(4)
    v_mfma_f32_32x32x16_bf16 v[144:159], v[188:191], v[60:63], v[144:159]
    ds_read_b128 v[184:187], v12 offset:34816
    ds_read_b128 v[216:219], v13 offset:320
    s_waitcnt lgkmcnt(5)
    v_mfma_f32_32x32x16_bf16 v[144:159], v[176:179], v[64:67], v[144:159]
    ds_read_b128 v[188:191], v12 offset:35840
    s_add_u32 m0, s50, 16384
    s_add_u32 s67, s32, 14336
    buffer_load_dwordx4 v15, s[4:7], s67 offen sc1 lds
    ds_read_b128 v[220:223], v13 offset:352
    s_waitcnt lgkmcnt(5)
    v_mfma_f32_32x32x16_bf16 v[144:159], v[180:183], v[68:71], v[144:159]
    ds_read_b128 v[176:179], v12 offset:36864
    s_waitcnt lgkmcnt(4)
    v_mfma_f32_32x32x16_bf16 v[144:159], v[184:187], v[72:75], v[144:159]
    ds_read_b128 v[180:183], v12 offset:37888
    s_add_u32 m0, s50, 20480
    s_add_u32 s67, s32, 17920
    buffer_load_dwordx4 v15, s[4:7], s67 offen sc1 lds
    s_waitcnt lgkmcnt(3)
    v_mfma_f32_32x32x16_bf16 v[144:159], v[188:191], v[76:79], v[144:159]
    ds_read_b128 v[184:187], v12 offset:38912
    s_waitcnt lgkmcnt(3)
    v_mul_f32_e64 v208, v208, v206
    s_waitcnt lgkmcnt(2)
    v_mfma_f32_32x32x16_bf16 v[144:159], v[176:179], v[80:83], v[144:159]
    ds_read_b128 v[188:191], v12 offset:39936
    s_add_u32 m0, s50, 24576
    s_add_u32 s67, s32, 21504
    buffer_load_dwordx4 v15, s[4:7], s67 offen sc1 lds
    v_mul_f32 v209, v209, v206
    s_waitcnt lgkmcnt(2)
    v_mfma_f32_32x32x16_bf16 v[144:159], v[180:183], v[84:87], v[144:159]
    ds_read_b128 v[176:179], v12 offset:40960
    v_mul_f32 v210, v210, v206
    s_waitcnt lgkmcnt(2)
    v_mfma_f32_32x32x16_bf16 v[144:159], v[184:187], v[88:91], v[144:159]
    ds_read_b128 v[180:183], v12 offset:41984
    s_add_u32 m0, s50, 28672
    s_add_u32 s67, s32, 25088
    buffer_load_dwordx4 v15, s[4:7], s67 offen sc1 lds
    v_mul_f32 v211, v211, v206
    s_waitcnt lgkmcnt(2)
    v_mfma_f32_32x32x16_bf16 v[144:159], v[188:191], v[92:95], v[144:159]
    ds_read_b128 v[184:187], v12 offset:43008
    v_mul_f32 v212, v212, v206
    s_waitcnt lgkmcnt(2)
    v_mfma_f32_32x32x16_bf16 v[144:159], v[176:179], v[96:99], v[144:159]
    ds_read_b128 v[188:191], v12 offset:44032
    s_add_u32 m0, s50, 32768
    s_add_u32 s67, s32, 28672
    buffer_load_dwordx4 v15, s[4:7], s67 offen sc1 lds
    v_mul_f32 v213, v213, v206
    s_waitcnt lgkmcnt(2)
    v_mfma_f32_32x32x16_bf16 v[144:159], v[180:183], v[100:103], v[144:159]
    ds_read_b128 v[176:179], v12 offset:45056
    v_mul_f32 v214, v214, v206
    s_waitcnt lgkmcnt(2)
    v_mfma_f32_32x32x16_bf16 v[144:159], v[184:187], v[104:107], v[144:159]
    ds_read_b128 v[180:183], v12 offset:46080
    s_add_u32 m0, s50, 36864
    s_add_u32 s67, s32, 32256
    buffer_load_dwordx4 v15, s[4:7], s67 offen sc1 lds
    v_mul_f32 v215, v215, v206
    s_waitcnt lgkmcnt(2)
    v_mfma_f32_32x32x16_bf16 v[144:159], v[188:191], v[108:111], v[144:159]
    ds_read_b128 v[184:187], v12 offset:47104
    v_mul_f32 v216, v216, v206
    s_waitcnt lgkmcnt(2)
    v_mfma_f32_32x32x16_bf16 v[144:159], v[176:179], v[112:115], v[144:159]
    ds_read_b128 v[188:191], v12 offset:48128
    s_add_u32 m0, s50, 40960
    s_add_u32 s67, s32, 35840
    buffer_load_dwordx4 v15, s[4:7], s67 offen sc1 lds
    v_mul_f32 v217, v217, v206
    s_waitcnt lgkmcnt(2)
    v_mfma_f32_32x32x16_bf16 v[144:159], v[180:183], v[116:119], v[144:159]
    ds_read_b128 v[176:179], v12 offset:49152
    v_mul_f32 v218, v218, v206
    s_waitcnt lgkmcnt(2)
    v_mfma_f32_32x32x16_bf16 v[144:159], v[184:187], v[120:123], v[144:159]
    ds_read_b128 v[180:183], v12 offset:50176
    s_add_u32 m0, s50, 45056
    s_add_u32 s67, s32, 39424
    buffer_load_dwordx4 v15, s[4:7], s67 offen sc1 lds
    v_mul_f32_e64 v219, v219, v206
    s_waitcnt vmcnt(12)
    s_mov_b64 exec, 1
    buffer_store_dword v9, off, s[4:7], s40 sc1
    s_mov_b64 exec, -1
    s_waitcnt lgkmcnt(2)
    v_mfma_f32_32x32x16_bf16 v[144:159], v[188:191], v[124:127], v[144:159]
    ds_read_b128 v[184:187], v12 offset:51200
    v_mul_f32 v220, v220, v206
    s_waitcnt lgkmcnt(2)
    v_mfma_f32_32x32x16_bf16 v[144:159], v[176:179], v[128:131], v[144:159]
    ds_read_b128 v[188:191], v12 offset:52224
    s_add_u32 m0, s50, 49152
    s_add_u32 s67, s32, 43008
    buffer_load_dwordx4 v15, s[4:7], s67 offen sc1 lds
    v_mul_f32 v221, v221, v206
    s_waitcnt lgkmcnt(2)
    v_mfma_f32_32x32x16_bf16 v[144:159], v[180:183], v[132:135], v[144:159]
    v_mul_f32 v222, v222, v206
    s_waitcnt lgkmcnt(1)
    v_mfma_f32_32x32x16_bf16 v[144:159], v[184:187], v[136:139], v[144:159]
    s_add_u32 m0, s50, 53248
    s_add_u32 s67, s32, 46592
    buffer_load_dwordx4 v15, s[4:7], s67 offen sc1 lds
    v_mul_f32 v223, v223, v206
    s_waitcnt lgkmcnt(0)
    v_mfma_f32_32x32x16_bf16 v[144:159], v[188:191], v[140:143], v[144:159]
    s_barrier
    v_and_b32 v176, 15, v0
    v_lshlrev_b32_e64 v176, 7, v176
    s_mul_i32 s67, s13, 1792
    s_add_u32 s67, s67, s33
    v_mov_b32 v177, s67
    v_mov_b32_e64 v178, s35
    v_cndmask_b32 v177, v177, v178, s[54:55]
    s_and_b32 s67, s60, 1
    s_lshl_b32 s67, s67, 8
    s_add_u32 s67, s67, s58
    v_add_u32 v176, v176, v177
    v_writelane_b32 v176, s67, 16
    s_add_u32 s67, s67, 128
    v_writelane_b32 v176, s67, 17
    buffer_load_dword v6, v176, s[4:7], 0 offen sc1
    s_getpc_b64 s[28:29]
L_pc_6:
    s_lshr_b32 s67, s2, 3
    s_lshl_b32 s67, s67, 2
    s_add_u32 s67, s67, s14
    s_lshl_b32 s67, s67, 7
    s_add_u32 s67, s67, 1024
    s_min_u32 s67, s67, interleave_layers__linear_kernel_hedgehog__mha_block__prompt_kernel_last-L_pc_6-4
    v_mov_b32 v176, s67
    global_load_dword v6, v176, s[28:29]
    s_add_u32 s17, s13, 16
    s_mul_i32 s17, s17, 3
    s_min_u32 s18, s14, 2
    s_add_u32 s17, s17, s18
    s_lshl_b32 s17, s17, 11
    s_add_u32 s17, s17, 3670016
    v_lshrrev_b32 v2, 5, v0
    v_mul_u32_u24 v2, 896, v2
    v_and_b32_e64 v3, 31, v0
    v_lshl_add_u32 v2, v3, 2, v2
    buffer_load_dword v184, v2, s[4:7], s17 offen offset:0 sc1
    buffer_load_dword v185, v2, s[4:7], s17 offen offset:128 sc1
    buffer_load_dword v186, v2, s[4:7], s17 offen offset:256 sc1
    buffer_load_dword v187, v2, s[4:7], s17 offen offset:384 sc1
    buffer_load_dword v188, v2, s[4:7], s17 offen offset:512 sc1
    buffer_load_dword v189, v2, s[4:7], s17 offen offset:640 sc1
    buffer_load_dword v190, v2, s[4:7], s17 offen offset:768 sc1
    v_and_b32 v182, 31, v0
    v_lshlrev_b32 v182, 7, v182
    v_pk_fma_f32 v[144:145], v[144:145], v[8:9], v[208:209] op_sel_hi:[1,0,1]
    v_pk_fma_f32 v[146:147], v[146:147], v[8:9], v[210:211] op_sel_hi:[1,0,1]
    v_pk_fma_f32 v[148:149], v[148:149], v[8:9], v[212:213] op_sel_hi:[1,0,1]
    v_pk_fma_f32 v[150:151], v[150:151], v[8:9], v[214:215] op_sel_hi:[1,0,1]
    v_pk_fma_f32 v[152:153], v[152:153], v[8:9], v[216:217] op_sel_hi:[1,0,1]
    v_pk_fma_f32 v[154:155], v[154:155], v[8:9], v[218:219] op_sel_hi:[1,0,1]
    v_pk_fma_f32 v[156:157], v[156:157], v[8:9], v[220:221] op_sel_hi:[1,0,1]
    v_pk_fma_f32 v[158:159], v[158:159], v[8:9], v[222:223] op_sel_hi:[1,0,1]
    s_mov_b64 exec, s[54:55]
    v_mov_b32 v156, v144
    v_mov_b32 v157, v144
    v_mov_b32 v158, v144
    v_mov_b32 v159, v144
    s_mov_b64 exec, -1
    v_max3_f32 v2, v144, v145, v146
    v_max3_f32 v2, v2, v147, v148
    s_add_u32 s68, s14, 0
    s_and_b32 s68, s68, 3
    s_add_u32 s68, s68, 0
    s_mul_i32 s68, s68, 7168
    s_add_u32 s68, s68, s48
    buffer_load_dwordx4 a[0:3], v1, s[4:7], s68 offen offset:0 sc1
    v_max3_f32 v2, v2, v149, v150
    v_max3_f32 v2, v2, v151, v152
    v_max3_f32 v2, v2, v153, v154
    v_max3_f32 v2, v2, v155, v156
    v_max3_f32 v2, v2, v157, v158
    v_max3_f32 v2, v2, v159, v159
    v_min3_f32 v4, v144, v145, v146
    v_min3_f32 v4, v4, v147, v148
    v_min3_f32 v4, v4, v149, v150
    v_min3_f32 v4, v4, v151, v152
    buffer_load_dwordx4 a[4:7], v1, s[4:7], s68 offen offset:1024 sc1
    v_min3_f32 v4, v4, v153, v154
    v_min3_f32 v4, v4, v155, v156
    v_min3_f32 v4, v4, v157, v158
    v_min3_f32 v4, v4, v159, v159
    v_mov_b32 v3, v2
    v_mov_b32 v5, v4
    s_nop 0
    v_permlane32_swap_b32 v2, v3
    v_permlane32_swap_b32 v4, v5
    v_max_f32 v10, v2, v3
    v_min_f32_e64 v11, v4, v5
    buffer_load_dwordx4 a[8:11], v1, s[4:7], s68 offen offset:2048 sc1
    v_pk_add_f32 v[208:209], v[144:145], v[10:11] op_sel_hi:[1,0] neg_lo:[0,1] neg_hi:[0,1]
    v_pk_add_f32 v[224:225], v[144:145], v[10:11] op_sel:[0,1] op_sel_hi:[1,1] neg_lo:[1,0] neg_hi:[1,0]
    v_pk_add_f32 v[210:211], v[146:147], v[10:11] op_sel_hi:[1,0] neg_lo:[0,1] neg_hi:[0,1]
    v_pk_add_f32 v[226:227], v[146:147], v[10:11] op_sel:[0,1] op_sel_hi:[1,1] neg_lo:[1,0] neg_hi:[1,0]
    v_pk_add_f32 v[212:213], v[148:149], v[10:11] op_sel_hi:[1,0] neg_lo:[0,1] neg_hi:[0,1]
    v_pk_add_f32 v[228:229], v[148:149], v[10:11] op_sel:[0,1] op_sel_hi:[1,1] neg_lo:[1,0] neg_hi:[1,0]
    v_pk_add_f32 v[214:215], v[150:151], v[10:11] op_sel_hi:[1,0] neg_lo:[0,1] neg_hi:[0,1]
    v_pk_add_f32 v[230:231], v[150:151], v[10:11] op_sel:[0,1] op_sel_hi:[1,1] neg_lo:[1,0] neg_hi:[1,0]
    v_pk_add_f32 v[216:217], v[152:153], v[10:11] op_sel_hi:[1,0] neg_lo:[0,1] neg_hi:[0,1]
    v_pk_add_f32 v[232:233], v[152:153], v[10:11] op_sel:[0,1] op_sel_hi:[1,1] neg_lo:[1,0] neg_hi:[1,0]
    buffer_load_dwordx4 a[12:15], v1, s[4:7], s68 offen offset:3072 sc1
    v_pk_add_f32 v[218:219], v[154:155], v[10:11] op_sel_hi:[1,0] neg_lo:[0,1] neg_hi:[0,1]
    v_pk_add_f32 v[234:235], v[154:155], v[10:11] op_sel:[0,1] op_sel_hi:[1,1] neg_lo:[1,0] neg_hi:[1,0]
    v_pk_add_f32 v[220:221], v[156:157], v[10:11] op_sel_hi:[1,0] neg_lo:[0,1] neg_hi:[0,1]
    v_pk_add_f32 v[236:237], v[156:157], v[10:11] op_sel:[0,1] op_sel_hi:[1,1] neg_lo:[1,0] neg_hi:[1,0]
    v_pk_add_f32 v[222:223], v[158:159], v[10:11] op_sel_hi:[1,0] neg_lo:[0,1] neg_hi:[0,1]
    v_pk_add_f32 v[238:239], v[158:159], v[10:11] op_sel:[0,1] op_sel_hi:[1,1] neg_lo:[1,0] neg_hi:[1,0]
    v_exp_f32 v208, v208
    v_exp_f32 v224, v224
    v_exp_f32 v209, v209
    v_exp_f32 v225, v225
    s_add_u32 s68, s68, 4096
    buffer_load_dwordx4 a[16:19], v1, s[4:7], s68 offen offset:0 sc1
    v_exp_f32 v210, v210
    v_exp_f32 v226, v226
    v_exp_f32 v211, v211
    v_exp_f32 v227, v227
    v_exp_f32 v212, v212
    v_exp_f32 v228, v228
    v_exp_f32 v213, v213
    v_exp_f32 v229, v229
    v_exp_f32 v214, v214
    v_exp_f32 v230, v230
    buffer_load_dwordx4 a[20:23], v1, s[4:7], s68 offen offset:1024 sc1
    v_exp_f32 v215, v215
    v_exp_f32 v231, v231
    v_exp_f32 v216, v216
    v_exp_f32 v232, v232
    v_exp_f32 v217, v217
    v_exp_f32 v233, v233
    v_exp_f32 v218, v218
    v_exp_f32 v234, v234
    v_exp_f32 v219, v219
    v_exp_f32 v235, v235
    buffer_load_dwordx4 a[24:27], v1, s[4:7], s68 offen offset:2048 sc1
    v_exp_f32 v220, v220
    v_exp_f32 v236, v236
    v_exp_f32 v221, v221
    v_exp_f32 v237, v237
    v_exp_f32 v222, v222
    v_exp_f32 v238, v238
    v_exp_f32 v223, v223
    v_exp_f32 v239, v239
    s_mov_b64 exec, s[54:55]
    v_mov_b32 v220, 0
    v_mov_b32 v236, 0
    v_mov_b32 v221, 0
    v_mov_b32 v237, 0
    v_mov_b32 v222, 0
    v_mov_b32 v238, 0
    v_mov_b32 v223, 0
    v_mov_b32 v239, 0
    s_mov_b64 exec, -1
    v_pk_add_f32 v[2:3], v[208:209], v[210:211]
    v_pk_add_f32 v[4:5], v[224:225], v[226:227]
    s_add_u32 s68, s14, 1
    s_and_b32 s68, s68, 3
    s_add_u32 s68, s68, 0
    s_mul_i32 s68, s68, 7168
    s_add_u32 s68, s68, s48
    buffer_load_dwordx4 a[28:31], v1, s[4:7], s68 offen offset:0 sc1
    v_pk_add_f32 v[2:3], v[2:3], v[212:213]
    v_pk_add_f32 v[4:5], v[4:5], v[228:229]
    v_pk_add_f32 v[2:3], v[2:3], v[214:215]
    v_pk_add_f32 v[4:5], v[4:5], v[230:231]
    v_pk_add_f32 v[2:3], v[2:3], v[216:217]
    v_pk_add_f32 v[4:5], v[4:5], v[232:233]
    v_pk_add_f32 v[2:3], v[2:3], v[218:219]
    v_pk_add_f32 v[4:5], v[4:5], v[234:235]
    v_pk_add_f32 v[2:3], v[2:3], v[220:221]
    v_pk_add_f32 v[4:5], v[4:5], v[236:237]
    buffer_load_dwordx4 a[32:35], v1, s[4:7], s68 offen offset:1024 sc1
    v_pk_add_f32 v[2:3], v[2:3], v[222:223]
    v_pk_add_f32 v[4:5], v[4:5], v[238:239]
    v_add_f32 v2, v2, v3
    v_add_f32 v4, v4, v5
    v_mov_b32 v3, v2
    v_mov_b32 v5, v4
    s_nop 0
    v_permlane32_swap_b32 v2, v3
    v_permlane32_swap_b32 v4, v5
    v_add_f32 v2, v2, v3
    v_add_f32_e64 v4, v4, v5
    buffer_load_dwordx4 a[36:39], v1, s[4:7], s68 offen offset:2048 sc1
    v_rcp_f32 v10, v2
    v_rcp_f32_e64 v11, v4
    s_nop 0
    v_pk_mul_f32 v[208:209], v[208:209], v[10:11] op_sel_hi:[1,0]
    v_pk_mul_f32 v[210:211], v[210:211], v[10:11] op_sel_hi:[1,0]
    v_cvt_pk_bf16_f32 v240, v208, v209
    v_cvt_pk_bf16_f32 v241, v210, v211
    v_pk_mul_f32 v[212:213], v[212:213], v[10:11] op_sel_hi:[1,0]
    v_pk_mul_f32 v[214:215], v[214:215], v[10:11] op_sel_hi:[1,0]
    v_cvt_pk_bf16_f32 v242, v212, v213
    v_cvt_pk_bf16_f32 v243, v214, v215
    v_pk_mul_f32 v[216:217], v[216:217], v[10:11] op_sel_hi:[1,0]
    v_pk_mul_f32 v[218:219], v[218:219], v[10:11] op_sel_hi:[1,0]
    v_cvt_pk_bf16_f32 v244, v216, v217
    v_cvt_pk_bf16_f32 v245, v218, v219
    v_pk_mul_f32 v[220:221], v[220:221], v[10:11] op_sel_hi:[1,0]
    v_pk_mul_f32 v[222:223], v[222:223], v[10:11] op_sel_hi:[1,0]
    v_cvt_pk_bf16_f32 v246, v220, v221
    v_cvt_pk_bf16_f32 v247, v222, v223
    v_pk_mul_f32 v[224:225], v[224:225], v[10:11] op_sel:[0,1] op_sel_hi:[1,1]
    v_pk_mul_f32 v[226:227], v[226:227], v[10:11] op_sel:[0,1] op_sel_hi:[1,1]
    v_cvt_pk_bf16_f32 v248, v224, v225
    v_cvt_pk_bf16_f32 v249, v226, v227
    v_pk_mul_f32 v[228:229], v[228:229], v[10:11] op_sel:[0,1] op_sel_hi:[1,1]
    v_pk_mul_f32 v[230:231], v[230:231], v[10:11] op_sel:[0,1] op_sel_hi:[1,1]
    v_cvt_pk_bf16_f32 v250, v228, v229
    v_cvt_pk_bf16_f32 v251, v230, v231
    v_pk_mul_f32 v[232:233], v[232:233], v[10:11] op_sel:[0,1] op_sel_hi:[1,1]
    v_pk_mul_f32 v[234:235], v[234:235], v[10:11] op_sel:[0,1] op_sel_hi:[1,1]
    v_cvt_pk_bf16_f32 v252, v232, v233
    v_cvt_pk_bf16_f32 v253, v234, v235
    v_pk_mul_f32 v[236:237], v[236:237], v[10:11] op_sel:[0,1] op_sel_hi:[1,1]
    v_pk_mul_f32 v[238:239], v[238:239], v[10:11] op_sel:[0,1] op_sel_hi:[1,1]
    v_cvt_pk_bf16_f32 v254, v236, v237
    v_cvt_pk_bf16_f32 v255, v238, v239
    buffer_load_dword v9, v182, s[4:7], s41 offen sc1
    s_waitcnt vmcnt(11)
    v_add_f32 v2, v184, v185
    v_add_f32 v3, v186, v187
    v_add_f32 v2, v2, v188
    v_add_f32 v3, v3, v189
    v_add_f32 v2, v2, v190
    v_add_f32 v2, v2, v3
    v_mov_b32 v3, v2
    s_min_u32 s18, s14, 2
    s_lshl_b32 s18, s18, 7
    s_add_u32 s18, s18, 147840
    v_and_b32 v4, 31, v0
    v_permlane32_swap_b32 v2, v3
    v_add_f32_e64 v2, v2, v3
    v_mul_f32 v2, 3138537765, v2
    v_lshl_add_u32 v4, v4, 2, s18
    ds_write_b32 v4, v2
    s_add_u32 s17, s50, 110592
    v_add_u32_e64 v12, s17, v1
    v_add_u32 v13, 110592, v1
    v_lshrrev_b32 v194, 5, v0
    s_mul_i32 s17, s13, 7
    v_add_u32 v194, s17, v194
    v_and_b32 v192, 1, v194
    v_lshlrev_b32_e64 v192, 5, v192
    v_and_or_b32 v192, v0, 31, v192
    v_lshlrev_b32 v192, 4, v192
    v_add_u32 v195, 2, v194
    v_bfe_u32 v196, v195, 1, 1
    v_lshrrev_b32_e64 v195, 2, v195
    v_lshl_add_u32 v196, v196, 3, v192
    v_lshl_add_u32 v193, v195, 10, v196
    v_bfe_u32 v196, v194, 1, 1
    v_lshrrev_b32_e64 v194, 2, v194
    v_lshl_add_u32 v196, v196, 3, v192
    v_lshl_add_u32 v192, v194, 10, v196
    v_mov_b32 v196, 0x10000000
    v_cndmask_b32 v194, v193, v196, s[54:55]
    v_accvgpr_write_b32 a112, v192
    v_accvgpr_write_b32 a113, v193
    v_accvgpr_write_b32 a114, v194
    s_waitcnt vmcnt(0)
    v_cmp_ne_u32 vcc, s56, v9
    s_cbranch_vccnz L_kvpwait_8
L_kvpok_7:
    s_xor_b32 s18, s38, 0
    buffer_load_dwordx4 v[32:35], v1, s[4:7], s18 offen sc1
    s_xor_b32 s18, s38, 4096
    buffer_load_dwordx4 v[36:39], v1, s[4:7], s18 offen sc1
    s_xor_b32 s18, s38, 8192
    buffer_load_dwordx4 v[40:43], v1, s[4:7], s18 offen sc1
    s_xor_b32 s18, s38, 12288
    buffer_load_dwordx4 v[44:47], v1, s[4:7], s18 offen sc1
    s_xor_b32 s18, s38, 16384
    buffer_load_dwordx4 v[48:51], v1, s[4:7], s18 offen sc1
    s_xor_b32 s18, s38, 20480
    buffer_load_dwordx4 v[52:55], v1, s[4:7], s18 offen sc1
    s_xor_b32 s18, s38, 24576
    buffer_load_dwordx4 v[56:59], v1, s[4:7], s18 offen sc1
    s_xor_b32 s18, s38, 28672
    buffer_load_dwordx4 v[60:63], v1, s[4:7], s18 offen sc1
    s_xor_b32 s18, s38, 32768
    buffer_load_dwordx4 v[64:67], v1, s[4:7], s18 offen sc1
    s_xor_b32 s18, s38, 36864
    buffer_load_dwordx4 v[68:71], v1, s[4:7], s18 offen sc1
    s_xor_b32 s18, s38, 40960
    buffer_load_dwordx4 v[72:75], v1, s[4:7], s18 offen sc1
    s_xor_b32 s18, s38, 45056
    buffer_load_dwordx4 v[76:79], v1, s[4:7], s18 offen sc1
    s_xor_b32 s18, s38, 49152
    buffer_load_dwordx4 v[80:83], v1, s[4:7], s18 offen sc1
    s_xor_b32 s18, s38, 53248
    buffer_load_dwordx4 v[84:87], v1, s[4:7], s18 offen sc1
    s_xor_b32 s18, s38, 57344
    buffer_load_dwordx4 v[88:91], v1, s[4:7], s18 offen sc1
    s_xor_b32 s18, s38, 61440
    buffer_load_dwordx4 v[92:95], v1, s[4:7], s18 offen sc1
    s_waitcnt vmcnt(15)
    v_lshlrev_b32 v160, 16, v32
    v_and_b32 v161, 0xffff0000, v32
    v_lshlrev_b32_e64 v162, 16, v33
    v_and_b32 v163, 0xffff0000, v33
    v_lshlrev_b32_e64 v164, 16, v34
    v_and_b32 v165, 0xffff0000, v34
    v_lshlrev_b32_e64 v166, 16, v35
    v_and_b32 v167, 0xffff0000, v35
    s_waitcnt vmcnt(14)
    v_lshlrev_b32 v168, 16, v36
    v_and_b32 v169, 0xffff0000, v36
    v_pk_add_f32 v[160:161], v[160:161], v[168:169]
    v_lshlrev_b32_e64 v170, 16, v37
    v_and_b32 v171, 0xffff0000, v37
    v_pk_add_f32 v[162:163], v[162:163], v[170:171]
    buffer_load_dwordx4 a[40:43], v1, s[4:7], s68 offen offset:3072 sc1
    v_lshlrev_b32_e64 v168, 16, v38
    v_and_b32 v169, 0xffff0000, v38
    v_pk_add_f32 v[164:165], v[164:165], v[168:169]
    v_lshlrev_b32_e64 v170, 16, v39
    v_and_b32 v171, 0xffff0000, v39
    v_pk_add_f32 v[166:167], v[166:167], v[170:171]
    s_waitcnt vmcnt(14)
    v_lshlrev_b32 v168, 16, v40
    v_and_b32 v169, 0xffff0000, v40
    v_pk_add_f32 v[160:161], v[160:161], v[168:169]
    v_lshlrev_b32_e64 v170, 16, v41
    v_and_b32 v171, 0xffff0000, v41
    v_pk_add_f32 v[162:163], v[162:163], v[170:171]
    v_lshlrev_b32_e64 v168, 16, v42
    v_and_b32 v169, 0xffff0000, v42
    s_add_u32 s68, s68, 4096
    buffer_load_dwordx4 a[44:47], v1, s[4:7], s68 offen offset:0 sc1
    v_pk_add_f32 v[164:165], v[164:165], v[168:169]
    v_lshlrev_b32_e64 v170, 16, v43
    v_and_b32 v171, 0xffff0000, v43
    v_pk_add_f32 v[166:167], v[166:167], v[170:171]
    s_waitcnt vmcnt(14)
    v_lshlrev_b32 v168, 16, v44
    v_and_b32 v169, 0xffff0000, v44
    v_pk_add_f32 v[160:161], v[160:161], v[168:169]
    v_lshlrev_b32_e64 v170, 16, v45
    v_and_b32 v171, 0xffff0000, v45
    v_pk_add_f32 v[162:163], v[162:163], v[170:171]
    v_lshlrev_b32_e64 v168, 16, v46
    v_and_b32 v169, 0xffff0000, v46
    v_pk_add_f32 v[164:165], v[164:165], v[168:169]
    v_lshlrev_b32_e64 v170, 16, v47
    buffer_load_dwordx4 a[48:51], v1, s[4:7], s68 offen offset:1024 sc1
    v_and_b32 v171, 0xffff0000, v47
    v_pk_add_f32 v[166:167], v[166:167], v[170:171]
    s_waitcnt vmcnt(14)
    v_lshlrev_b32 v168, 16, v48
    v_and_b32 v169, 0xffff0000, v48
    v_pk_add_f32 v[160:161], v[160:161], v[168:169]
    v_lshlrev_b32_e64 v170, 16, v49
    v_and_b32 v171, 0xffff0000, v49
    v_pk_add_f32 v[162:163], v[162:163], v[170:171]
    v_lshlrev_b32_e64 v168, 16, v50
    v_and_b32 v169, 0xffff0000, v50
    v_pk_add_f32 v[164:165], v[164:165], v[168:169]
    v_lshlrev_b32_e64 v170, 16, v51
    v_and_b32 v171, 0xffff0000, v51
    v_pk_add_f32 v[166:167], v[166:167], v[170:171]
    buffer_load_dwordx4 a[52:55], v1, s[4:7], s68 offen offset:2048 sc1
    s_waitcnt vmcnt(14)
    v_lshlrev_b32 v168, 16, v52
    v_and_b32 v169, 0xffff0000, v52
    v_pk_add_f32 v[160:161], v[160:161], v[168:169]
    v_lshlrev_b32_e64 v170, 16, v53
    v_and_b32 v171, 0xffff0000, v53
    v_pk_add_f32 v[162:163], v[162:163], v[170:171]
    v_lshlrev_b32_e64 v168, 16, v54
    v_and_b32 v169, 0xffff0000, v54
    v_pk_add_f32 v[164:165], v[164:165], v[168:169]
    v_lshlrev_b32_e64 v170, 16, v55
    v_and_b32 v171, 0xffff0000, v55
    v_pk_add_f32 v[166:167], v[166:167], v[170:171]
    s_waitcnt vmcnt(13)
    v_lshlrev_b32 v168, 16, v56
    v_and_b32 v169, 0xffff0000, v56
    s_add_u32 s68, s14, 2
    s_and_b32 s68, s68, 3
    s_add_u32 s68, s68, 0
    s_mul_i32 s68, s68, 7168
    s_add_u32 s68, s68, s48
    buffer_load_dwordx4 a[56:59], v1, s[4:7], s68 offen offset:0 sc1
    v_pk_add_f32 v[160:161], v[160:161], v[168:169]
    v_lshlrev_b32_e64 v170, 16, v57
    v_and_b32 v171, 0xffff0000, v57
    v_pk_add_f32 v[162:163], v[162:163], v[170:171]
    v_lshlrev_b32_e64 v168, 16, v58
    v_and_b32 v169, 0xffff0000, v58
    v_pk_add_f32 v[164:165], v[164:165], v[168:169]
    v_lshlrev_b32_e64 v170, 16, v59
    v_and_b32 v171, 0xffff0000, v59
    v_pk_add_f32 v[166:167], v[166:167], v[170:171]
    s_waitcnt vmcnt(13)
    v_lshlrev_b32 v168, 16, v60
    v_and_b32 v169, 0xffff0000, v60
    v_pk_add_f32 v[160:161], v[160:161], v[168:169]
    v_lshlrev_b32_e64 v170, 16, v61
    buffer_load_dwordx4 a[60:63], v1, s[4:7], s68 offen offset:1024 sc1
    v_and_b32 v171, 0xffff0000, v61
    v_pk_add_f32 v[162:163], v[162:163], v[170:171]
    v_lshlrev_b32_e64 v168, 16, v62
    v_and_b32 v169, 0xffff0000, v62
    v_pk_add_f32 v[164:165], v[164:165], v[168:169]
    v_lshlrev_b32_e64 v170, 16, v63
    v_and_b32 v171, 0xffff0000, v63
    v_pk_add_f32 v[166:167], v[166:167], v[170:171]
    s_waitcnt vmcnt(13)
    v_lshlrev_b32 v168, 16, v64
    v_and_b32 v169, 0xffff0000, v64
    v_pk_add_f32 v[160:161], v[160:161], v[168:169]
    v_lshlrev_b32_e64 v170, 16, v65
    v_and_b32 v171, 0xffff0000, v65
    v_pk_add_f32 v[162:163], v[162:163], v[170:171]
    buffer_load_dwordx4 a[64:67], v1, s[4:7], s68 offen offset:2048 sc1
    v_lshlrev_b32_e64 v168, 16, v66
    v_and_b32 v169, 0xffff0000, v66
    v_pk_add_f32 v[164:165], v[164:165], v[168:169]
    v_lshlrev_b32_e64 v170, 16, v67
    v_and_b32 v171, 0xffff0000, v67
    v_pk_add_f32 v[166:167], v[166:167], v[170:171]
    s_waitcnt vmcnt(13)
    v_lshlrev_b32 v168, 16, v68
    v_and_b32 v169, 0xffff0000, v68
    v_pk_add_f32 v[160:161], v[160:161], v[168:169]
    v_lshlrev_b32_e64 v170, 16, v69
    v_and_b32 v171, 0xffff0000, v69
    v_pk_add_f32 v[162:163], v[162:163], v[170:171]
    v_lshlrev_b32_e64 v168, 16, v70
    v_and_b32 v169, 0xffff0000, v70
    buffer_load_dwordx4 a[68:71], v1, s[4:7], s68 offen offset:3072 sc1
    v_pk_add_f32 v[164:165], v[164:165], v[168:169]
    v_lshlrev_b32_e64 v170, 16, v71
    v_and_b32 v171, 0xffff0000, v71
    v_pk_add_f32 v[166:167], v[166:167], v[170:171]
    s_waitcnt vmcnt(13)
    v_lshlrev_b32 v168, 16, v72
    v_and_b32 v169, 0xffff0000, v72
    v_pk_add_f32 v[160:161], v[160:161], v[168:169]
    v_lshlrev_b32_e64 v170, 16, v73
    v_and_b32 v171, 0xffff0000, v73
    v_pk_add_f32 v[162:163], v[162:163], v[170:171]
    v_lshlrev_b32_e64 v168, 16, v74
    v_and_b32 v169, 0xffff0000, v74
    v_pk_add_f32 v[164:165], v[164:165], v[168:169]
    v_lshlrev_b32_e64 v170, 16, v75
    s_add_u32 s68, s68, 4096
    buffer_load_dwordx4 a[72:75], v1, s[4:7], s68 offen offset:0 sc1
    v_and_b32 v171, 0xffff0000, v75
    v_pk_add_f32 v[166:167], v[166:167], v[170:171]
    s_waitcnt vmcnt(13)
    v_lshlrev_b32 v168, 16, v76
    v_and_b32 v169, 0xffff0000, v76
    v_pk_add_f32 v[160:161], v[160:161], v[168:169]
    v_lshlrev_b32_e64 v170, 16, v77
    v_and_b32 v171, 0xffff0000, v77
    v_pk_add_f32 v[162:163], v[162:163], v[170:171]
    v_lshlrev_b32_e64 v168, 16, v78
    v_and_b32 v169, 0xffff0000, v78
    v_pk_add_f32 v[164:165], v[164:165], v[168:169]
    v_lshlrev_b32_e64 v170, 16, v79
    v_and_b32 v171, 0xffff0000, v79
    v_pk_add_f32 v[166:167], v[166:167], v[170:171]
    buffer_load_dwordx4 a[76:79], v1, s[4:7], s68 offen offset:1024 sc1
    s_waitcnt vmcnt(13)
    v_lshlrev_b32 v168, 16, v80
    v_and_b32 v169, 0xffff0000, v80
    v_pk_add_f32 v[160:161], v[160:161], v[168:169]
    v_lshlrev_b32_e64 v170, 16, v81
    v_and_b32 v171, 0xffff0000, v81
    v_pk_add_f32 v[162:163], v[162:163], v[170:171]
    v_lshlrev_b32_e64 v168, 16, v82
    v_and_b32 v169, 0xffff0000, v82
    v_pk_add_f32 v[164:165], v[164:165], v[168:169]
    v_lshlrev_b32_e64 v170, 16, v83
    v_and_b32 v171, 0xffff0000, v83
    v_pk_add_f32 v[166:167], v[166:167], v[170:171]
    s_waitcnt vmcnt(12)
    v_lshlrev_b32 v168, 16, v84
    v_and_b32 v169, 0xffff0000, v84
    buffer_load_dwordx4 a[80:83], v1, s[4:7], s68 offen offset:2048 sc1
    v_pk_add_f32 v[160:161], v[160:161], v[168:169]
    v_lshlrev_b32_e64 v170, 16, v85
    v_and_b32 v171, 0xffff0000, v85
    v_pk_add_f32 v[162:163], v[162:163], v[170:171]
    v_lshlrev_b32_e64 v168, 16, v86
    v_and_b32 v169, 0xffff0000, v86
    v_pk_add_f32 v[164:165], v[164:165], v[168:169]
    v_lshlrev_b32_e64 v170, 16, v87
    v_and_b32 v171, 0xffff0000, v87
    v_pk_add_f32 v[166:167], v[166:167], v[170:171]
    s_waitcnt vmcnt(12)
    v_lshlrev_b32 v168, 16, v88
    v_and_b32 v169, 0xffff0000, v88
    v_pk_add_f32 v[160:161], v[160:161], v[168:169]
    v_lshlrev_b32 v170, 16, v89
    s_add_u32 s68, s14, 3
    s_and_b32 s68, s68, 3
    s_add_u32 s68, s68, 0
    s_mul_i32 s68, s68, 7168
    s_add_u32 s68, s68, s48
    buffer_load_dwordx4 a[84:87], v1, s[4:7], s68 offen offset:0 sc1
    v_and_b32 v171, 0xffff0000, v89
    v_pk_add_f32 v[162:163], v[162:163], v[170:171]
    v_lshlrev_b32 v168, 16, v90
    v_and_b32 v169, 0xffff0000, v90
    v_pk_add_f32 v[164:165], v[164:165], v[168:169]
    v_lshlrev_b32_e64 v170, 16, v91
    v_and_b32 v171, 0xffff0000, v91
    v_pk_add_f32 v[166:167], v[166:167], v[170:171]
    s_waitcnt vmcnt(12)
    v_lshlrev_b32 v168, 16, v92
    v_and_b32 v169, 0xffff0000, v92
    v_pk_add_f32 v[160:161], v[160:161], v[168:169]
    v_lshlrev_b32_e64 v170, 16, v93
    v_and_b32 v171, 0xffff0000, v93
    v_pk_add_f32 v[162:163], v[162:163], v[170:171]
    v_lshlrev_b32_e64 v168, 16, v94
    v_and_b32 v169, 0xffff0000, v94
    v_pk_add_f32 v[164:165], v[164:165], v[168:169]
    v_lshlrev_b32_e64 v170, 16, v95
    v_and_b32 v171, 0xffff0000, v95
    v_pk_add_f32 v[166:167], v[166:167], v[170:171]
    v_cvt_pk_bf16_f32 v208, v160, v161
    v_cvt_pk_bf16_f32 v209, v162, v163
    v_cvt_pk_bf16_f32 v210, v164, v165
    v_cvt_pk_bf16_f32 v211, v166, v167
    ds_write_b128 v12, v[208:211]
    s_waitcnt lgkmcnt(0)
    s_barrier
    ds_read_b128 v[224:227], v13 offset:0
    ds_read_b128 v[228:231], v13 offset:1024
    ds_read_b128 v[232:235], v13 offset:2048
    ds_read_b128 v[236:239], v13 offset:3072
    s_waitcnt lgkmcnt(3)
    v_mfma_f32_32x32x16_bf16 v[144:159], v[224:227], v[240:243], 0
    s_waitcnt lgkmcnt(2)
    v_mfma_f32_32x32x16_bf16 v[144:159], v[228:231], v[244:247], v[144:159]
    s_waitcnt lgkmcnt(1)
    v_mfma_f32_32x32x16_bf16 v[144:159], v[232:235], v[248:251], v[144:159]
    s_waitcnt lgkmcnt(0)
    v_mfma_f32_32x32x16_bf16 v[144:159], v[236:239], v[252:255], v[144:159]
    s_add_u32 s57, s56, 1
    v_mov_b32 v9, s57
    v_and_b32 v13, 3, v0
    v_lshlrev_b32 v13, 2, v13
    s_mul_i32 s19, s14, 7168
    s_add_u32 s19, s19, 114688
    v_add_u32 v12, 114688, v1
    s_nop 4
    v_mov_b32 v2, v156
    v_mov_b32_e64 v3, v156
    s_nop 1
    v_permlane32_swap_b32 v2, v3
    v_add_f32 v3, 897988541, v3
    v_rcp_f32 v10, v3
    s_nop 0
    v_pk_mul_f32 v[144:145], v[144:145], v[10:11] op_sel_hi:[1,0]
    v_pk_mul_f32 v[146:147], v[146:147], v[10:11] op_sel_hi:[1,0]
    v_pk_mul_f32 v[148:149], v[148:149], v[10:11] op_sel_hi:[1,0]
    v_pk_mul_f32 v[150:151], v[150:151], v[10:11] op_sel_hi:[1,0]
    v_pk_mul_f32 v[152:153], v[152:153], v[10:11] op_sel_hi:[1,0]
    v_pk_mul_f32 v[154:155], v[154:155], v[10:11] op_sel_hi:[1,0]
    v_pk_mul_f32 v[156:157], v[156:157], v[10:11] op_sel_hi:[1,0]
    v_pk_mul_f32 v[158:159], v[158:159], v[10:11] op_sel_hi:[1,0]
    v_cvt_pk_bf16_f32 v208, v144, v145
    v_cvt_pk_bf16_f32 v209, v146, v147
    v_cvt_pk_bf16_f32 v210, v148, v149
    v_cvt_pk_bf16_f32 v211, v150, v151
    v_cvt_pk_bf16_f32 v212, v152, v153
    v_cvt_pk_bf16_f32 v213, v154, v155
    v_cvt_pk_bf16_f32 v214, v156, v157
    v_cvt_pk_bf16_f32 v215, v158, v159
    s_cmp_eq_u32 s16, 0
    s_cbranch_scc0 L_slow_9
    buffer_store_dwordx2 v[208:209], v192, s[4:7], s33 offen
    buffer_store_dwordx2 v[210:211], v193, s[4:7], s33 offen
    buffer_store_dwordx2 v[212:213], v192, s[4:7], s33 offen offset:1024
    buffer_store_dwordx2 v[214:215], v194, s[4:7], s33 offen offset:1024
L_join_10:
    s_waitcnt vmcnt(0)
    s_mov_b64 exec, 1
    s_cmp_eq_u32 s16, 0
    s_cbranch_scc0 L_slow_11
    buffer_store_dword v9, off, s[4:7], s44
L_join_12:
    s_mov_b64 exec, -1
    buffer_load_dwordx4 a[88:91], v1, s[4:7], s68 offen offset:1024 sc1
    buffer_load_dwordx4 a[92:95], v1, s[4:7], s68 offen offset:2048 sc1
    buffer_load_dwordx4 a[96:99], v1, s[4:7], s68 offen offset:3072 sc1
    s_add_u32 s68, s68, 4096
    buffer_load_dwordx4 a[100:103], v1, s[4:7], s68 offen offset:0 sc1
    buffer_load_dwordx4 a[104:107], v1, s[4:7], s68 offen offset:1024 sc1
    buffer_load_dwordx4 a[108:111], v1, s[4:7], s68 offen offset:2048 sc1
    s_add_u32 s57, s56, 1
L_poll_13:
    buffer_load_dword v5, v13, s[4:7], s45 offen sc1
    s_waitcnt vmcnt(0)
    v_cmp_ne_u32 vcc, s57, v5
    s_cbranch_vccnz L_retry_14
    s_add_u32 m0, s19, 0
    s_add_u32 s18, s34, 0
    buffer_load_dwordx4 v1, s[4:7], s18 offen offset:0 sc1 lds
    buffer_load_dwordx4 v1, s[4:7], s18 offen offset:1024 sc1 lds
    buffer_load_dwordx4 v1, s[4:7], s18 offen offset:2048 sc1 lds
    buffer_load_dwordx4 v1, s[4:7], s18 offen offset:3072 sc1 lds
    s_add_u32 m0, s19, 4096
    s_add_u32 s18, s34, 4096
    buffer_load_dwordx4 v1, s[4:7], s18 offen offset:0 sc1 lds
    buffer_load_dwordx4 v1, s[4:7], s18 offen offset:1024 sc1 lds
    buffer_load_dwordx4 v1, s[4:7], s18 offen offset:2048 sc1 lds
    s_add_u32 s17, s14, 0
    s_and_b32 s17, s17, 3
    s_add_u32 s17, s17, 0
    s_mul_i32 s17, s17, 7168
    v_add_u32 v192, s17, v12
    s_add_u32 s17, s14, 1
    s_and_b32 s17, s17, 3
    s_add_u32 s17, s17, 0
    s_mul_i32 s17, s17, 7168
    v_add_u32 v193, s17, v12
    s_add_u32 s17, s14, 2
    s_and_b32 s17, s17, 3
    s_add_u32 s17, s17, 0
    s_mul_i32 s17, s17, 7168
    v_add_u32 v194, s17, v12
    s_add_u32 s17, s14, 3
    s_and_b32 s17, s17, 3
    s_add_u32 s17, s17, 0
    s_mul_i32 s17, s17, 7168
    v_add_u32 v195, s17, v12
    s_cmp_ge_u32 s36, 14
    s_cbranch_scc1 L_woskip_15
    s_waitcnt vmcnt(6)
    ds_read_b128 v[176:179], v192 offset:0
    s_waitcnt vmcnt(5)
    ds_read_b128 v[180:183], v192 offset:1024
    s_waitcnt vmcnt(4)
    ds_read_b128 v[184:187], v192 offset:2048
    s_waitcnt lgkmcnt(2)
    v_mfma_f32_32x32x16_bf16 v[16:31], a[0:3], v[176:179], v[16:31]
    s_waitcnt vmcnt(3)
    ds_read_b128 v[188:191], v192 offset:3072
    s_waitcnt lgkmcnt(2)
    v_mfma_f32_32x32x16_bf16 v[16:31], a[4:7], v[180:183], v[16:31]
    s_waitcnt vmcnt(2)
    ds_read_b128 v[176:179], v192 offset:4096
    s_waitcnt lgkmcnt(2)
    v_mfma_f32_32x32x16_bf16 v[16:31], a[8:11], v[184:187], v[16:31]
    s_waitcnt vmcnt(1)
    ds_read_b128 v[180:183], v192 offset:5120
    s_waitcnt lgkmcnt(2)
    v_mfma_f32_32x32x16_bf16 v[16:31], a[12:15], v[188:191], v[16:31]
    s_waitcnt vmcnt(0)
    ds_read_b128 v[184:187], v192 offset:6144
    s_waitcnt lgkmcnt(2)
    v_mfma_f32_32x32x16_bf16 v[16:31], a[16:19], v[176:179], v[16:31]
    s_barrier
    ds_read_b128 v[188:191], v193 offset:0
    s_waitcnt lgkmcnt(2)
    v_mfma_f32_32x32x16_bf16 v[16:31], a[20:23], v[180:183], v[16:31]
    ds_read_b128 v[176:179], v193 offset:1024
    s_waitcnt lgkmcnt(2)
    v_mfma_f32_32x32x16_bf16 v[16:31], a[24:27], v[184:187], v[16:31]
    s_add_u32 m0, s50, 57344
    s_add_u32 s67, s32, 50176
    buffer_load_dwordx4 v15, s[4:7], s67 offen sc1 lds
    ds_read_b128 v[180:183], v193 offset:2048
    s_waitcnt lgkmcnt(2)
    v_mfma_f32_32x32x16_bf16 v[16:31], a[28:31], v[188:191], v[16:31]
    ds_read_b128 v[184:187], v193 offset:3072
    s_waitcnt lgkmcnt(2)
    v_mfma_f32_32x32x16_bf16 v[16:31], a[32:35], v[176:179], v[16:31]
    s_add_u32 m0, s50, 61440
    s_add_u32 s67, s32, 53760
    buffer_load_dwordx4 v15, s[4:7], s67 offen sc1 lds
    ds_read_b128 v[188:191], v193 offset:4096
    s_waitcnt lgkmcnt(2)
    v_mfma_f32_32x32x16_bf16 v[16:31], a[36:39], v[180:183], v[16:31]
    ds_read_b128 v[176:179], v193 offset:5120
    s_waitcnt lgkmcnt(2)
    v_mfma_f32_32x32x16_bf16 v[16:31], a[40:43], v[184:187], v[16:31]
    s_add_u32 m0, s50, 65536
    s_add_u32 s67, s32, 57344
    buffer_load_dwordx4 v15, s[4:7], s67 offen sc1 lds
    ds_read_b128 v[180:183], v193 offset:6144
    s_waitcnt lgkmcnt(2)
    v_mfma_f32_32x32x16_bf16 v[16:31], a[44:47], v[188:191], v[16:31]
    ds_read_b128 v[184:187], v194 offset:0
    s_waitcnt lgkmcnt(2)
    v_mfma_f32_32x32x16_bf16 v[16:31], a[48:51], v[176:179], v[16:31]
    s_add_u32 m0, s50, 69632
    s_add_u32 s67, s32, 60928
    buffer_load_dwordx4 v15, s[4:7], s67 offen sc1 lds
    ds_read_b128 v[188:191], v194 offset:1024
    s_waitcnt lgkmcnt(2)
    v_mfma_f32_32x32x16_bf16 v[16:31], a[52:55], v[180:183], v[16:31]
    ds_read_b128 v[176:179], v194 offset:2048
    s_waitcnt lgkmcnt(2)
    v_mfma_f32_32x32x16_bf16 v[16:31], a[56:59], v[184:187], v[16:31]
    s_add_u32 m0, s50, 73728
    s_add_u32 s67, s32, 64512
    buffer_load_dwordx4 v15, s[4:7], s67 offen sc1 lds
    ds_read_b128 v[180:183], v194 offset:3072
    s_waitcnt lgkmcnt(2)
    v_mfma_f32_32x32x16_bf16 v[16:31], a[60:63], v[188:191], v[16:31]
    ds_read_b128 v[184:187], v194 offset:4096
    s_waitcnt lgkmcnt(2)
    v_mfma_f32_32x32x16_bf16 v[16:31], a[64:67], v[176:179], v[16:31]
    s_add_u32 m0, s50, 77824
    s_add_u32 s67, s32, 68096
    buffer_load_dwordx4 v15, s[4:7], s67 offen sc1 lds
    ds_read_b128 v[188:191], v194 offset:5120
    s_waitcnt lgkmcnt(2)
    v_mfma_f32_32x32x16_bf16 v[16:31], a[68:71], v[180:183], v[16:31]
    ds_read_b128 v[176:179], v194 offset:6144
    s_waitcnt lgkmcnt(2)
    v_mfma_f32_32x32x16_bf16 v[16:31], a[72:75], v[184:187], v[16:31]
    s_add_u32 m0, s50, 81920
    s_add_u32 s67, s32, 71680
    buffer_load_dwordx4 v15, s[4:7], s67 offen sc1 lds
    ds_read_b128 v[180:183], v195 offset:0
    s_waitcnt lgkmcnt(2)
    v_mfma_f32_32x32x16_bf16 v[16:31], a[76:79], v[188:191], v[16:31]
    ds_read_b128 v[184:187], v195 offset:1024
    s_waitcnt lgkmcnt(2)
    v_mfma_f32_32x32x16_bf16 v[16:31], a[80:83], v[176:179], v[16:31]
    ds_read_b128 v[188:191], v195 offset:2048
    s_waitcnt lgkmcnt(2)
    v_mfma_f32_32x32x16_bf16 v[16:31], a[84:87], v[180:183], v[16:31]
    ds_read_b128 v[176:179], v195 offset:3072
    s_waitcnt lgkmcnt(2)
    v_mfma_f32_32x32x16_bf16 v[16:31], a[88:91], v[184:187], v[16:31]
    ds_read_b128 v[180:183], v195 offset:4096
    s_waitcnt lgkmcnt(2)
    v_mfma_f32_32x32x16_bf16 v[16:31], a[92:95], v[188:191], v[16:31]
    ds_read_b128 v[184:187], v195 offset:5120
    s_waitcnt lgkmcnt(2)
    v_mfma_f32_32x32x16_bf16 v[16:31], a[96:99], v[176:179], v[16:31]
    ds_read_b128 v[188:191], v195 offset:6144
    s_waitcnt lgkmcnt(2)
    v_mfma_f32_32x32x16_bf16 v[16:31], a[100:103], v[180:183], v[16:31]
    s_waitcnt lgkmcnt(1)
    v_mfma_f32_32x32x16_bf16 v[16:31], a[104:107], v[184:187], v[16:31]
    s_waitcnt lgkmcnt(0)
    v_mfma_f32_32x32x16_bf16 v[16:31], a[108:111], v[188:191], v[16:31]
    v_and_b32 v13, 31, v0
    v_lshlrev_b32 v13, 4, v13
    s_nop 9
    v_cvt_pk_bf16_f32 v208, v16, v17
    v_cvt_pk_bf16_f32 v209, v18, v19
    v_cvt_pk_bf16_f32 v210, v20, v21
    v_cvt_pk_bf16_f32 v211, v22, v23
    v_cvt_pk_bf16_f32 v212, v24, v25
    v_cvt_pk_bf16_f32 v213, v26, v27
    v_cvt_pk_bf16_f32 v214, v28, v29
    v_cvt_pk_bf16_f32 v215, v30, v31
    s_cmp_eq_u32 s16, 0
    s_cbranch_scc0 L_slow_17
    buffer_store_dwordx4 v[208:211], v1, s[4:7], s35 offen
    buffer_store_dwordx4 v[212:215], v1, s[4:7], s35 offen offset:1024
L_join_18:
    v_pk_mul_f32 v[4:5], v[16:17], v[16:17]
    v_pk_add_f32 v[2:3], v[16:17], v[18:19]
    v_pk_fma_f32 v[4:5], v[18:19], v[18:19], v[4:5]
    v_pk_fma_f32 v[4:5], v[20:21], v[20:21], v[4:5]
    v_pk_add_f32 v[2:3], v[2:3], v[20:21]
    v_pk_fma_f32 v[4:5], v[22:23], v[22:23], v[4:5]
    v_pk_add_f32 v[2:3], v[2:3], v[22:23]
    v_pk_fma_f32 v[4:5], v[24:25], v[24:25], v[4:5]
    v_pk_add_f32 v[2:3], v[2:3], v[24:25]
    v_pk_fma_f32 v[4:5], v[26:27], v[26:27], v[4:5]
    v_pk_add_f32 v[2:3], v[2:3], v[26:27]
    v_pk_fma_f32 v[4:5], v[28:29], v[28:29], v[4:5]
    v_pk_add_f32 v[2:3], v[2:3], v[28:29]
    v_pk_fma_f32 v[4:5], v[30:31], v[30:31], v[4:5]
    v_pk_add_f32 v[2:3], v[2:3], v[30:31]
    v_add_f32 v2, v2, v3
    v_add_f32 v3, v4, v5
    v_mov_b32 v4, v2
    v_mov_b32_e64 v5, v3
    s_nop 0
    v_permlane32_swap_b32 v2, v4
    v_permlane32_swap_b32 v3, v5
    v_pk_add_f32 v[4:5], v[4:5], v[2:3]
    s_cmp_eq_u32 s16, 0
    s_cbranch_scc0 L_slow_19
    buffer_store_dwordx2 v[4:5], v13, s[4:7], s58 offen
L_join_20:
    s_add_u32 s57, s56, 1
    v_mov_b32 v9, s57
    s_waitcnt vmcnt(0)
    s_mov_b64 exec, 1
    s_cmp_eq_u32 s16, 0
    s_cbranch_scc0 L_slow_21
    buffer_store_dword v9, off, s[4:7], s46
L_join_22:
    s_mov_b64 exec, -1
L_wojoin_16:
    v_and_b32 v2, 15, v0
    v_min_u32 v2, 13, v2
    v_lshlrev_b32 v2, 2, v2
    s_barrier
    s_add_u32 s57, s56, 1
L_poll_23:
    buffer_load_dword v5, v2, s[4:7], s47 offen sc1
    s_waitcnt vmcnt(0)
    v_cmp_ne_u32 vcc, s57, v5
    s_cbranch_vccnz L_retry_24
    s_add_u32 s66, s30, 0
    buffer_load_dwordx4 v[32:35], v1, s[4:7], s66 offen offset:0 sc1
    buffer_load_dwordx4 v[36:39], v1, s[4:7], s66 offen offset:1024 sc1
    buffer_load_dwordx4 v[40:43], v1, s[4:7], s66 offen offset:2048 sc1
    buffer_load_dwordx4 v[44:47], v1, s[4:7], s66 offen offset:3072 sc1
    s_add_u32 s66, s30, 4096
    buffer_load_dwordx4 v[48:51], v1, s[4:7], s66 offen offset:0 sc1
    buffer_load_dwordx4 v[52:55], v1, s[4:7], s66 offen offset:1024 sc1
    buffer_load_dwordx4 v[56:59], v1, s[4:7], s66 offen offset:2048 sc1
    buffer_load_dwordx4 v[60:63], v1, s[4:7], s66 offen offset:3072 sc1
    v_and_b32 v2, 31, v0
    v_lshrrev_b32_e64 v3, 5, v0
    s_lshl_b32 s17, s14, 11
    s_add_u32 s17, s17, 139264
    v_bfe_u32 v5, v0, 1, 3
    v_xor_b32 v5, v5, v3
    v_lshlrev_b32 v5, 3, v5
    v_lshl_add_u32 v5, v2, 6, v5
    v_add_u32_e64 v248, s17, v5
    v_bfe_u32 v2, v0, 2, 2
    v_lshl_add_u32 v4, v3, 3, v2
    v_bfe_u32 v5, v0, 3, 1
    v_lshl_or_b32 v5, v3, 2, v5
    v_and_b32_e64 v12, 3, v0
    v_bfe_u32 v2, v0, 4, 1
    v_lshl_or_b32 v12, v2, 2, v12
    v_xor_b32 v5, v5, v12
    v_lshlrev_b32 v5, 3, v5
    v_lshl_add_u32 v5, v4, 6, v5
    v_add_u32 v249, s17, v5
    v_xor_b32 v250, 16, v249
    v_add_u32 v250, 256, v250
    ds_read_b128 v[176:179], v1 offset:0
    ds_read_b128 v[180:183], v1 offset:28672
    ds_read_b128 v[184:187], v1 offset:1024
    ds_read_b128 v[188:191], v1 offset:29696
    v_lshrrev_b32 v3, 5, v0
    v_and_b32 v4, 31, v0
    v_lshlrev_b32_e64 v4, 4, v4
    v_mul_u32_u24 v14, 1536, v3
    v_add_u32_e64 v14, v14, v4
    v_lshl_add_u32 v4, v3, 3, v4
    s_waitcnt vmcnt(7) lgkmcnt(2)
    v_mfma_f32_32x32x16_bf16 v[144:159], v[176:179], v[32:35], 0
    s_add_u32 s66, s30, 8192
    buffer_load_dwordx4 v[64:67], v1, s[4:7], s66 offen offset:0 sc1
    ds_read_b128 v[192:195], v1 offset:2048
    v_mfma_f32_32x32x16_bf16 v[160:175], v[180:183], v[32:35], 0
    ds_read_b128 v[196:199], v1 offset:30720
    s_waitcnt vmcnt(7) lgkmcnt(2)
    v_mfma_f32_32x32x16_bf16 v[144:159], v[184:187], v[36:39], v[144:159]
    buffer_load_dwordx4 v[68:71], v1, s[4:7], s66 offen offset:1024 sc1
    ds_read_b128 v[176:179], v1 offset:3072
    v_mfma_f32_32x32x16_bf16 v[160:175], v[188:191], v[36:39], v[160:175]
    ds_read_b128 v[180:183], v1 offset:31744
    s_waitcnt vmcnt(7) lgkmcnt(2)
    v_mfma_f32_32x32x16_bf16 v[144:159], v[192:195], v[40:43], v[144:159]
    buffer_load_dwordx4 v[72:75], v1, s[4:7], s66 offen offset:2048 sc1
    ds_read_b128 v[184:187], v1 offset:4096
    v_mfma_f32_32x32x16_bf16 v[160:175], v[196:199], v[40:43], v[160:175]
    ds_read_b128 v[188:191], v1 offset:32768
    s_waitcnt vmcnt(7) lgkmcnt(2)
    v_mfma_f32_32x32x16_bf16 v[144:159], v[176:179], v[44:47], v[144:159]
    buffer_load_dwordx4 v[76:79], v1, s[4:7], s66 offen offset:3072 sc1
    ds_read_b128 v[192:195], v1 offset:5120
    v_mfma_f32_32x32x16_bf16 v[160:175], v[180:183], v[44:47], v[160:175]
    ds_read_b128 v[196:199], v1 offset:33792
    s_waitcnt vmcnt(7) lgkmcnt(2)
    v_mfma_f32_32x32x16_bf16 v[144:159], v[184:187], v[48:51], v[144:159]
    s_add_u32 s66, s30, 12288
    buffer_load_dwordx4 v[80:83], v1, s[4:7], s66 offen offset:0 sc1
    ds_read_b128 v[176:179], v1 offset:6144
    v_mfma_f32_32x32x16_bf16 v[160:175], v[188:191], v[48:51], v[160:175]
    ds_read_b128 v[180:183], v1 offset:34816
    s_waitcnt vmcnt(7) lgkmcnt(2)
    v_mfma_f32_32x32x16_bf16 v[144:159], v[192:195], v[52:55], v[144:159]
    buffer_load_dwordx4 v[84:87], v1, s[4:7], s66 offen offset:1024 sc1
    ds_read_b128 v[184:187], v1 offset:7168
    v_mfma_f32_32x32x16_bf16 v[160:175], v[196:199], v[52:55], v[160:175]
    ds_read_b128 v[188:191], v1 offset:35840
    s_waitcnt vmcnt(7) lgkmcnt(2)
    v_mfma_f32_32x32x16_bf16 v[144:159], v[176:179], v[56:59], v[144:159]
    buffer_load_dwordx4 v[88:91], v1, s[4:7], s66 offen offset:2048 sc1
    ds_read_b128 v[192:195], v1 offset:8192
    v_mfma_f32_32x32x16_bf16 v[160:175], v[180:183], v[56:59], v[160:175]
    ds_read_b128 v[196:199], v1 offset:36864
    s_waitcnt vmcnt(7) lgkmcnt(2)
    v_mfma_f32_32x32x16_bf16 v[144:159], v[184:187], v[60:63], v[144:159]
    buffer_load_dwordx4 v[92:95], v1, s[4:7], s66 offen offset:3072 sc1
    ds_read_b128 v[176:179], v1 offset:9216
    v_mfma_f32_32x32x16_bf16 v[160:175], v[188:191], v[60:63], v[160:175]
    ds_read_b128 v[180:183], v1 offset:37888
    s_waitcnt vmcnt(7) lgkmcnt(2)
    v_mfma_f32_32x32x16_bf16 v[144:159], v[192:195], v[64:67], v[144:159]
    s_add_u32 s66, s30, 16384
    buffer_load_dwordx4 v[96:99], v1, s[4:7], s66 offen offset:0 sc1
    ds_read_b128 v[184:187], v1 offset:10240
    v_mfma_f32_32x32x16_bf16 v[160:175], v[196:199], v[64:67], v[160:175]
    ds_read_b128 v[188:191], v1 offset:38912
    s_waitcnt vmcnt(7) lgkmcnt(2)
    v_mfma_f32_32x32x16_bf16 v[144:159], v[176:179], v[68:71], v[144:159]
    buffer_load_dwordx4 v[100:103], v1, s[4:7], s66 offen offset:1024 sc1
    ds_read_b128 v[192:195], v1 offset:11264
    v_mfma_f32_32x32x16_bf16 v[160:175], v[180:183], v[68:71], v[160:175]
    ds_read_b128 v[196:199], v1 offset:39936
    s_waitcnt vmcnt(7) lgkmcnt(2)
    v_mfma_f32_32x32x16_bf16 v[144:159], v[184:187], v[72:75], v[144:159]
    buffer_load_dwordx4 v[104:107], v1, s[4:7], s66 offen offset:2048 sc1
    ds_read_b128 v[176:179], v1 offset:12288
    v_lshrrev_b32 v13, 5, v0
    v_lshlrev_b32_e64 v13, 4, v13
    v_add_u32 v13, 147456, v13
    ds_read_b128 v[208:211], v13 offset:384
    v_mfma_f32_32x32x16_bf16 v[160:175], v[188:191], v[72:75], v[160:175]
    ds_read_b128 v[180:183], v1 offset:40960
    s_waitcnt vmcnt(7) lgkmcnt(3)
    v_mfma_f32_32x32x16_bf16 v[144:159], v[192:195], v[76:79], v[144:159]
    buffer_load_dwordx4 v[108:111], v1, s[4:7], s66 offen offset:3072 sc1
    ds_read_b128 v[184:187], v1 offset:13312
    ds_read_b128 v[212:215], v13 offset:416
    v_mfma_f32_32x32x16_bf16 v[160:175], v[196:199], v[76:79], v[160:175]
    ds_read_b128 v[188:191], v1 offset:41984
    s_waitcnt vmcnt(7) lgkmcnt(3)
    v_mfma_f32_32x32x16_bf16 v[144:159], v[176:179], v[80:83], v[144:159]
    s_add_u32 s66, s30, 20480
    buffer_load_dwordx4 v[112:115], v1, s[4:7], s66 offen offset:0 sc1
    ds_read_b128 v[192:195], v1 offset:14336
    ds_read_b128 v[216:219], v13 offset:448
    v_mfma_f32_32x32x16_bf16 v[160:175], v[180:183], v[80:83], v[160:175]
    ds_read_b128 v[196:199], v1 offset:43008
    s_waitcnt vmcnt(7) lgkmcnt(3)
    v_mfma_f32_32x32x16_bf16 v[144:159], v[184:187], v[84:87], v[144:159]
    buffer_load_dwordx4 v[116:119], v1, s[4:7], s66 offen offset:1024 sc1
    ds_read_b128 v[176:179], v1 offset:15360
    ds_read_b128 v[220:223], v13 offset:480
    v_mfma_f32_32x32x16_bf16 v[160:175], v[188:191], v[84:87], v[160:175]
    ds_read_b128 v[180:183], v1 offset:44032
    s_waitcnt vmcnt(7) lgkmcnt(3)
    v_mfma_f32_32x32x16_bf16 v[144:159], v[192:195], v[88:91], v[144:159]
    buffer_load_dwordx4 v[120:123], v1, s[4:7], s66 offen offset:2048 sc1
    ds_read_b128 v[184:187], v1 offset:16384
    v_lshrrev_b32 v13, 5, v0
    v_lshlrev_b32 v13, 4, v13
    v_add_u32 v13, 147456, v13
    ds_read_b128 v[224:227], v13 offset:512
    v_mfma_f32_32x32x16_bf16 v[160:175], v[196:199], v[88:91], v[160:175]
    ds_read_b128 v[188:191], v1 offset:45056
    s_waitcnt vmcnt(7) lgkmcnt(3)
    v_mfma_f32_32x32x16_bf16 v[144:159], v[176:179], v[92:95], v[144:159]
    buffer_load_dwordx4 v[124:127], v1, s[4:7], s66 offen offset:3072 sc1
    ds_read_b128 v[192:195], v1 offset:17408
    ds_read_b128 v[228:231], v13 offset:544
    v_mfma_f32_32x32x16_bf16 v[160:175], v[180:183], v[92:95], v[160:175]
    ds_read_b128 v[196:199], v1 offset:46080
    s_waitcnt vmcnt(7) lgkmcnt(3)
    v_mfma_f32_32x32x16_bf16 v[144:159], v[184:187], v[96:99], v[144:159]
    s_add_u32 s66, s30, 24576
    buffer_load_dwordx4 v[128:131], v1, s[4:7], s66 offen offset:0 sc1
    ds_read_b128 v[176:179], v1 offset:18432
    ds_read_b128 v[232:235], v13 offset:576
    v_mfma_f32_32x32x16_bf16 v[160:175], v[188:191], v[96:99], v[160:175]
    ds_read_b128 v[180:183], v1 offset:47104
    s_waitcnt vmcnt(7) lgkmcnt(3)
    v_mfma_f32_32x32x16_bf16 v[144:159], v[192:195], v[100:103], v[144:159]
    buffer_load_dwordx4 v[132:135], v1, s[4:7], s66 offen offset:1024 sc1
    ds_read_b128 v[184:187], v1 offset:19456
    ds_read_b128 v[236:239], v13 offset:608
    v_mfma_f32_32x32x16_bf16 v[160:175], v[196:199], v[100:103], v[160:175]
    ds_read_b128 v[188:191], v1 offset:48128
    s_waitcnt vmcnt(7) lgkmcnt(3)
    v_mfma_f32_32x32x16_bf16 v[144:159], v[176:179], v[104:107], v[144:159]
    buffer_load_dwordx4 v[136:139], v1, s[4:7], s66 offen offset:2048 sc1
    ds_read_b128 v[192:195], v1 offset:20480
    v_mfma_f32_32x32x16_bf16 v[160:175], v[180:183], v[104:107], v[160:175]
    ds_read_b128 v[196:199], v1 offset:49152
    s_waitcnt vmcnt(7) lgkmcnt(2)
    v_mfma_f32_32x32x16_bf16 v[144:159], v[184:187], v[108:111], v[144:159]
    buffer_load_dwordx4 v[140:143], v1, s[4:7], s66 offen offset:3072 sc1
    ds_read_b128 v[176:179], v1 offset:21504
    v_mfma_f32_32x32x16_bf16 v[160:175], v[188:191], v[108:111], v[160:175]
    ds_read_b128 v[180:183], v1 offset:50176
    s_waitcnt vmcnt(7) lgkmcnt(2)
    v_mfma_f32_32x32x16_bf16 v[144:159], v[192:195], v[112:115], v[144:159]
    buffer_load_dwordx4 v[200:203], v14, s[4:7], s59 offen offset:0 sc1
    ds_read_b128 v[184:187], v1 offset:22528
    v_mfma_f32_32x32x16_bf16 v[160:175], v[196:199], v[112:115], v[160:175]
    ds_read_b128 v[188:191], v1 offset:51200
    buffer_load_dwordx4 v[240:243], v14, s[4:7], s59 offen offset:512 sc1
    s_waitcnt vmcnt(8) lgkmcnt(2)
    v_mfma_f32_32x32x16_bf16 v[144:159], v[176:179], v[116:119], v[144:159]
    buffer_load_dwordx4 v[244:247], v14, s[4:7], s59 offen offset:1024 sc1
    ds_read_b128 v[192:195], v1 offset:23552
    v_mfma_f32_32x32x16_bf16 v[160:175], v[180:183], v[116:119], v[160:175]
    ds_read_b128 v[196:199], v1 offset:52224
    buffer_load_dwordx2 v[204:205], v4, s[4:7], s59 offen offset:3072 sc1
    s_waitcnt vmcnt(9) lgkmcnt(2)
    v_mfma_f32_32x32x16_bf16 v[144:159], v[184:187], v[120:123], v[144:159]
    ds_read_b128 v[176:179], v1 offset:24576
    v_mfma_f32_32x32x16_bf16 v[160:175], v[188:191], v[120:123], v[160:175]
    ds_read_b128 v[180:183], v1 offset:53248
    s_waitcnt vmcnt(8) lgkmcnt(2)
    v_mfma_f32_32x32x16_bf16 v[144:159], v[192:195], v[124:127], v[144:159]
    ds_read_b128 v[184:187], v1 offset:25600
    v_mfma_f32_32x32x16_bf16 v[160:175], v[196:199], v[124:127], v[160:175]
    ds_read_b128 v[188:191], v1 offset:54272
    s_waitcnt vmcnt(7) lgkmcnt(2)
    v_mfma_f32_32x32x16_bf16 v[144:159], v[176:179], v[128:131], v[144:159]
    ds_read_b128 v[192:195], v1 offset:26624
    v_mfma_f32_32x32x16_bf16 v[160:175], v[180:183], v[128:131], v[160:175]
    ds_read_b128 v[196:199], v1 offset:55296
    s_waitcnt vmcnt(6) lgkmcnt(2)
    v_mfma_f32_32x32x16_bf16 v[144:159], v[184:187], v[132:135], v[144:159]
    ds_read_b128 v[176:179], v1 offset:27648
    v_mfma_f32_32x32x16_bf16 v[160:175], v[188:191], v[132:135], v[160:175]
    ds_read_b128 v[180:183], v1 offset:56320
    s_waitcnt vmcnt(5) lgkmcnt(2)
    v_mfma_f32_32x32x16_bf16 v[144:159], v[192:195], v[136:139], v[144:159]
    v_mfma_f32_32x32x16_bf16 v[160:175], v[196:199], v[136:139], v[160:175]
    s_waitcnt vmcnt(4) lgkmcnt(0)
    v_mfma_f32_32x32x16_bf16 v[144:159], v[176:179], v[140:143], v[144:159]
    v_mfma_f32_32x32x16_bf16 v[160:175], v[180:183], v[140:143], v[160:175]
    s_waitcnt vmcnt(0)
    v_pk_add_f32 v[200:201], v[200:201], v[240:241]
    v_pk_add_f32 v[202:203], v[202:203], v[242:243]
    v_pk_add_f32 v[244:245], v[244:245], v[204:205]
    v_pk_add_f32 v[200:201], v[200:201], v[246:247]
    v_pk_add_f32 v[244:245], v[244:245], v[202:203]
    v_pk_add_f32 v[200:201], v[200:201], v[244:245]
    v_mov_b32 v206, v200
    v_mov_b32_e64 v207, v201
    s_nop 0
    v_permlane32_swap_b32 v200, v206
    v_permlane32_swap_b32 v201, v207
    v_pk_add_f32 v[206:207], v[206:207], v[200:201]
    v_mul_f32 v5, 991054117, v206
    v_mul_f32 v2, 991054117, v207
    v_fma_f32 v2, -v5, v5, v2
    v_max_f32_e64 v2, 0, v2
    v_add_f32 v2, 925353388, v2
    v_rsq_f32 v8, v2
    s_nop 0
    v_mul_f32_e64 v206, v206, v8
    v_pk_mul_f32 v[224:225], v[224:225], v[206:207] op_sel_hi:[1,0]
    v_pk_mul_f32 v[226:227], v[226:227], v[206:207] op_sel_hi:[1,0]
    v_pk_mul_f32 v[228:229], v[228:229], v[206:207] op_sel_hi:[1,0]
    v_pk_mul_f32 v[230:231], v[230:231], v[206:207] op_sel_hi:[1,0]
    v_pk_mul_f32 v[232:233], v[232:233], v[206:207] op_sel_hi:[1,0]
    v_pk_mul_f32 v[234:235], v[234:235], v[206:207] op_sel_hi:[1,0]
    v_pk_mul_f32 v[236:237], v[236:237], v[206:207] op_sel_hi:[1,0]
    v_pk_mul_f32 v[238:239], v[238:239], v[206:207] op_sel_hi:[1,0]
    v_pk_mul_f32 v[208:209], v[208:209], v[206:207] op_sel_hi:[1,0]
    v_pk_mul_f32 v[210:211], v[210:211], v[206:207] op_sel_hi:[1,0]
    v_pk_mul_f32 v[212:213], v[212:213], v[206:207] op_sel_hi:[1,0]
    v_pk_mul_f32 v[214:215], v[214:215], v[206:207] op_sel_hi:[1,0]
    v_pk_mul_f32 v[216:217], v[216:217], v[206:207] op_sel_hi:[1,0]
    v_pk_mul_f32 v[218:219], v[218:219], v[206:207] op_sel_hi:[1,0]
    v_pk_mul_f32 v[220:221], v[220:221], v[206:207] op_sel_hi:[1,0]
    v_pk_mul_f32 v[222:223], v[222:223], v[206:207] op_sel_hi:[1,0]
    v_pk_fma_f32 v[160:161], v[160:161], v[8:9], v[224:225] op_sel_hi:[1,0,1]
    v_pk_fma_f32 v[162:163], v[162:163], v[8:9], v[226:227] op_sel_hi:[1,0,1]
    v_pk_fma_f32 v[164:165], v[164:165], v[8:9], v[228:229] op_sel_hi:[1,0,1]
    v_pk_fma_f32 v[166:167], v[166:167], v[8:9], v[230:231] op_sel_hi:[1,0,1]
    v_pk_fma_f32 v[168:169], v[168:169], v[8:9], v[232:233] op_sel_hi:[1,0,1]
    v_pk_fma_f32 v[170:171], v[170:171], v[8:9], v[234:235] op_sel_hi:[1,0,1]
    v_pk_fma_f32 v[172:173], v[172:173], v[8:9], v[236:237] op_sel_hi:[1,0,1]
    v_pk_fma_f32 v[174:175], v[174:175], v[8:9], v[238:239] op_sel_hi:[1,0,1]
    s_mov_b64 exec, s[54:55]
    v_mov_b32_e64 v172, 1.0
    s_mov_b64 exec, -1
    v_cvt_pk_bf16_f32 v176, v160, v161
    v_cvt_pk_bf16_f32 v177, v162, v163
    v_cvt_pk_bf16_f32 v178, v164, v165
    v_cvt_pk_bf16_f32 v179, v166, v167
    v_cvt_pk_bf16_f32 v180, v168, v169
    v_cvt_pk_bf16_f32 v181, v170, v171
    v_cvt_pk_bf16_f32 v182, v172, v173
    v_cvt_pk_bf16_f32 v183, v174, v175
    ds_write_b64 v248, v[176:177]
    v_xor_b32_e64 v12, 16, v248
    ds_write_b64 v12, v[178:179]
    v_xor_b32_e64 v12, 32, v248
    ds_write_b64 v12, v[180:181]
    v_xor_b32_e64 v12, 48, v248
    ds_write_b64 v12, v[182:183]
    v_pk_fma_f32 v[144:145], v[144:145], v[8:9], v[208:209] op_sel_hi:[1,0,1]
    v_pk_fma_f32 v[146:147], v[146:147], v[8:9], v[210:211] op_sel_hi:[1,0,1]
    v_pk_fma_f32 v[148:149], v[148:149], v[8:9], v[212:213] op_sel_hi:[1,0,1]
    v_pk_fma_f32 v[150:151], v[150:151], v[8:9], v[214:215] op_sel_hi:[1,0,1]
    v_pk_fma_f32 v[152:153], v[152:153], v[8:9], v[216:217] op_sel_hi:[1,0,1]
    v_pk_fma_f32 v[154:155], v[154:155], v[8:9], v[218:219] op_sel_hi:[1,0,1]
    v_pk_fma_f32 v[156:157], v[156:157], v[8:9], v[220:221] op_sel_hi:[1,0,1]
    v_pk_fma_f32 v[158:159], v[158:159], v[8:9], v[222:223] op_sel_hi:[1,0,1]
    s_waitcnt lgkmcnt(0)
    ds_read_b64_tr_b16 v[232:233], v249 offset:0
    ds_read_b64_tr_b16 v[234:235], v250 offset:0
    ds_read_b64_tr_b16 v[236:237], v249 offset:1024
    ds_read_b64_tr_b16 v[238:239], v250 offset:1024
    s_mov_b64 exec, s[54:55]
    v_mov_b32 v156, 1.0
    v_mov_b32 v157, 1.0
    v_mov_b32 v158, 1.0
    s_mov_b64 exec, -1
    v_cvt_pk_bf16_f32 v224, v144, v145
    v_cvt_pk_bf16_f32 v225, v146, v147
    v_cvt_pk_bf16_f32 v226, v148, v149
    v_cvt_pk_bf16_f32 v227, v150, v151
    v_cvt_pk_bf16_f32 v228, v152, v153
    v_cvt_pk_bf16_f32 v229, v154, v155
    v_cvt_pk_bf16_f32 v230, v156, v157
    v_cvt_pk_bf16_f32 v231, v158, v159
    s_waitcnt lgkmcnt(0)
    v_add_u32 v12, 32768, v1
    ds_read_b128 v[176:179], v12 offset:24576
    ds_read_b128 v[180:183], v12 offset:25600
    ds_read_b128 v[184:187], v12 offset:26624
    buffer_store_dwordx4 v[232:235], v1, s[4:7], s39 offen offset:2048 sc1
    buffer_store_dwordx4 v[236:239], v1, s[4:7], s39 offen offset:3072 sc1
    buffer_store_dwordx4 v[224:227], v1, s[4:7], s39 offen offset:0 sc1
    buffer_store_dwordx4 v[228:231], v1, s[4:7], s39 offen offset:1024 sc1
    v_mov_b32_e64 v9, s56
    s_waitcnt lgkmcnt(2)
    v_mfma_f32_32x32x16_bf16 v[144:159], v[176:179], v[32:35], 0
    ds_read_b128 v[188:191], v12 offset:27648
    s_add_u32 s17, s14, 1
    s_and_b32 s17, s17, 3
    s_lshl_b32 s18, s17, 11
    s_add_u32 s18, s18, 155648
    v_add_u32 v242, s18, v1
    s_mul_i32 s17, s17, 12288
    s_add_u32 s17, s17, 86016
    v_add_u32 v251, s17, v1
    s_waitcnt lgkmcnt(2)
    v_mfma_f32_32x32x16_bf16 v[144:159], v[180:183], v[36:39], v[144:159]
    ds_read_b128 v[176:179], v12 offset:28672
    s_add_u32 s17, s14, 2
    s_and_b32 s17, s17, 3
    s_lshl_b32 s18, s17, 11
    s_add_u32 s18, s18, 155648
    v_add_u32 v243, s18, v1
    s_mul_i32 s17, s17, 12288
    s_add_u32 s17, s17, 90112
    v_add_u32 v252, s17, v1
    s_waitcnt lgkmcnt(2)
    v_mfma_f32_32x32x16_bf16 v[144:159], v[184:187], v[40:43], v[144:159]
    ds_read_b128 v[180:183], v12 offset:29696
    s_add_u32 s17, s14, 3
    s_and_b32 s17, s17, 3
    s_lshl_b32 s18, s17, 11
    s_add_u32 s18, s18, 155648
    v_add_u32 v244, s18, v1
    s_mul_i32 s17, s17, 12288
    s_add_u32 s17, s17, 94208
    v_add_u32 v253, s17, v1
    s_waitcnt lgkmcnt(2)
    v_mfma_f32_32x32x16_bf16 v[144:159], v[188:191], v[44:47], v[144:159]
    ds_read_b128 v[184:187], v12 offset:30720
    s_lshl_b32 s17, s14, 11
    s_add_u32 s17, s17, 155648
    v_add_u32 v245, s17, v1
    s_mul_i32 s17, s14, 12288
    s_add_u32 s17, s17, 86016
    v_add_u32 v254, s17, v1
    s_waitcnt lgkmcnt(2)
    v_mfma_f32_32x32x16_bf16 v[144:159], v[176:179], v[48:51], v[144:159]
    ds_read_b128 v[188:191], v12 offset:31744
    s_andn2_b32 s64, s39, 0x4000
    s_and_b32 s17, s12, 14
    s_and_b32 s18, s12, 1
    s_xor_b32 s18, s18, 1
    v_and_b32 v247, 15, v0
    v_med3_u32 v241, v247, 2, 4
    v_xor_b32 v241, s17, v241
    v_mov_b32 v2, s18
    v_cmp_gt_u32 vcc, 5, v247
    s_nop 1
    v_cndmask_b32 v247, v247, v2, vcc
    v_xor_b32_e64 v247, s17, v247
    s_waitcnt lgkmcnt(2)
    v_mfma_f32_32x32x16_bf16 v[144:159], v[180:183], v[52:55], v[144:159]
    ds_read_b128 v[176:179], v12 offset:32768
    v_lshlrev_b32 v241, 7, v241
    v_lshlrev_b32 v247, 7, v247
    v_mov_b32 v246, 0xdddddddd
    v_lshrrev_b32 v13, 5, v0
    v_lshlrev_b32 v13, 4, v13
    v_add_u32 v13, 147456, v13
    ds_read_b128 v[208:211], v13 offset:640
    s_waitcnt lgkmcnt(3)
    v_mfma_f32_32x32x16_bf16 v[144:159], v[184:187], v[56:59], v[144:159]
    ds_read_b128 v[180:183], v12 offset:33792
    ds_read_b128 v[212:215], v13 offset:672
    s_waitcnt lgkmcnt(4)
    v_mfma_f32_32x32x16_bf16 v[144:159], v[188:191], v[60:63], v[144:159]
    ds_read_b128 v[184:187], v12 offset:34816
    ds_read_b128 v[216:219], v13 offset:704
    s_waitcnt lgkmcnt(5)
    v_mfma_f32_32x32x16_bf16 v[144:159], v[176:179], v[64:67], v[144:159]
    ds_read_b128 v[188:191], v12 offset:35840
    ds_read_b128 v[220:223], v13 offset:736
    s_waitcnt lgkmcnt(5)
    v_mfma_f32_32x32x16_bf16 v[144:159], v[180:183], v[68:71], v[144:159]
    ds_read_b128 v[176:179], v12 offset:36864
    v_mov_b32 v64, 0
    v_mov_b32 v65, 0
    v_mov_b32 v66, 0
    v_mov_b32_e64 v67, 0
    s_waitcnt lgkmcnt(4)
    v_mfma_f32_32x32x16_bf16 v[144:159], v[184:187], v[72:75], v[144:159]
    ds_read_b128 v[180:183], v12 offset:37888
    v_mov_b32 v68, 0
    v_mov_b32 v69, 0
    v_mov_b32 v70, 0
    v_mov_b32_e64 v71, 0
    s_waitcnt lgkmcnt(3)
    v_mfma_f32_32x32x16_bf16 v[144:159], v[188:191], v[76:79], v[144:159]
    ds_read_b128 v[184:187], v12 offset:38912
    v_mov_b32 v72, 0
    v_mov_b32 v73, 0
    v_mov_b32 v74, 0
    v_mov_b32 v75, 0
    s_waitcnt lgkmcnt(3)
    v_mul_f32_e64 v208, v208, v206
    s_waitcnt lgkmcnt(2)
    v_mfma_f32_32x32x16_bf16 v[144:159], v[176:179], v[80:83], v[144:159]
    ds_read_b128 v[188:191], v12 offset:39936
    v_mov_b32 v76, 0
    v_mov_b32 v77, 0
    v_mov_b32 v78, 0
    v_mov_b32 v79, 0
    v_mul_f32 v209, v209, v206
    s_waitcnt lgkmcnt(2)
    v_mfma_f32_32x32x16_bf16 v[144:159], v[180:183], v[84:87], v[144:159]
    ds_read_b128 v[176:179], v12 offset:40960
    v_mov_b32 v80, 0
    v_mov_b32 v81, 0
    v_mov_b32 v82, 0
    v_mov_b32 v83, 0
    v_mul_f32 v210, v210, v206
    s_waitcnt lgkmcnt(2)
    v_mfma_f32_32x32x16_bf16 v[144:159], v[184:187], v[88:91], v[144:159]
    ds_read_b128 v[180:183], v12 offset:41984
    v_mov_b32 v84, 0
    v_mov_b32 v85, 0
    v_mov_b32 v86, 0
    v_mov_b32 v87, 0
    v_mul_f32 v211, v211, v206
    s_waitcnt lgkmcnt(2)
    v_mfma_f32_32x32x16_bf16 v[144:159], v[188:191], v[92:95], v[144:159]
    ds_read_b128 v[184:187], v12 offset:43008
    v_mov_b32 v88, 0
    v_mov_b32 v89, 0
    v_mov_b32 v90, 0
    v_mov_b32 v91, 0
    v_mul_f32 v212, v212, v206
    s_waitcnt lgkmcnt(2)
    v_mfma_f32_32x32x16_bf16 v[144:159], v[176:179], v[96:99], v[144:159]
    ds_read_b128 v[188:191], v12 offset:44032
    v_mov_b32 v92, 0
    v_mov_b32 v93, 0
    v_mov_b32 v94, 0
    v_mov_b32 v95, 0
    v_mul_f32 v213, v213, v206
    s_waitcnt lgkmcnt(2)
    v_mfma_f32_32x32x16_bf16 v[144:159], v[180:183], v[100:103], v[144:159]
    ds_read_b128 v[176:179], v12 offset:45056
    v_mov_b32 v96, 0
    v_mov_b32 v97, 0
    v_mov_b32 v98, 0
    v_mov_b32 v99, 0
    v_mul_f32 v214, v214, v206
    s_waitcnt lgkmcnt(2)
    v_mfma_f32_32x32x16_bf16 v[144:159], v[184:187], v[104:107], v[144:159]
    ds_read_b128 v[180:183], v12 offset:46080
    v_mov_b32 v100, 0
    v_mov_b32 v101, 0
    v_mov_b32 v102, 0
    v_mov_b32 v103, 0
    v_mul_f32 v215, v215, v206
    s_waitcnt lgkmcnt(2)
    v_mfma_f32_32x32x16_bf16 v[144:159], v[188:191], v[108:111], v[144:159]
    ds_read_b128 v[184:187], v12 offset:47104
    v_mov_b32 v104, 0
    v_mov_b32 v105, 0
    v_mov_b32 v106, 0
    v_mov_b32 v107, 0
    v_mul_f32 v216, v216, v206
    s_waitcnt lgkmcnt(2)
    v_mfma_f32_32x32x16_bf16 v[144:159], v[176:179], v[112:115], v[144:159]
    ds_read_b128 v[188:191], v12 offset:48128
    v_mov_b32 v108, 0
    v_mov_b32 v109, 0
    v_mov_b32 v110, 0
    v_mov_b32 v111, 0
    v_mul_f32 v217, v217, v206
    s_waitcnt lgkmcnt(2)
    v_mfma_f32_32x32x16_bf16 v[144:159], v[180:183], v[116:119], v[144:159]
    ds_read_b128 v[176:179], v12 offset:49152
    v_mov_b32 v112, 0
    v_mov_b32 v113, 0
    v_mov_b32 v114, 0
    v_mov_b32 v115, 0
    v_mul_f32 v218, v218, v206
    s_waitcnt lgkmcnt(2)
    v_mfma_f32_32x32x16_bf16 v[144:159], v[184:187], v[120:123], v[144:159]
    ds_read_b128 v[180:183], v12 offset:50176
    v_mov_b32 v116, 0
    v_mov_b32 v117, 0
    v_mov_b32 v118, 0
    v_mov_b32 v119, 0
    v_mul_f32_e64 v219, v219, v206
    s_waitcnt vmcnt(0)
    s_mov_b64 exec, 1
    buffer_store_dword v9, off, s[4:7], s42 sc1
    s_mov_b64 exec, -1
    s_waitcnt lgkmcnt(2)
    v_mfma_f32_32x32x16_bf16 v[144:159], v[188:191], v[124:127], v[144:159]
    ds_read_b128 v[184:187], v12 offset:51200
    v_mov_b32 v120, 0
    v_mov_b32 v121, 0
    v_mov_b32 v122, 0
    v_mov_b32 v123, 0
    v_mul_f32 v220, v220, v206
    s_waitcnt lgkmcnt(2)
    v_mfma_f32_32x32x16_bf16 v[144:159], v[176:179], v[128:131], v[144:159]
    ds_read_b128 v[188:191], v12 offset:52224
    v_mov_b32 v124, 0
    v_mov_b32 v125, 0
    v_mov_b32 v126, 0
    v_mov_b32 v127, 0
    v_mul_f32 v221, v221, v206
    s_waitcnt lgkmcnt(2)
    v_mfma_f32_32x32x16_bf16 v[144:159], v[180:183], v[132:135], v[144:159]
    v_mul_f32 v222, v222, v206
    s_waitcnt lgkmcnt(1)
    v_mfma_f32_32x32x16_bf16 v[144:159], v[184:187], v[136:139], v[144:159]
    v_mul_f32 v223, v223, v206
    s_waitcnt lgkmcnt(0)
    v_mfma_f32_32x32x16_bf16 v[144:159], v[188:191], v[140:143], v[144:159]
    s_nop 11
    v_pk_fma_f32 v[144:145], v[144:145], v[8:9], v[208:209] op_sel_hi:[1,0,1]
    v_pk_fma_f32 v[146:147], v[146:147], v[8:9], v[210:211] op_sel_hi:[1,0,1]
    v_pk_fma_f32 v[148:149], v[148:149], v[8:9], v[212:213] op_sel_hi:[1,0,1]
    v_pk_fma_f32 v[150:151], v[150:151], v[8:9], v[214:215] op_sel_hi:[1,0,1]
    v_pk_fma_f32 v[152:153], v[152:153], v[8:9], v[216:217] op_sel_hi:[1,0,1]
    v_pk_fma_f32 v[154:155], v[154:155], v[8:9], v[218:219] op_sel_hi:[1,0,1]
    v_pk_fma_f32 v[156:157], v[156:157], v[8:9], v[220:221] op_sel_hi:[1,0,1]
    v_pk_fma_f32 v[158:159], v[158:159], v[8:9], v[222:223] op_sel_hi:[1,0,1]
    v_cvt_pk_bf16_f32 v56, v144, v145
    v_cvt_pk_bf16_f32 v57, v146, v147
    v_cvt_pk_bf16_f32 v58, v148, v149
    v_cvt_pk_bf16_f32 v59, v150, v151
    v_cvt_pk_bf16_f32 v60, v152, v153
    v_cvt_pk_bf16_f32 v61, v154, v155
    v_cvt_pk_bf16_f32 v62, v156, v157
    v_cvt_pk_bf16_f32 v63, v158, v159
    s_mov_b32 s70, 0
    v_mfma_f32_32x32x16_bf16 v[160:175], v[224:227], v[56:59], 0
    v_mfma_f32_32x32x16_bf16 v[160:175], v[228:231], v[60:63], v[160:175]
    s_nop 11
    v_max3_f32 v240, v160, v161, v162
    v_max3_f32 v240, v240, v163, v164
    v_max3_f32 v240, v240, v165, v166
    v_max3_f32 v240, v240, v167, v168
    v_max3_f32 v240, v240, v169, v170
    v_max3_f32 v240, v240, v171, v172
    v_max3_f32 v240, v240, v173, v174
    v_max3_f32 v240, v240, v175, v175
    v_mov_b32 v4, v240
    s_nop 1
    v_permlane32_swap_b32 v240, v4
    v_max_f32_e64 v240, v240, v4
L_attn_25:
    v_xor_b32 v2, 0x80000000, v240
    v_and_b32 v3, 0xffff0000, v2
    v_sub_f32_e64 v2, v2, v3
    v_and_b32 v4, 0xffff0000, v2
    v_sub_f32 v2, v2, v4
    v_lshrrev_b32 v3, 16, v3
    s_mov_b64 exec, s[54:55]
    v_or_b32 v62, v3, v4
    v_lshrrev_b32 v63, 16, v2
    s_mov_b64 exec, -1
    ds_write_b128 v245, v[56:59]
    ds_write_b128 v245, v[60:63] offset:1024
    s_waitcnt lgkmcnt(0)
    s_barrier
    ds_read_b128 v[32:35], v242
    ds_read_b128 v[36:39], v242 offset:1024
    ds_read_b128 v[40:43], v243
    ds_read_b128 v[44:47], v243 offset:1024
    ds_read_b128 v[48:51], v244
    ds_read_b128 v[52:55], v244 offset:1024
    buffer_load_dword v9, v241, s[4:7], s43 offen sc1
    s_waitcnt lgkmcnt(4)
    v_mfma_f32_32x32x16_bf16 v[128:143], v[224:227], v[32:35], 0
    v_mfma_f32_32x32x16_bf16 v[128:143], v[228:231], v[36:39], v[128:143]
    s_waitcnt lgkmcnt(2)
    v_mfma_f32_32x32x16_bf16 v[144:159], v[224:227], v[40:43], 0
    v_mfma_f32_32x32x16_bf16 v[144:159], v[228:231], v[44:47], v[144:159]
    s_nop 8
    v_exp_f32 v128, v128
    v_exp_f32 v129, v129
    v_exp_f32 v130, v130
    v_exp_f32 v131, v131
    v_exp_f32 v132, v132
    v_exp_f32 v133, v133
    v_exp_f32 v134, v134
    v_exp_f32 v135, v135
    s_waitcnt lgkmcnt(0)
    v_mfma_f32_32x32x16_bf16 v[160:175], v[224:227], v[48:51], 0
    v_exp_f32 v136, v136
    v_exp_f32 v137, v137
    v_exp_f32 v138, v138
    v_exp_f32 v139, v139
    v_smfmac_f32_32x32x32_bf16 v[64:79], v[232:235], v[128:135], v246
    v_exp_f32 v140, v140
    v_exp_f32 v141, v141
    v_exp_f32 v142, v142
    v_exp_f32 v143, v143
    v_mfma_f32_32x32x16_bf16 v[160:175], v[228:231], v[52:55], v[160:175]
    s_waitcnt vmcnt(0)
    v_cmp_ne_u32 vcc, s56, v9
    s_cbranch_vccnz L_kvwait_27
L_kvok_26:
    s_xor_b32 s69, s64, 32768
    buffer_load_dwordx4 v[176:179], v1, s[4:7], s69 offen offset:0 sc1
    v_exp_f32 v144, v144
    v_exp_f32 v145, v145
    v_exp_f32 v146, v146
    v_exp_f32_e64 v147, v147
    v_smfmac_f32_32x32x32_bf16 v[64:79], v[236:239], v[136:143], v246
    buffer_load_dwordx4 v[180:183], v1, s[4:7], s69 offen offset:1024 sc1
    v_exp_f32 v148, v148
    v_exp_f32 v149, v149
    v_exp_f32 v150, v150
    v_exp_f32 v151, v151
    v_mfma_f32_32x32x16_bf16 v[128:143], v[224:227], v[56:59], 0
    buffer_load_dwordx4 v[184:187], v1, s[4:7], s69 offen offset:2048 sc1
    v_exp_f32 v152, v152
    v_exp_f32 v153, v153
    v_exp_f32 v154, v154
    v_exp_f32 v155, v155
    v_smfmac_f32_32x32x32_bf16 v[80:95], v[232:235], v[144:151], v246
    buffer_load_dwordx4 v[188:191], v1, s[4:7], s69 offen offset:3072 sc1
    v_exp_f32 v156, v156
    v_exp_f32 v157, v157
    v_exp_f32 v158, v158
    v_exp_f32 v159, v159
    v_mfma_f32_32x32x16_bf16 v[128:143], v[228:231], v[60:63], v[128:143]
    s_xor_b32 s69, s64, 49152
    buffer_load_dwordx4 v[192:195], v1, s[4:7], s69 offen offset:0 sc1
    v_exp_f32 v160, v160
    v_exp_f32 v161, v161
    v_exp_f32 v162, v162
    v_exp_f32 v163, v163
    v_smfmac_f32_32x32x32_bf16 v[80:95], v[236:239], v[152:159], v246
    buffer_load_dwordx4 v[196:199], v1, s[4:7], s69 offen offset:1024 sc1
    v_exp_f32 v164, v164
    v_exp_f32 v165, v165
    v_exp_f32 v166, v166
    v_exp_f32 v167, v167
    v_exp_f32 v168, v168
    v_exp_f32 v169, v169
    v_exp_f32 v170, v170
    v_exp_f32 v171, v171
    v_smfmac_f32_32x32x32_bf16 v[96:111], v[232:235], v[160:167], v246
    v_exp_f32 v172, v172
    v_exp_f32 v173, v173
    v_exp_f32 v174, v174
    v_exp_f32 v175, v175
    buffer_load_dwordx4 v[200:203], v1, s[4:7], s69 offen offset:2048 sc1
    v_exp_f32 v128, v128
    v_exp_f32 v129, v129
    v_exp_f32 v130, v130
    v_exp_f32 v131, v131
    v_smfmac_f32_32x32x32_bf16 v[96:111], v[236:239], v[168:175], v246
    buffer_load_dwordx4 v[204:207], v1, s[4:7], s69 offen offset:3072 sc1
    v_exp_f32 v132, v132
    v_exp_f32 v133, v133
    v_exp_f32 v134, v134
    v_exp_f32 v135, v135
    v_exp_f32 v136, v136
    v_exp_f32 v137, v137
    v_exp_f32 v138, v138
    v_exp_f32 v139, v139
    v_smfmac_f32_32x32x32_bf16 v[112:127], v[232:235], v[128:135], v246
    v_exp_f32 v140, v140
    v_exp_f32 v141, v141
    v_exp_f32 v142, v142
    v_exp_f32 v143, v143
    s_xor_b32 s69, s64, 65536
    buffer_load_dwordx4 v[208:211], v1, s[4:7], s69 offen offset:0 sc1
    s_waitcnt vmcnt(7)
    v_mfma_f32_32x32x16_bf16 v[144:159], v[176:179], v[32:35], 0
    v_mfma_f32_32x32x16_bf16 v[144:159], v[180:183], v[36:39], v[144:159]
    v_mfma_f32_32x32x16_bf16 v[160:175], v[176:179], v[40:43], 0
    v_mfma_f32_32x32x16_bf16 v[160:175], v[180:183], v[44:47], v[160:175]
    s_nop 9
    v_exp_f32 v144, v144
    v_exp_f32 v145, v145
    v_exp_f32 v146, v146
    v_exp_f32 v147, v147
    v_smfmac_f32_32x32x32_bf16 v[112:127], v[236:239], v[136:143], v246
    v_exp_f32 v148, v148
    v_exp_f32 v149, v149
    v_exp_f32 v150, v150
    v_exp_f32 v151, v151
    v_mfma_f32_32x32x16_bf16 v[128:143], v[176:179], v[48:51], 0
    v_exp_f32 v152, v152
    v_exp_f32 v153, v153
    v_exp_f32 v154, v154
    v_exp_f32_e64 v155, v155
    s_waitcnt vmcnt(5)
    v_smfmac_f32_32x32x32_bf16 v[64:79], v[184:187], v[144:151], v246
    v_exp_f32 v156, v156
    v_exp_f32 v157, v157
    v_exp_f32 v158, v158
    v_exp_f32 v159, v159
    v_mfma_f32_32x32x16_bf16 v[128:143], v[180:183], v[52:55], v[128:143]
    buffer_load_dword v9, v247, s[4:7], s43 offen sc1
    buffer_load_dwordx4 v[212:215], v1, s[4:7], s69 offen offset:1024 sc1
    v_exp_f32 v160, v160
    v_exp_f32 v161, v161
    v_exp_f32 v162, v162
    v_exp_f32 v163, v163
    v_smfmac_f32_32x32x32_bf16 v[64:79], v[188:191], v[152:159], v246
    v_exp_f32 v164, v164
    v_exp_f32 v165, v165
    v_exp_f32 v166, v166
    v_exp_f32 v167, v167
    v_mfma_f32_32x32x16_bf16 v[144:159], v[176:179], v[56:59], 0
    v_exp_f32 v168, v168
    v_exp_f32 v169, v169
    v_exp_f32 v170, v170
    v_exp_f32 v171, v171
    v_smfmac_f32_32x32x32_bf16 v[80:95], v[184:187], v[160:167], v246
    v_exp_f32 v172, v172
    v_exp_f32 v173, v173
    v_exp_f32 v174, v174
    v_exp_f32 v175, v175
    v_mfma_f32_32x32x16_bf16 v[144:159], v[180:183], v[60:63], v[144:159]
    buffer_load_dwordx4 v[216:219], v1, s[4:7], s69 offen offset:2048 sc1
    v_exp_f32 v128, v128
    v_exp_f32 v129, v129
    v_exp_f32 v130, v130
    v_exp_f32 v131, v131
    v_smfmac_f32_32x32x32_bf16 v[80:95], v[188:191], v[168:175], v246
    v_exp_f32 v132, v132
    v_exp_f32 v133, v133
    v_exp_f32 v134, v134
    v_exp_f32_e64 v135, v135
    s_waitcnt vmcnt(6)
    v_mfma_f32_32x32x16_bf16 v[160:175], v[192:195], v[32:35], 0
    v_exp_f32 v136, v136
    v_exp_f32 v137, v137
    v_exp_f32 v138, v138
    v_exp_f32 v139, v139
    v_smfmac_f32_32x32x32_bf16 v[96:111], v[184:187], v[128:135], v246
    v_exp_f32 v140, v140
    v_exp_f32 v141, v141
    v_exp_f32 v142, v142
    v_exp_f32 v143, v143
    v_mfma_f32_32x32x16_bf16 v[160:175], v[196:199], v[36:39], v[160:175]
    buffer_load_dwordx4 v[220:223], v1, s[4:7], s69 offen offset:3072 sc1
    v_exp_f32 v144, v144
    v_exp_f32 v145, v145
    v_exp_f32 v146, v146
    v_exp_f32 v147, v147
    v_smfmac_f32_32x32x32_bf16 v[96:111], v[188:191], v[136:143], v246
    v_exp_f32 v148, v148
    v_exp_f32 v149, v149
    v_exp_f32 v150, v150
    v_exp_f32 v151, v151
    v_mfma_f32_32x32x16_bf16 v[128:143], v[192:195], v[40:43], 0
    v_exp_f32 v152, v152
    v_exp_f32 v153, v153
    v_exp_f32 v154, v154
    v_exp_f32 v155, v155
    v_smfmac_f32_32x32x32_bf16 v[112:127], v[184:187], v[144:151], v246
    v_exp_f32 v156, v156
    v_exp_f32 v157, v157
    v_exp_f32 v158, v158
    v_exp_f32 v159, v159
    v_mfma_f32_32x32x16_bf16 v[128:143], v[196:199], v[44:47], v[128:143]
    s_waitcnt vmcnt(3)
    v_cmp_ne_u32 vcc, s56, v9
    s_cbranch_vccnz L_kvwait_29
L_kvok_28:
    s_xor_b32 s69, s64, 81920
    buffer_load_dwordx4 v[224:227], v1, s[4:7], s69 offen offset:0 sc1
    v_exp_f32 v160, v160
    v_exp_f32 v161, v161
    v_exp_f32 v162, v162
    v_exp_f32_e64 v163, v163
    v_smfmac_f32_32x32x32_bf16 v[112:127], v[188:191], v[152:159], v246
    buffer_load_dwordx4 v[228:231], v1, s[4:7], s69 offen offset:1024 sc1
    v_exp_f32 v164, v164
    v_exp_f32 v165, v165
    v_exp_f32 v166, v166
    v_exp_f32 v167, v167
    v_mfma_f32_32x32x16_bf16 v[144:159], v[192:195], v[48:51], 0
    v_exp_f32 v168, v168
    v_exp_f32 v169, v169
    v_exp_f32 v170, v170
    v_exp_f32 v171, v171
    v_smfmac_f32_32x32x32_bf16 v[64:79], v[200:203], v[160:167], v246
    v_exp_f32 v172, v172
    v_exp_f32 v173, v173
    v_exp_f32 v174, v174
    v_exp_f32 v175, v175
    v_mfma_f32_32x32x16_bf16 v[144:159], v[196:199], v[52:55], v[144:159]
    buffer_load_dwordx4 v[232:235], v1, s[4:7], s69 offen offset:2048 sc1
    v_exp_f32 v128, v128
    v_exp_f32 v129, v129
    v_exp_f32 v130, v130
    v_exp_f32 v131, v131
    v_smfmac_f32_32x32x32_bf16 v[64:79], v[204:207], v[168:175], v246
    buffer_load_dwordx4 v[236:239], v1, s[4:7], s69 offen offset:3072 sc1
    v_exp_f32 v132, v132
    v_exp_f32 v133, v133
    v_exp_f32 v134, v134
    v_exp_f32 v135, v135
    v_mfma_f32_32x32x16_bf16 v[160:175], v[192:195], v[56:59], 0
    v_exp_f32 v136, v136
    v_exp_f32 v137, v137
    v_exp_f32 v138, v138
    v_exp_f32 v139, v139
    v_smfmac_f32_32x32x32_bf16 v[80:95], v[200:203], v[128:135], v246
    v_exp_f32 v140, v140
    v_exp_f32 v141, v141
    v_exp_f32 v142, v142
    v_exp_f32 v143, v143
    v_mfma_f32_32x32x16_bf16 v[160:175], v[196:199], v[60:63], v[160:175]
    s_xor_b32 s69, s64, 98304
    buffer_load_dwordx4 v[176:179], v1, s[4:7], s69 offen offset:0 sc1
    v_exp_f32 v144, v144
    v_exp_f32 v145, v145
    v_exp_f32 v146, v146
    v_exp_f32 v147, v147
    v_smfmac_f32_32x32x32_bf16 v[80:95], v[204:207], v[136:143], v246
    buffer_load_dwordx4 v[180:183], v1, s[4:7], s69 offen offset:1024 sc1
    v_exp_f32 v148, v148
    v_exp_f32 v149, v149
    v_exp_f32 v150, v150
    v_exp_f32_e64 v151, v151
    s_waitcnt vmcnt(8)
    v_mfma_f32_32x32x16_bf16 v[128:143], v[208:211], v[32:35], 0
    s_add_u32 s68, s14, 0
    s_and_b32 s68, s68, 3
    s_add_u32 s68, s68, 0
    s_mul_i32 s68, s68, 7168
    s_add_u32 s68, s68, s49
    buffer_load_dwordx4 a[128:131], v1, s[4:7], s68 offen offset:0 sc1
    v_exp_f32 v152, v152
    v_exp_f32 v153, v153
    v_exp_f32 v154, v154
    v_exp_f32 v155, v155
    v_smfmac_f32_32x32x32_bf16 v[96:111], v[200:203], v[144:151], v246
    v_exp_f32 v156, v156
    v_exp_f32 v157, v157
    v_exp_f32 v158, v158
    v_exp_f32 v159, v159
    v_mfma_f32_32x32x16_bf16 v[128:143], v[212:215], v[36:39], v[128:143]
    buffer_load_dwordx4 v[184:187], v1, s[4:7], s69 offen offset:2048 sc1
    v_exp_f32 v160, v160
    v_exp_f32 v161, v161
    v_exp_f32 v162, v162
    v_exp_f32 v163, v163
    v_smfmac_f32_32x32x32_bf16 v[96:111], v[204:207], v[152:159], v246
    buffer_load_dwordx4 v[188:191], v1, s[4:7], s69 offen offset:3072 sc1
    v_exp_f32 v164, v164
    v_exp_f32 v165, v165
    v_exp_f32 v166, v166
    v_exp_f32 v167, v167
    v_mfma_f32_32x32x16_bf16 v[144:159], v[208:211], v[40:43], 0
    buffer_load_dwordx4 a[132:135], v1, s[4:7], s68 offen offset:1024 sc1
    v_exp_f32 v168, v168
    v_exp_f32 v169, v169
    v_exp_f32 v170, v170
    v_exp_f32 v171, v171
    v_smfmac_f32_32x32x32_bf16 v[112:127], v[200:203], v[160:167], v246
    v_exp_f32 v172, v172
    v_exp_f32 v173, v173
    v_exp_f32 v174, v174
    v_exp_f32 v175, v175
    v_mfma_f32_32x32x16_bf16 v[144:159], v[212:215], v[44:47], v[144:159]
    v_exp_f32 v128, v128
    v_exp_f32 v129, v129
    v_exp_f32 v130, v130
    v_exp_f32 v131, v131
    v_smfmac_f32_32x32x32_bf16 v[112:127], v[204:207], v[168:175], v246
    s_xor_b32 s69, s64, 114688
    buffer_load_dwordx4 v[192:195], v1, s[4:7], s69 offen offset:0 sc1
    v_exp_f32 v132, v132
    v_exp_f32 v133, v133
    v_exp_f32 v134, v134
    v_exp_f32 v135, v135
    v_mfma_f32_32x32x16_bf16 v[160:175], v[208:211], v[48:51], 0
    v_exp_f32 v136, v136
    v_exp_f32 v137, v137
    v_exp_f32 v138, v138
    v_exp_f32_e64 v139, v139
    s_waitcnt vmcnt(11)
    v_smfmac_f32_32x32x32_bf16 v[64:79], v[216:219], v[128:135], v246
    v_exp_f32 v140, v140
    v_exp_f32 v141, v141
    v_exp_f32 v142, v142
    v_exp_f32 v143, v143
    v_mfma_f32_32x32x16_bf16 v[160:175], v[212:215], v[52:55], v[160:175]
    buffer_load_dwordx4 v[196:199], v1, s[4:7], s69 offen offset:1024 sc1
    v_exp_f32 v144, v144
    v_exp_f32 v145, v145
    v_exp_f32 v146, v146
    v_exp_f32 v147, v147
    v_smfmac_f32_32x32x32_bf16 v[64:79], v[220:223], v[136:143], v246
    v_exp_f32 v148, v148
    v_exp_f32 v149, v149
    v_exp_f32 v150, v150
    v_exp_f32 v151, v151
    v_mfma_f32_32x32x16_bf16 v[128:143], v[208:211], v[56:59], 0
    buffer_load_dwordx4 a[136:139], v1, s[4:7], s68 offen offset:2048 sc1
    v_exp_f32 v152, v152
    v_exp_f32 v153, v153
    v_exp_f32 v154, v154
    v_exp_f32 v155, v155
    v_smfmac_f32_32x32x32_bf16 v[80:95], v[216:219], v[144:151], v246
    v_exp_f32 v156, v156
    v_exp_f32 v157, v157
    v_exp_f32 v158, v158
    v_exp_f32 v159, v159
    v_mfma_f32_32x32x16_bf16 v[128:143], v[212:215], v[60:63], v[128:143]
    buffer_load_dwordx4 v[200:203], v1, s[4:7], s69 offen offset:2048 sc1
    v_exp_f32 v160, v160
    v_exp_f32 v161, v161
    v_exp_f32 v162, v162
    v_exp_f32 v163, v163
    v_smfmac_f32_32x32x32_bf16 v[80:95], v[220:223], v[152:159], v246
    v_exp_f32 v164, v164
    v_exp_f32 v165, v165
    v_exp_f32 v166, v166
    v_exp_f32_e64 v167, v167
    s_waitcnt vmcnt(12)
    v_mfma_f32_32x32x16_bf16 v[144:159], v[224:227], v[32:35], 0
    v_exp_f32 v168, v168
    v_exp_f32 v169, v169
    v_exp_f32 v170, v170
    v_exp_f32 v171, v171
    v_smfmac_f32_32x32x32_bf16 v[96:111], v[216:219], v[160:167], v246
    v_exp_f32 v172, v172
    v_exp_f32 v173, v173
    v_exp_f32 v174, v174
    v_exp_f32 v175, v175
    v_mfma_f32_32x32x16_bf16 v[144:159], v[228:231], v[36:39], v[144:159]
    buffer_load_dwordx4 v[204:207], v1, s[4:7], s69 offen offset:3072 sc1
    v_exp_f32 v128, v128
    v_exp_f32 v129, v129
    v_exp_f32 v130, v130
    v_exp_f32 v131, v131
    v_smfmac_f32_32x32x32_bf16 v[96:111], v[220:223], v[168:175], v246
    v_exp_f32 v132, v132
    v_exp_f32 v133, v133
    v_exp_f32 v134, v134
    v_exp_f32 v135, v135
    v_mfma_f32_32x32x16_bf16 v[160:175], v[224:227], v[40:43], 0
    buffer_load_dwordx4 a[140:143], v1, s[4:7], s68 offen offset:3072 sc1
    v_exp_f32 v136, v136
    v_exp_f32 v137, v137
    v_exp_f32 v138, v138
    v_exp_f32 v139, v139
    v_smfmac_f32_32x32x32_bf16 v[112:127], v[216:219], v[128:135], v246
    v_exp_f32 v140, v140
    v_exp_f32 v141, v141
    v_exp_f32 v142, v142
    v_exp_f32 v143, v143
    v_mfma_f32_32x32x16_bf16 v[160:175], v[228:231], v[44:47], v[160:175]
    v_exp_f32 v144, v144
    v_exp_f32 v145, v145
    v_exp_f32 v146, v146
    v_exp_f32 v147, v147
    v_smfmac_f32_32x32x32_bf16 v[112:127], v[220:223], v[136:143], v246
    s_xor_b32 s69, s64, 131072
    buffer_load_dwordx4 v[208:211], v1, s[4:7], s69 offen offset:0 sc1
    v_exp_f32 v148, v148
    v_exp_f32 v149, v149
    v_exp_f32 v150, v150
    v_exp_f32 v151, v151
    v_mfma_f32_32x32x16_bf16 v[128:143], v[224:227], v[48:51], 0
    v_exp_f32 v152, v152
    v_exp_f32 v153, v153
    v_exp_f32 v154, v154
    v_exp_f32_e64 v155, v155
    s_waitcnt vmcnt(13)
    v_smfmac_f32_32x32x32_bf16 v[64:79], v[232:235], v[144:151], v246
    v_exp_f32 v156, v156
    v_exp_f32 v157, v157
    v_exp_f32 v158, v158
    v_exp_f32 v159, v159
    v_mfma_f32_32x32x16_bf16 v[128:143], v[228:231], v[52:55], v[128:143]
    buffer_load_dwordx4 v[212:215], v1, s[4:7], s69 offen offset:1024 sc1
    v_exp_f32 v160, v160
    v_exp_f32 v161, v161
    v_exp_f32 v162, v162
    v_exp_f32 v163, v163
    v_smfmac_f32_32x32x32_bf16 v[64:79], v[236:239], v[152:159], v246
    v_exp_f32 v164, v164
    v_exp_f32 v165, v165
    v_exp_f32 v166, v166
    v_exp_f32 v167, v167
    v_mfma_f32_32x32x16_bf16 v[144:159], v[224:227], v[56:59], 0
    s_add_u32 s68, s68, 4096
    buffer_load_dwordx4 a[144:147], v1, s[4:7], s68 offen offset:0 sc1
    v_exp_f32 v168, v168
    v_exp_f32 v169, v169
    v_exp_f32 v170, v170
    v_exp_f32 v171, v171
    v_smfmac_f32_32x32x32_bf16 v[80:95], v[232:235], v[160:167], v246
    v_exp_f32 v172, v172
    v_exp_f32 v173, v173
    v_exp_f32 v174, v174
    v_exp_f32 v175, v175
    v_mfma_f32_32x32x16_bf16 v[144:159], v[228:231], v[60:63], v[144:159]
    buffer_load_dwordx4 v[216:219], v1, s[4:7], s69 offen offset:2048 sc1
    v_exp_f32 v128, v128
    v_exp_f32 v129, v129
    v_exp_f32 v130, v130
    v_exp_f32 v131, v131
    v_smfmac_f32_32x32x32_bf16 v[80:95], v[236:239], v[168:175], v246
    v_exp_f32 v132, v132
    v_exp_f32 v133, v133
    v_exp_f32 v134, v134
    v_exp_f32_e64 v135, v135
    s_waitcnt vmcnt(14)
    v_mfma_f32_32x32x16_bf16 v[160:175], v[176:179], v[32:35], 0
    v_exp_f32 v136, v136
    v_exp_f32 v137, v137
    v_exp_f32 v138, v138
    v_exp_f32 v139, v139
    v_smfmac_f32_32x32x32_bf16 v[96:111], v[232:235], v[128:135], v246
    v_exp_f32 v140, v140
    v_exp_f32 v141, v141
    v_exp_f32 v142, v142
    v_exp_f32 v143, v143
    v_mfma_f32_32x32x16_bf16 v[160:175], v[180:183], v[36:39], v[160:175]
    buffer_load_dwordx4 v[220:223], v1, s[4:7], s69 offen offset:3072 sc1
    v_exp_f32 v144, v144
    v_exp_f32 v145, v145
    v_exp_f32 v146, v146
    v_exp_f32 v147, v147
    v_smfmac_f32_32x32x32_bf16 v[96:111], v[236:239], v[136:143], v246
    v_exp_f32 v148, v148
    v_exp_f32 v149, v149
    v_exp_f32 v150, v150
    v_exp_f32 v151, v151
    v_mfma_f32_32x32x16_bf16 v[128:143], v[176:179], v[40:43], 0
    buffer_load_dwordx4 a[148:151], v1, s[4:7], s68 offen offset:1024 sc1
    v_exp_f32 v152, v152
    v_exp_f32 v153, v153
    v_exp_f32 v154, v154
    v_exp_f32 v155, v155
    v_smfmac_f32_32x32x32_bf16 v[112:127], v[232:235], v[144:151], v246
    v_exp_f32 v156, v156
    v_exp_f32 v157, v157
    v_exp_f32 v158, v158
    v_exp_f32 v159, v159
    v_mfma_f32_32x32x16_bf16 v[128:143], v[180:183], v[44:47], v[128:143]
    v_exp_f32 v160, v160
    v_exp_f32 v161, v161
    v_exp_f32 v162, v162
    v_exp_f32 v163, v163
    v_smfmac_f32_32x32x32_bf16 v[112:127], v[236:239], v[152:159], v246
    s_xor_b32 s69, s64, 147456
    buffer_load_dwordx4 v[224:227], v1, s[4:7], s69 offen offset:0 sc1
    v_exp_f32 v164, v164
    v_exp_f32 v165, v165
    v_exp_f32 v166, v166
    v_exp_f32 v167, v167
    v_mfma_f32_32x32x16_bf16 v[144:159], v[176:179], v[48:51], 0
    s_add_u32 m0, s50, 0
    s_add_u32 s67, s31, 0
    buffer_load_dwordx4 v15, s[4:7], s67 offen sc1 lds
    v_exp_f32 v168, v168
    v_exp_f32 v169, v169
    v_exp_f32 v170, v170
    v_exp_f32_e64 v171, v171
    s_waitcnt vmcnt(15)
    v_smfmac_f32_32x32x32_bf16 v[64:79], v[184:187], v[160:167], v246
    v_exp_f32 v172, v172
    v_exp_f32 v173, v173
    v_exp_f32 v174, v174
    v_exp_f32 v175, v175
    v_mfma_f32_32x32x16_bf16 v[144:159], v[180:183], v[52:55], v[144:159]
    buffer_load_dwordx4 v[228:231], v1, s[4:7], s69 offen offset:1024 sc1
    v_exp_f32 v128, v128
    v_exp_f32 v129, v129
    v_exp_f32 v130, v130
    v_exp_f32 v131, v131
    v_smfmac_f32_32x32x32_bf16 v[64:79], v[188:191], v[168:175], v246
    v_exp_f32 v132, v132
    v_exp_f32 v133, v133
    v_exp_f32 v134, v134
    v_exp_f32 v135, v135
    v_mfma_f32_32x32x16_bf16 v[160:175], v[176:179], v[56:59], 0
    buffer_load_dwordx4 a[152:155], v1, s[4:7], s68 offen offset:2048 sc1
    v_exp_f32 v136, v136
    v_exp_f32 v137, v137
    v_exp_f32 v138, v138
    v_exp_f32 v139, v139
    v_smfmac_f32_32x32x32_bf16 v[80:95], v[184:187], v[128:135], v246
    v_exp_f32 v140, v140
    v_exp_f32 v141, v141
    v_exp_f32 v142, v142
    v_exp_f32 v143, v143
    v_mfma_f32_32x32x16_bf16 v[160:175], v[180:183], v[60:63], v[160:175]
    buffer_load_dwordx4 v[232:235], v1, s[4:7], s69 offen offset:2048 sc1
    v_exp_f32 v144, v144
    v_exp_f32 v145, v145
    v_exp_f32 v146, v146
    v_exp_f32 v147, v147
    v_smfmac_f32_32x32x32_bf16 v[80:95], v[188:191], v[136:143], v246
    v_exp_f32 v148, v148
    v_exp_f32 v149, v149
    v_exp_f32 v150, v150
    v_exp_f32_e64 v151, v151
    s_waitcnt vmcnt(15)
    v_mfma_f32_32x32x16_bf16 v[128:143], v[192:195], v[32:35], 0
    v_exp_f32 v152, v152
    v_exp_f32 v153, v153
    v_exp_f32 v154, v154
    v_exp_f32 v155, v155
    v_smfmac_f32_32x32x32_bf16 v[96:111], v[184:187], v[144:151], v246
    v_exp_f32 v156, v156
    v_exp_f32 v157, v157
    v_exp_f32 v158, v158
    v_exp_f32 v159, v159
    v_mfma_f32_32x32x16_bf16 v[128:143], v[196:199], v[36:39], v[128:143]
    buffer_load_dwordx4 v[236:239], v1, s[4:7], s69 offen offset:3072 sc1
    v_exp_f32 v160, v160
    v_exp_f32 v161, v161
    v_exp_f32 v162, v162
    v_exp_f32 v163, v163
    v_smfmac_f32_32x32x32_bf16 v[96:111], v[188:191], v[152:159], v246
    v_exp_f32 v164, v164
    v_exp_f32 v165, v165
    v_exp_f32 v166, v166
    v_exp_f32 v167, v167
    v_mfma_f32_32x32x16_bf16 v[144:159], v[192:195], v[40:43], 0
    s_add_u32 m0, s50, 4096
    s_add_u32 s67, s31, 3584
    buffer_load_dwordx4 v15, s[4:7], s67 offen sc1 lds
    v_exp_f32 v168, v168
    v_exp_f32 v169, v169
    v_exp_f32 v170, v170
    v_exp_f32 v171, v171
    v_smfmac_f32_32x32x32_bf16 v[112:127], v[184:187], v[160:167], v246
    s_add_u32 s68, s14, 1
    s_and_b32 s68, s68, 3
    s_add_u32 s68, s68, 0
    s_mul_i32 s68, s68, 7168
    s_add_u32 s68, s68, s49
    buffer_load_dwordx4 a[156:159], v1, s[4:7], s68 offen offset:0 sc1
    v_exp_f32 v172, v172
    v_exp_f32 v173, v173
    v_exp_f32 v174, v174
    v_exp_f32 v175, v175
    v_mfma_f32_32x32x16_bf16 v[144:159], v[196:199], v[44:47], v[144:159]
    v_exp_f32 v128, v128
    v_exp_f32 v129, v129
    v_exp_f32 v130, v130
    v_exp_f32 v131, v131
    v_smfmac_f32_32x32x32_bf16 v[112:127], v[188:191], v[168:175], v246
    s_xor_b32 s69, s64, 163840
    buffer_load_dwordx4 v[176:179], v1, s[4:7], s69 offen offset:0 sc1
    v_exp_f32 v132, v132
    v_exp_f32 v133, v133
    v_exp_f32 v134, v134
    v_exp_f32 v135, v135
    v_mfma_f32_32x32x16_bf16 v[160:175], v[192:195], v[48:51], 0
    buffer_load_dwordx4 a[160:163], v1, s[4:7], s68 offen offset:1024 sc1
    v_exp_f32 v136, v136
    v_exp_f32 v137, v137
    v_exp_f32 v138, v138
    v_exp_f32_e64 v139, v139
    s_waitcnt vmcnt(17)
    v_smfmac_f32_32x32x32_bf16 v[64:79], v[200:203], v[128:135], v246
    v_exp_f32 v140, v140
    v_exp_f32 v141, v141
    v_exp_f32 v142, v142
    v_exp_f32 v143, v143
    v_mfma_f32_32x32x16_bf16 v[160:175], v[196:199], v[52:55], v[160:175]
    buffer_load_dwordx4 v[180:183], v1, s[4:7], s69 offen offset:1024 sc1
    v_exp_f32 v144, v144
    v_exp_f32 v145, v145
    v_exp_f32 v146, v146
    v_exp_f32 v147, v147
    v_smfmac_f32_32x32x32_bf16 v[64:79], v[204:207], v[136:143], v246
    v_exp_f32 v148, v148
    v_exp_f32 v149, v149
    v_exp_f32 v150, v150
    v_exp_f32 v151, v151
    v_mfma_f32_32x32x16_bf16 v[128:143], v[192:195], v[56:59], 0
    v_exp_f32 v152, v152
    v_exp_f32 v153, v153
    v_exp_f32 v154, v154
    v_exp_f32 v155, v155
    v_smfmac_f32_32x32x32_bf16 v[80:95], v[200:203], v[144:151], v246
    v_exp_f32 v156, v156
    v_exp_f32 v157, v157
    v_exp_f32 v158, v158
    v_exp_f32 v159, v159
    v_mfma_f32_32x32x16_bf16 v[128:143], v[196:199], v[60:63], v[128:143]
    buffer_load_dwordx4 v[184:187], v1, s[4:7], s69 offen offset:2048 sc1
    v_exp_f32 v160, v160
    v_exp_f32 v161, v161
    v_exp_f32 v162, v162
    v_exp_f32 v163, v163
    v_smfmac_f32_32x32x32_bf16 v[80:95], v[204:207], v[152:159], v246
    v_exp_f32 v164, v164
    v_exp_f32 v165, v165
    v_exp_f32 v166, v166
    v_exp_f32_e64 v167, v167
    s_waitcnt vmcnt(16)
    v_mfma_f32_32x32x16_bf16 v[144:159], v[208:211], v[32:35], 0
    s_add_u32 m0, s50, 8192
    s_add_u32 s67, s31, 7168
    buffer_load_dwordx4 v15, s[4:7], s67 offen sc1 lds
    v_exp_f32 v168, v168
    v_exp_f32 v169, v169
    v_exp_f32 v170, v170
    v_exp_f32 v171, v171
    v_smfmac_f32_32x32x32_bf16 v[96:111], v[200:203], v[160:167], v246
    buffer_load_dwordx4 a[164:167], v1, s[4:7], s68 offen offset:2048 sc1
    v_exp_f32 v172, v172
    v_exp_f32 v173, v173
    v_exp_f32 v174, v174
    v_exp_f32 v175, v175
    v_mfma_f32_32x32x16_bf16 v[144:159], v[212:215], v[36:39], v[144:159]
    buffer_load_dwordx4 v[188:191], v1, s[4:7], s69 offen offset:3072 sc1
    v_exp_f32 v128, v128
    v_exp_f32 v129, v129
    v_exp_f32 v130, v130
    v_exp_f32 v131, v131
    v_smfmac_f32_32x32x32_bf16 v[96:111], v[204:207], v[168:175], v246
    v_exp_f32 v132, v132
    v_exp_f32 v133, v133
    v_exp_f32 v134, v134
    v_exp_f32 v135, v135
    v_mfma_f32_32x32x16_bf16 v[160:175], v[208:211], v[40:43], 0
    v_exp_f32 v136, v136
    v_exp_f32 v137, v137
    v_exp_f32 v138, v138
    v_exp_f32 v139, v139
    v_smfmac_f32_32x32x32_bf16 v[112:127], v[200:203], v[128:135], v246
    v_exp_f32 v140, v140
    v_exp_f32 v141, v141
    v_exp_f32 v142, v142
    v_exp_f32 v143, v143
    v_mfma_f32_32x32x16_bf16 v[160:175], v[212:215], v[44:47], v[160:175]
    v_exp_f32 v144, v144
    v_exp_f32 v145, v145
    v_exp_f32 v146, v146
    v_exp_f32 v147, v147
    v_smfmac_f32_32x32x32_bf16 v[112:127], v[204:207], v[136:143], v246
    s_xor_b32 s69, s64, 180224
    buffer_load_dwordx4 v[192:195], v1, s[4:7], s69 offen offset:0 sc1
    v_exp_f32 v148, v148
    v_exp_f32 v149, v149
    v_exp_f32 v150, v150
    v_exp_f32 v151, v151
    v_mfma_f32_32x32x16_bf16 v[128:143], v[208:211], v[48:51], 0
    buffer_load_dwordx4 a[168:171], v1, s[4:7], s68 offen offset:3072 sc1
    v_exp_f32 v152, v152
    v_exp_f32 v153, v153
    v_exp_f32 v154, v154
    v_exp_f32_e64 v155, v155
    s_waitcnt vmcnt(18)
    v_smfmac_f32_32x32x32_bf16 v[64:79], v[216:219], v[144:151], v246
    v_exp_f32 v156, v156
    v_exp_f32 v157, v157
    v_exp_f32 v158, v158
    v_exp_f32 v159, v159
    v_mfma_f32_32x32x16_bf16 v[128:143], v[212:215], v[52:55], v[128:143]
    buffer_load_dwordx4 v[196:199], v1, s[4:7], s69 offen offset:1024 sc1
    v_exp_f32 v160, v160
    v_exp_f32 v161, v161
    v_exp_f32 v162, v162
    v_exp_f32 v163, v163
    v_smfmac_f32_32x32x32_bf16 v[64:79], v[220:223], v[152:159], v246
    v_exp_f32 v164, v164
    v_exp_f32 v165, v165
    v_exp_f32 v166, v166
    v_exp_f32 v167, v167
    v_mfma_f32_32x32x16_bf16 v[144:159], v[208:211], v[56:59], 0
    s_add_u32 m0, s50, 12288
    s_add_u32 s67, s31, 10752
    buffer_load_dwordx4 v15, s[4:7], s67 offen sc1 lds
    v_exp_f32 v168, v168
    v_exp_f32 v169, v169
    v_exp_f32 v170, v170
    v_exp_f32 v171, v171
    v_smfmac_f32_32x32x32_bf16 v[80:95], v[216:219], v[160:167], v246
    v_exp_f32 v172, v172
    v_exp_f32 v173, v173
    v_exp_f32 v174, v174
    v_exp_f32 v175, v175
    v_mfma_f32_32x32x16_bf16 v[144:159], v[212:215], v[60:63], v[144:159]
    buffer_load_dwordx4 v[200:203], v1, s[4:7], s69 offen offset:2048 sc1
    v_exp_f32 v128, v128
    v_exp_f32 v129, v129
    v_exp_f32 v130, v130
    v_exp_f32 v131, v131
    v_smfmac_f32_32x32x32_bf16 v[80:95], v[220:223], v[168:175], v246
    v_exp_f32 v132, v132
    v_exp_f32 v133, v133
    v_exp_f32 v134, v134
    v_exp_f32_e64 v135, v135
    s_waitcnt vmcnt(17)
    v_mfma_f32_32x32x16_bf16 v[160:175], v[224:227], v[32:35], 0
    s_add_u32 s68, s68, 4096
    buffer_load_dwordx4 a[172:175], v1, s[4:7], s68 offen offset:0 sc1
    v_exp_f32 v136, v136
    v_exp_f32 v137, v137
    v_exp_f32 v138, v138
    v_exp_f32 v139, v139
    v_smfmac_f32_32x32x32_bf16 v[96:111], v[216:219], v[128:135], v246
    v_exp_f32 v140, v140
    v_exp_f32 v141, v141
    v_exp_f32 v142, v142
    v_exp_f32 v143, v143
    v_mfma_f32_32x32x16_bf16 v[160:175], v[228:231], v[36:39], v[160:175]
    buffer_load_dwordx4 v[204:207], v1, s[4:7], s69 offen offset:3072 sc1
    v_exp_f32 v144, v144
    v_exp_f32 v145, v145
    v_exp_f32 v146, v146
    v_exp_f32 v147, v147
    v_smfmac_f32_32x32x32_bf16 v[96:111], v[220:223], v[136:143], v246
    v_exp_f32 v148, v148
    v_exp_f32 v149, v149
    v_exp_f32 v150, v150
    v_exp_f32 v151, v151
    v_mfma_f32_32x32x16_bf16 v[128:143], v[224:227], v[40:43], 0
    v_exp_f32 v152, v152
    v_exp_f32 v153, v153
    v_exp_f32 v154, v154
    v_exp_f32 v155, v155
    v_smfmac_f32_32x32x32_bf16 v[112:127], v[216:219], v[144:151], v246
    v_exp_f32 v156, v156
    v_exp_f32 v157, v157
    v_exp_f32 v158, v158
    v_exp_f32 v159, v159
    v_mfma_f32_32x32x16_bf16 v[128:143], v[228:231], v[44:47], v[128:143]
    v_exp_f32 v160, v160
    v_exp_f32 v161, v161
    v_exp_f32 v162, v162
    v_exp_f32 v163, v163
    v_smfmac_f32_32x32x32_bf16 v[112:127], v[220:223], v[152:159], v246
    s_xor_b32 s69, s64, 196608
    buffer_load_dwordx4 v[208:211], v1, s[4:7], s69 offen offset:0 sc1
    v_exp_f32 v164, v164
    v_exp_f32 v165, v165
    v_exp_f32 v166, v166
    v_exp_f32 v167, v167
    v_mfma_f32_32x32x16_bf16 v[144:159], v[224:227], v[48:51], 0
    s_add_u32 m0, s50, 16384
    s_add_u32 s67, s31, 14336
    buffer_load_dwordx4 v15, s[4:7], s67 offen sc1 lds
    v_exp_f32 v168, v168
    v_exp_f32 v169, v169
    v_exp_f32 v170, v170
    v_exp_f32_e64 v171, v171
    s_waitcnt vmcnt(18)
    v_smfmac_f32_32x32x32_bf16 v[64:79], v[232:235], v[160:167], v246
    buffer_load_dwordx4 a[176:179], v1, s[4:7], s68 offen offset:1024 sc1
    v_exp_f32 v172, v172
    v_exp_f32 v173, v173
    v_exp_f32 v174, v174
    v_exp_f32 v175, v175
    v_mfma_f32_32x32x16_bf16 v[144:159], v[228:231], v[52:55], v[144:159]
    buffer_load_dwordx4 v[212:215], v1, s[4:7], s69 offen offset:1024 sc1
    v_exp_f32 v128, v128
    v_exp_f32 v129, v129
    v_exp_f32 v130, v130
    v_exp_f32 v131, v131
    v_smfmac_f32_32x32x32_bf16 v[64:79], v[236:239], v[168:175], v246
    v_exp_f32 v132, v132
    v_exp_f32 v133, v133
    v_exp_f32 v134, v134
    v_exp_f32 v135, v135
    v_mfma_f32_32x32x16_bf16 v[160:175], v[224:227], v[56:59], 0
    v_exp_f32 v136, v136
    v_exp_f32 v137, v137
    v_exp_f32 v138, v138
    v_exp_f32 v139, v139
    v_smfmac_f32_32x32x32_bf16 v[80:95], v[232:235], v[128:135], v246
    v_exp_f32 v140, v140
    v_exp_f32 v141, v141
    v_exp_f32 v142, v142
    v_exp_f32 v143, v143
    v_mfma_f32_32x32x16_bf16 v[160:175], v[228:231], v[60:63], v[160:175]
    buffer_load_dwordx4 v[216:219], v1, s[4:7], s69 offen offset:2048 sc1
    v_exp_f32 v144, v144
    v_exp_f32 v145, v145
    v_exp_f32 v146, v146
    v_exp_f32 v147, v147
    v_smfmac_f32_32x32x32_bf16 v[80:95], v[236:239], v[136:143], v246
    v_exp_f32 v148, v148
    v_exp_f32 v149, v149
    v_exp_f32 v150, v150
    v_exp_f32_e64 v151, v151
    s_waitcnt vmcnt(16)
    v_mfma_f32_32x32x16_bf16 v[128:143], v[176:179], v[32:35], 0
    buffer_load_dwordx4 a[180:183], v1, s[4:7], s68 offen offset:2048 sc1
    v_exp_f32 v152, v152
    v_exp_f32 v153, v153
    v_exp_f32 v154, v154
    v_exp_f32 v155, v155
    v_smfmac_f32_32x32x32_bf16 v[96:111], v[232:235], v[144:151], v246
    v_exp_f32 v156, v156
    v_exp_f32 v157, v157
    v_exp_f32 v158, v158
    v_exp_f32 v159, v159
    v_mfma_f32_32x32x16_bf16 v[128:143], v[180:183], v[36:39], v[128:143]
    buffer_load_dwordx4 v[220:223], v1, s[4:7], s69 offen offset:3072 sc1
    v_exp_f32 v160, v160
    v_exp_f32 v161, v161
    v_exp_f32 v162, v162
    v_exp_f32 v163, v163
    v_smfmac_f32_32x32x32_bf16 v[96:111], v[236:239], v[152:159], v246
    v_exp_f32 v164, v164
    v_exp_f32 v165, v165
    v_exp_f32 v166, v166
    v_exp_f32 v167, v167
    v_mfma_f32_32x32x16_bf16 v[144:159], v[176:179], v[40:43], 0
    s_add_u32 m0, s50, 20480
    s_add_u32 s67, s31, 17920
    buffer_load_dwordx4 v15, s[4:7], s67 offen sc1 lds
    v_exp_f32 v168, v168
    v_exp_f32 v169, v169
    v_exp_f32 v170, v170
    v_exp_f32 v171, v171
    v_smfmac_f32_32x32x32_bf16 v[112:127], v[232:235], v[160:167], v246
    v_exp_f32 v172, v172
    v_exp_f32 v173, v173
    v_exp_f32 v174, v174
    v_exp_f32 v175, v175
    v_mfma_f32_32x32x16_bf16 v[144:159], v[180:183], v[44:47], v[144:159]
    v_exp_f32 v128, v128
    v_exp_f32 v129, v129
    v_exp_f32 v130, v130
    v_exp_f32 v131, v131
    v_smfmac_f32_32x32x32_bf16 v[112:127], v[236:239], v[168:175], v246
    s_xor_b32 s69, s64, 212992
    buffer_load_dwordx4 v[224:227], v1, s[4:7], s69 offen offset:0 sc1
    v_exp_f32 v132, v132
    v_exp_f32 v133, v133
    v_exp_f32 v134, v134
    v_exp_f32 v135, v135
    v_mfma_f32_32x32x16_bf16 v[160:175], v[176:179], v[48:51], 0
    s_add_u32 s68, s14, 2
    s_and_b32 s68, s68, 3
    s_add_u32 s68, s68, 0
    s_mul_i32 s68, s68, 7168
    s_add_u32 s68, s68, s49
    buffer_load_dwordx4 a[184:187], v1, s[4:7], s68 offen offset:0 sc1
    v_exp_f32 v136, v136
    v_exp_f32 v137, v137
    v_exp_f32 v138, v138
    v_exp_f32_e64 v139, v139
    s_waitcnt vmcnt(17)
    v_smfmac_f32_32x32x32_bf16 v[64:79], v[184:187], v[128:135], v246
    v_exp_f32 v140, v140
    v_exp_f32 v141, v141
    v_exp_f32 v142, v142
    v_exp_f32 v143, v143
    v_mfma_f32_32x32x16_bf16 v[160:175], v[180:183], v[52:55], v[160:175]
    buffer_load_dwordx4 v[228:231], v1, s[4:7], s69 offen offset:1024 sc1
    v_exp_f32 v144, v144
    v_exp_f32 v145, v145
    v_exp_f32 v146, v146
    v_exp_f32 v147, v147
    v_smfmac_f32_32x32x32_bf16 v[64:79], v[188:191], v[136:143], v246
    v_exp_f32 v148, v148
    v_exp_f32 v149, v149
    v_exp_f32 v150, v150
    v_exp_f32 v151, v151
    v_mfma_f32_32x32x16_bf16 v[128:143], v[176:179], v[56:59], 0
    buffer_load_dwordx4 a[188:191], v1, s[4:7], s68 offen offset:1024 sc1
    v_exp_f32 v152, v152
    v_exp_f32 v153, v153
    v_exp_f32 v154, v154
    v_exp_f32 v155, v155
    v_smfmac_f32_32x32x32_bf16 v[80:95], v[184:187], v[144:151], v246
    v_exp_f32 v156, v156
    v_exp_f32 v157, v157
    v_exp_f32 v158, v158
    v_exp_f32 v159, v159
    v_mfma_f32_32x32x16_bf16 v[128:143], v[180:183], v[60:63], v[128:143]
    buffer_load_dwordx4 v[232:235], v1, s[4:7], s69 offen offset:2048 sc1
    v_exp_f32 v160, v160
    v_exp_f32 v161, v161
    v_exp_f32 v162, v162
    v_exp_f32 v163, v163
    v_smfmac_f32_32x32x32_bf16 v[80:95], v[188:191], v[152:159], v246
    v_exp_f32 v164, v164
    v_exp_f32 v165, v165
    v_exp_f32 v166, v166
    v_exp_f32_e64 v167, v167
    s_waitcnt vmcnt(17)
    v_mfma_f32_32x32x16_bf16 v[144:159], v[192:195], v[32:35], 0
    s_add_u32 m0, s50, 24576
    s_add_u32 s67, s31, 21504
    buffer_load_dwordx4 v15, s[4:7], s67 offen sc1 lds
    v_exp_f32 v168, v168
    v_exp_f32 v169, v169
    v_exp_f32 v170, v170
    v_exp_f32 v171, v171
    v_smfmac_f32_32x32x32_bf16 v[96:111], v[184:187], v[160:167], v246
    v_exp_f32 v172, v172
    v_exp_f32 v173, v173
    v_exp_f32 v174, v174
    v_exp_f32 v175, v175
    v_mfma_f32_32x32x16_bf16 v[144:159], v[196:199], v[36:39], v[144:159]
    buffer_load_dwordx4 v[236:239], v1, s[4:7], s69 offen offset:3072 sc1
    v_exp_f32 v128, v128
    v_exp_f32 v129, v129
    v_exp_f32 v130, v130
    v_exp_f32 v131, v131
    v_smfmac_f32_32x32x32_bf16 v[96:111], v[188:191], v[168:175], v246
    v_exp_f32 v132, v132
    v_exp_f32 v133, v133
    v_exp_f32 v134, v134
    v_exp_f32 v135, v135
    v_mfma_f32_32x32x16_bf16 v[160:175], v[192:195], v[40:43], 0
    buffer_load_dwordx4 a[192:195], v1, s[4:7], s68 offen offset:2048 sc1
    v_exp_f32 v136, v136
    v_exp_f32 v137, v137
    v_exp_f32 v138, v138
    v_exp_f32 v139, v139
    v_smfmac_f32_32x32x32_bf16 v[112:127], v[184:187], v[128:135], v246
    v_exp_f32 v140, v140
    v_exp_f32 v141, v141
    v_exp_f32 v142, v142
    v_exp_f32 v143, v143
    v_mfma_f32_32x32x16_bf16 v[160:175], v[196:199], v[44:47], v[160:175]
    v_exp_f32 v144, v144
    v_exp_f32 v145, v145
    v_exp_f32 v146, v146
    v_exp_f32 v147, v147
    v_smfmac_f32_32x32x32_bf16 v[112:127], v[188:191], v[136:143], v246
    s_xor_b32 s69, s64, 229376
    buffer_load_dwordx4 v[176:179], v1, s[4:7], s69 offen offset:0 sc1
    v_exp_f32 v148, v148
    v_exp_f32 v149, v149
    v_exp_f32 v150, v150
    v_exp_f32 v151, v151
    v_mfma_f32_32x32x16_bf16 v[128:143], v[192:195], v[48:51], 0
    v_exp_f32 v152, v152
    v_exp_f32 v153, v153
    v_exp_f32 v154, v154
    v_exp_f32_e64 v155, v155
    s_waitcnt vmcnt(17)
    v_smfmac_f32_32x32x32_bf16 v[64:79], v[200:203], v[144:151], v246
    v_exp_f32 v156, v156
    v_exp_f32 v157, v157
    v_exp_f32 v158, v158
    v_exp_f32 v159, v159
    v_mfma_f32_32x32x16_bf16 v[128:143], v[196:199], v[52:55], v[128:143]
    buffer_load_dwordx4 v[180:183], v1, s[4:7], s69 offen offset:1024 sc1
    v_exp_f32 v160, v160
    v_exp_f32 v161, v161
    v_exp_f32 v162, v162
    v_exp_f32 v163, v163
    v_smfmac_f32_32x32x32_bf16 v[64:79], v[204:207], v[152:159], v246
    v_exp_f32 v164, v164
    v_exp_f32 v165, v165
    v_exp_f32 v166, v166
    v_exp_f32 v167, v167
    v_mfma_f32_32x32x16_bf16 v[144:159], v[192:195], v[56:59], 0
    s_add_u32 m0, s50, 28672
    s_add_u32 s67, s31, 25088
    buffer_load_dwordx4 v15, s[4:7], s67 offen sc1 lds
    v_exp_f32 v168, v168
    v_exp_f32 v169, v169
    v_exp_f32 v170, v170
    v_exp_f32 v171, v171
    v_smfmac_f32_32x32x32_bf16 v[80:95], v[200:203], v[160:167], v246
    buffer_load_dwordx4 a[196:199], v1, s[4:7], s68 offen offset:3072 sc1
    v_exp_f32 v172, v172
    v_exp_f32 v173, v173
    v_exp_f32 v174, v174
    v_exp_f32 v175, v175
    v_mfma_f32_32x32x16_bf16 v[144:159], v[196:199], v[60:63], v[144:159]
    buffer_load_dwordx4 v[184:187], v1, s[4:7], s69 offen offset:2048 sc1
    v_exp_f32 v128, v128
    v_exp_f32 v129, v129
    v_exp_f32 v130, v130
    v_exp_f32 v131, v131
    v_smfmac_f32_32x32x32_bf16 v[80:95], v[204:207], v[168:175], v246
    v_exp_f32 v132, v132
    v_exp_f32 v133, v133
    v_exp_f32 v134, v134
    v_exp_f32_e64 v135, v135
    s_waitcnt vmcnt(17)
    v_mfma_f32_32x32x16_bf16 v[160:175], v[208:211], v[32:35], 0
    v_exp_f32 v136, v136
    v_exp_f32 v137, v137
    v_exp_f32 v138, v138
    v_exp_f32 v139, v139
    v_smfmac_f32_32x32x32_bf16 v[96:111], v[200:203], v[128:135], v246
    v_exp_f32 v140, v140
    v_exp_f32 v141, v141
    v_exp_f32 v142, v142
    v_exp_f32 v143, v143
    v_mfma_f32_32x32x16_bf16 v[160:175], v[212:215], v[36:39], v[160:175]
    buffer_load_dwordx4 v[188:191], v1, s[4:7], s69 offen offset:3072 sc1
    v_exp_f32 v144, v144
    v_exp_f32 v145, v145
    v_exp_f32 v146, v146
    v_exp_f32 v147, v147
    v_smfmac_f32_32x32x32_bf16 v[96:111], v[204:207], v[136:143], v246
    v_exp_f32 v148, v148
    v_exp_f32 v149, v149
    v_exp_f32 v150, v150
    v_exp_f32 v151, v151
    v_mfma_f32_32x32x16_bf16 v[128:143], v[208:211], v[40:43], 0
    s_add_u32 s68, s68, 4096
    buffer_load_dwordx4 a[200:203], v1, s[4:7], s68 offen offset:0 sc1
    v_exp_f32 v152, v152
    v_exp_f32 v153, v153
    v_exp_f32 v154, v154
    v_exp_f32 v155, v155
    v_smfmac_f32_32x32x32_bf16 v[112:127], v[200:203], v[144:151], v246
    v_exp_f32 v156, v156
    v_exp_f32 v157, v157
    v_exp_f32 v158, v158
    v_exp_f32 v159, v159
    v_mfma_f32_32x32x16_bf16 v[128:143], v[212:215], v[44:47], v[128:143]
    v_exp_f32 v160, v160
    v_exp_f32 v161, v161
    v_exp_f32 v162, v162
    v_exp_f32 v163, v163
    v_smfmac_f32_32x32x32_bf16 v[112:127], v[204:207], v[152:159], v246
    s_xor_b32 s69, s64, 245760
    buffer_load_dwordx4 v[192:195], v1, s[4:7], s69 offen offset:0 sc1
    v_exp_f32 v164, v164
    v_exp_f32 v165, v165
    v_exp_f32 v166, v166
    v_exp_f32 v167, v167
    v_mfma_f32_32x32x16_bf16 v[144:159], v[208:211], v[48:51], 0
    s_add_u32 m0, s50, 32768
    s_add_u32 s67, s31, 28672
    buffer_load_dwordx4 v15, s[4:7], s67 offen sc1 lds
    v_exp_f32 v168, v168
    v_exp_f32 v169, v169
    v_exp_f32 v170, v170
    v_exp_f32_e64 v171, v171
    s_waitcnt vmcnt(18)
    v_smfmac_f32_32x32x32_bf16 v[64:79], v[216:219], v[160:167], v246
    v_exp_f32 v172, v172
    v_exp_f32 v173, v173
    v_exp_f32 v174, v174
    v_exp_f32 v175, v175
    v_mfma_f32_32x32x16_bf16 v[144:159], v[212:215], v[52:55], v[144:159]
    buffer_load_dwordx4 v[196:199], v1, s[4:7], s69 offen offset:1024 sc1
    v_exp_f32 v128, v128
    v_exp_f32 v129, v129
    v_exp_f32 v130, v130
    v_exp_f32 v131, v131
    v_smfmac_f32_32x32x32_bf16 v[64:79], v[220:223], v[168:175], v246
    v_exp_f32 v132, v132
    v_exp_f32 v133, v133
    v_exp_f32 v134, v134
    v_exp_f32 v135, v135
    v_mfma_f32_32x32x16_bf16 v[160:175], v[208:211], v[56:59], 0
    buffer_load_dwordx4 a[204:207], v1, s[4:7], s68 offen offset:1024 sc1
    v_exp_f32 v136, v136
    v_exp_f32 v137, v137
    v_exp_f32 v138, v138
    v_exp_f32 v139, v139
    v_smfmac_f32_32x32x32_bf16 v[80:95], v[216:219], v[128:135], v246
    v_exp_f32 v140, v140
    v_exp_f32 v141, v141
    v_exp_f32 v142, v142
    v_exp_f32 v143, v143
    v_mfma_f32_32x32x16_bf16 v[160:175], v[212:215], v[60:63], v[160:175]
    buffer_load_dwordx4 v[200:203], v1, s[4:7], s69 offen offset:2048 sc1
    v_exp_f32 v144, v144
    v_exp_f32 v145, v145
    v_exp_f32 v146, v146
    v_exp_f32 v147, v147
    v_smfmac_f32_32x32x32_bf16 v[80:95], v[220:223], v[136:143], v246
    v_exp_f32 v148, v148
    v_exp_f32 v149, v149
    v_exp_f32 v150, v150
    v_exp_f32_e64 v151, v151
    s_waitcnt vmcnt(17)
    v_mfma_f32_32x32x16_bf16 v[128:143], v[224:227], v[32:35], 0
    v_exp_f32 v152, v152
    v_exp_f32 v153, v153
    v_exp_f32 v154, v154
    v_exp_f32 v155, v155
    v_smfmac_f32_32x32x32_bf16 v[96:111], v[216:219], v[144:151], v246
    v_exp_f32 v156, v156
    v_exp_f32 v157, v157
    v_exp_f32 v158, v158
    v_exp_f32 v159, v159
    v_mfma_f32_32x32x16_bf16 v[128:143], v[228:231], v[36:39], v[128:143]
    buffer_load_dwordx4 v[204:207], v1, s[4:7], s69 offen offset:3072 sc1
    v_exp_f32 v160, v160
    v_exp_f32 v161, v161
    v_exp_f32 v162, v162
    v_exp_f32 v163, v163
    v_smfmac_f32_32x32x32_bf16 v[96:111], v[220:223], v[152:159], v246
    v_exp_f32 v164, v164
    v_exp_f32 v165, v165
    v_exp_f32 v166, v166
    v_exp_f32 v167, v167
    v_mfma_f32_32x32x16_bf16 v[144:159], v[224:227], v[40:43], 0
    s_add_u32 m0, s50, 36864
    s_add_u32 s67, s31, 32256
    buffer_load_dwordx4 v15, s[4:7], s67 offen sc1 lds
    v_exp_f32 v168, v168
    v_exp_f32 v169, v169
    v_exp_f32 v170, v170
    v_exp_f32 v171, v171
    v_smfmac_f32_32x32x32_bf16 v[112:127], v[216:219], v[160:167], v246
    buffer_load_dwordx4 a[208:211], v1, s[4:7], s68 offen offset:2048 sc1
    v_exp_f32 v172, v172
    v_exp_f32 v173, v173
    v_exp_f32 v174, v174
    v_exp_f32 v175, v175
    v_mfma_f32_32x32x16_bf16 v[144:159], v[228:231], v[44:47], v[144:159]
    v_exp_f32 v128, v128
    v_exp_f32 v129, v129
    v_exp_f32 v130, v130
    v_exp_f32 v131, v131
    v_smfmac_f32_32x32x32_bf16 v[112:127], v[220:223], v[168:175], v246
    s_xor_b32 s69, s39, 16384
    buffer_load_dwordx4 v[208:211], v1, s[4:7], s69 offen offset:0 sc1
    v_exp_f32 v132, v132
    v_exp_f32 v133, v133
    v_exp_f32 v134, v134
    v_exp_f32 v135, v135
    v_mfma_f32_32x32x16_bf16 v[160:175], v[224:227], v[48:51], 0
    v_exp_f32 v136, v136
    v_exp_f32 v137, v137
    v_exp_f32 v138, v138
    v_exp_f32_e64 v139, v139
    s_waitcnt vmcnt(17)
    v_smfmac_f32_32x32x32_bf16 v[64:79], v[232:235], v[128:135], v246
    v_exp_f32 v140, v140
    v_exp_f32 v141, v141
    v_exp_f32 v142, v142
    v_exp_f32 v143, v143
    v_mfma_f32_32x32x16_bf16 v[160:175], v[228:231], v[52:55], v[160:175]
    buffer_load_dwordx4 v[212:215], v1, s[4:7], s69 offen offset:1024 sc1
    v_exp_f32 v144, v144
    v_exp_f32 v145, v145
    v_exp_f32 v146, v146
    v_exp_f32 v147, v147
    v_smfmac_f32_32x32x32_bf16 v[64:79], v[236:239], v[136:143], v246
    v_exp_f32 v148, v148
    v_exp_f32 v149, v149
    v_exp_f32 v150, v150
    v_exp_f32 v151, v151
    v_mfma_f32_32x32x16_bf16 v[128:143], v[224:227], v[56:59], 0
    s_add_u32 s68, s14, 3
    s_and_b32 s68, s68, 3
    s_add_u32 s68, s68, 0
    s_mul_i32 s68, s68, 7168
    s_add_u32 s68, s68, s49
    buffer_load_dwordx4 a[212:215], v1, s[4:7], s68 offen offset:0 sc1
    v_exp_f32 v152, v152
    v_exp_f32 v153, v153
    v_exp_f32 v154, v154
    v_exp_f32 v155, v155
    v_smfmac_f32_32x32x32_bf16 v[80:95], v[232:235], v[144:151], v246
    v_exp_f32 v156, v156
    v_exp_f32 v157, v157
    v_exp_f32 v158, v158
    v_exp_f32 v159, v159
    v_mfma_f32_32x32x16_bf16 v[128:143], v[228:231], v[60:63], v[128:143]
    buffer_load_dwordx4 v[216:219], v1, s[4:7], s69 offen offset:2048 sc1
    v_exp_f32 v160, v160
    v_exp_f32 v161, v161
    v_exp_f32 v162, v162
    v_exp_f32 v163, v163
    v_smfmac_f32_32x32x32_bf16 v[80:95], v[236:239], v[152:159], v246
    v_exp_f32 v164, v164
    v_exp_f32 v165, v165
    v_exp_f32 v166, v166
    v_exp_f32_e64 v167, v167
    s_waitcnt vmcnt(17)
    v_mfma_f32_32x32x16_bf16 v[144:159], v[176:179], v[32:35], 0
    s_add_u32 m0, s50, 40960
    s_add_u32 s67, s31, 35840
    buffer_load_dwordx4 v15, s[4:7], s67 offen sc1 lds
    v_exp_f32 v168, v168
    v_exp_f32 v169, v169
    v_exp_f32 v170, v170
    v_exp_f32 v171, v171
    v_smfmac_f32_32x32x32_bf16 v[96:111], v[232:235], v[160:167], v246
    buffer_load_dwordx4 a[216:219], v1, s[4:7], s68 offen offset:1024 sc1
    v_exp_f32 v172, v172
    v_exp_f32 v173, v173
    v_exp_f32 v174, v174
    v_exp_f32 v175, v175
    v_mfma_f32_32x32x16_bf16 v[144:159], v[180:183], v[36:39], v[144:159]
    buffer_load_dwordx4 v[220:223], v1, s[4:7], s69 offen offset:3072 sc1
    v_exp_f32 v128, v128
    v_exp_f32 v129, v129
    v_exp_f32 v130, v130
    v_exp_f32 v131, v131
    v_smfmac_f32_32x32x32_bf16 v[96:111], v[236:239], v[168:175], v246
    v_exp_f32 v132, v132
    v_exp_f32 v133, v133
    v_exp_f32 v134, v134
    v_exp_f32 v135, v135
    v_mfma_f32_32x32x16_bf16 v[160:175], v[176:179], v[40:43], 0
    v_and_b32 v2, 15, v0
    v_lshlrev_b32 v2, 7, v2
    s_mul_i32 s67, s13, 1792
    s_add_u32 s67, s67, s33
    v_mov_b32 v3, s67
    v_mov_b32_e64 v4, s35
    v_cndmask_b32 v3, v3, v4, s[54:55]
    s_and_b32 s67, s60, 1
    s_lshl_b32 s67, s67, 8
    s_add_u32 s67, s67, s58
    v_add_u32 v2, v2, v3
    v_writelane_b32 v2, s67, 16
    s_add_u32 s67, s67, 128
    v_writelane_b32 v2, s67, 17
    buffer_load_dword v6, v2, s[4:7], 0 offen sc1
    v_exp_f32 v136, v136
    v_exp_f32 v137, v137
    v_exp_f32 v138, v138
    v_exp_f32 v139, v139
    v_smfmac_f32_32x32x32_bf16 v[112:127], v[232:235], v[128:135], v246
    v_exp_f32 v140, v140
    v_exp_f32 v141, v141
    v_exp_f32 v142, v142
    v_exp_f32 v143, v143
    v_mfma_f32_32x32x16_bf16 v[160:175], v[180:183], v[44:47], v[160:175]
    v_exp_f32 v144, v144
    v_exp_f32 v145, v145
    v_exp_f32 v146, v146
    v_exp_f32 v147, v147
    v_smfmac_f32_32x32x32_bf16 v[112:127], v[236:239], v[136:143], v246
    v_exp_f32 v148, v148
    v_exp_f32 v149, v149
    v_exp_f32 v150, v150
    v_exp_f32 v151, v151
    v_mfma_f32_32x32x16_bf16 v[128:143], v[176:179], v[48:51], 0
    buffer_load_dwordx4 a[220:223], v1, s[4:7], s68 offen offset:2048 sc1
    s_getpc_b64 s[28:29]
L_pc_30:
    s_lshr_b32 s67, s2, 3
    s_lshl_b32 s67, s67, 2
    s_add_u32 s67, s67, s14
    s_lshl_b32 s67, s67, 7
    s_add_u32 s67, s67, 1024
    s_min_u32 s67, s67, interleave_layers__linear_kernel_hedgehog__mha_block__prompt_kernel_last-L_pc_30-4
    v_mov_b32 v2, s67
    global_load_dword v6, v2, s[28:29]
    v_exp_f32 v152, v152
    v_exp_f32 v153, v153
    v_exp_f32 v154, v154
    v_exp_f32_e64 v155, v155
    s_waitcnt vmcnt(19)
    v_smfmac_f32_32x32x32_bf16 v[64:79], v[184:187], v[144:151], v246
    v_exp_f32 v156, v156
    v_exp_f32 v157, v157
    v_exp_f32 v158, v158
    v_exp_f32 v159, v159
    v_mfma_f32_32x32x16_bf16 v[128:143], v[180:183], v[52:55], v[128:143]
    v_exp_f32 v160, v160
    v_exp_f32 v161, v161
    v_exp_f32 v162, v162
    v_exp_f32 v163, v163
    v_smfmac_f32_32x32x32_bf16 v[64:79], v[188:191], v[152:159], v246
    v_exp_f32 v164, v164
    v_exp_f32 v165, v165
    v_exp_f32 v166, v166
    v_exp_f32 v167, v167
    v_mfma_f32_32x32x16_bf16 v[144:159], v[176:179], v[56:59], 0
    s_add_u32 m0, s50, 45056
    s_add_u32 s67, s31, 39424
    buffer_load_dwordx4 v15, s[4:7], s67 offen sc1 lds
    v_exp_f32 v168, v168
    v_exp_f32 v169, v169
    v_exp_f32 v170, v170
    v_exp_f32 v171, v171
    v_smfmac_f32_32x32x32_bf16 v[80:95], v[184:187], v[160:167], v246
    v_exp_f32 v172, v172
    v_exp_f32 v173, v173
    v_exp_f32 v174, v174
    v_exp_f32 v175, v175
    v_mfma_f32_32x32x16_bf16 v[144:159], v[180:183], v[60:63], v[144:159]
    v_exp_f32 v128, v128
    v_exp_f32 v129, v129
    v_exp_f32 v130, v130
    v_exp_f32 v131, v131
    v_smfmac_f32_32x32x32_bf16 v[80:95], v[188:191], v[168:175], v246
    v_exp_f32 v132, v132
    v_exp_f32 v133, v133
    v_exp_f32 v134, v134
    v_exp_f32_e64 v135, v135
    s_waitcnt vmcnt(16)
    v_mfma_f32_32x32x16_bf16 v[160:175], v[192:195], v[32:35], 0
    buffer_load_dwordx4 a[224:227], v1, s[4:7], s68 offen offset:3072 sc1
    v_exp_f32 v136, v136
    v_exp_f32 v137, v137
    v_exp_f32 v138, v138
    v_exp_f32 v139, v139
    v_smfmac_f32_32x32x32_bf16 v[96:111], v[184:187], v[128:135], v246
    v_exp_f32 v140, v140
    v_exp_f32 v141, v141
    v_exp_f32 v142, v142
    v_exp_f32 v143, v143
    v_mfma_f32_32x32x16_bf16 v[160:175], v[196:199], v[36:39], v[160:175]
    v_exp_f32 v144, v144
    v_exp_f32 v145, v145
    v_exp_f32 v146, v146
    v_exp_f32 v147, v147
    v_smfmac_f32_32x32x32_bf16 v[96:111], v[188:191], v[136:143], v246
    v_exp_f32 v148, v148
    v_exp_f32 v149, v149
    v_exp_f32 v150, v150
    v_exp_f32_e64 v151, v151
    s_waitcnt vmcnt(10)
    v_mfma_f32_32x32x16_bf16 v[128:143], v[208:211], v[32:35], 0
    v_exp_f32 v152, v152
    v_exp_f32 v153, v153
    v_exp_f32 v154, v154
    v_exp_f32 v155, v155
    v_smfmac_f32_32x32x32_bf16 v[112:127], v[184:187], v[144:151], v246
    v_exp_f32 v156, v156
    v_exp_f32 v157, v157
    v_exp_f32 v158, v158
    v_exp_f32 v159, v159
    v_mfma_f32_32x32x16_bf16 v[128:143], v[212:215], v[36:39], v[128:143]
    v_exp_f32 v160, v160
    v_exp_f32 v161, v161
    v_exp_f32 v162, v162
    v_exp_f32 v163, v163
    v_smfmac_f32_32x32x32_bf16 v[112:127], v[188:191], v[152:159], v246
    v_exp_f32 v164, v164
    v_exp_f32 v165, v165
    v_exp_f32 v166, v166
    v_exp_f32 v167, v167
    v_mfma_f32_32x32x16_bf16 v[144:159], v[192:195], v[40:43], 0
    s_add_u32 m0, s50, 49152
    s_add_u32 s67, s31, 43008
    buffer_load_dwordx4 v15, s[4:7], s67 offen sc1 lds
    v_exp_f32 v168, v168
    v_exp_f32 v169, v169
    v_exp_f32 v170, v170
    v_exp_f32 v171, v171
    v_smfmac_f32_32x32x32_bf16 v[64:79], v[200:203], v[160:167], v246
    s_add_u32 s68, s68, 4096
    buffer_load_dwordx4 a[228:231], v1, s[4:7], s68 offen offset:0 sc1
    v_exp_f32 v172, v172
    v_exp_f32 v173, v173
    v_exp_f32 v174, v174
    v_exp_f32 v175, v175
    v_mfma_f32_32x32x16_bf16 v[144:159], v[196:199], v[44:47], v[144:159]
    v_exp_f32 v128, v128
    v_exp_f32 v129, v129
    v_exp_f32 v130, v130
    v_exp_f32 v131, v131
    v_smfmac_f32_32x32x32_bf16 v[64:79], v[204:207], v[168:175], v246
    v_exp_f32 v132, v132
    v_exp_f32 v133, v133
    v_exp_f32 v134, v134
    v_exp_f32 v135, v135
    v_mfma_f32_32x32x16_bf16 v[160:175], v[208:211], v[40:43], 0
    v_exp_f32 v136, v136
    v_exp_f32 v137, v137
    v_exp_f32 v138, v138
    v_exp_f32_e64 v139, v139
    s_waitcnt vmcnt(7)
    v_smfmac_f32_32x32x32_bf16 v[64:79], v[216:219], v[128:135], v246
    v_exp_f32 v140, v140
    v_exp_f32 v141, v141
    v_exp_f32 v142, v142
    v_exp_f32 v143, v143
    v_mfma_f32_32x32x16_bf16 v[160:175], v[212:215], v[44:47], v[160:175]
    v_exp_f32 v144, v144
    v_exp_f32 v145, v145
    v_exp_f32 v146, v146
    v_exp_f32 v147, v147
    v_smfmac_f32_32x32x32_bf16 v[64:79], v[220:223], v[136:143], v246
    v_exp_f32 v148, v148
    v_exp_f32 v149, v149
    v_exp_f32 v150, v150
    v_exp_f32 v151, v151
    v_mfma_f32_32x32x16_bf16 v[128:143], v[192:195], v[48:51], 0
    buffer_load_dwordx4 a[232:235], v1, s[4:7], s68 offen offset:1024 sc1
    v_exp_f32 v152, v152
    v_exp_f32 v153, v153
    v_exp_f32 v154, v154
    v_exp_f32 v155, v155
    v_smfmac_f32_32x32x32_bf16 v[80:95], v[200:203], v[144:151], v246
    v_exp_f32 v156, v156
    v_exp_f32 v157, v157
    v_exp_f32 v158, v158
    v_exp_f32 v159, v159
    v_mfma_f32_32x32x16_bf16 v[128:143], v[196:199], v[52:55], v[128:143]
    v_exp_f32 v160, v160
    v_exp_f32 v161, v161
    v_exp_f32 v162, v162
    v_exp_f32 v163, v163
    v_smfmac_f32_32x32x32_bf16 v[80:95], v[204:207], v[152:159], v246
    v_exp_f32 v164, v164
    v_exp_f32 v165, v165
    v_exp_f32 v166, v166
    v_exp_f32 v167, v167
    v_mfma_f32_32x32x16_bf16 v[144:159], v[208:211], v[48:51], 0
    s_add_u32 m0, s50, 53248
    s_add_u32 s67, s31, 46592
    buffer_load_dwordx4 v15, s[4:7], s67 offen sc1 lds
    ds_write_b128 v251, v[64:67] offset:0
    v_exp_f32 v168, v168
    v_exp_f32 v169, v169
    v_exp_f32 v170, v170
    v_exp_f32 v171, v171
    v_smfmac_f32_32x32x32_bf16 v[80:95], v[216:219], v[160:167], v246
    v_exp_f32 v172, v172
    v_exp_f32 v173, v173
    v_exp_f32 v174, v174
    v_exp_f32 v175, v175
    v_mfma_f32_32x32x16_bf16 v[144:159], v[212:215], v[52:55], v[144:159]
    ds_write_b128 v251, v[68:71] offset:1024
    v_exp_f32 v128, v128
    v_exp_f32 v129, v129
    v_exp_f32 v130, v130
    v_exp_f32 v131, v131
    v_smfmac_f32_32x32x32_bf16 v[80:95], v[220:223], v[168:175], v246
    v_exp_f32 v132, v132
    v_exp_f32 v133, v133
    v_exp_f32 v134, v134
    v_exp_f32 v135, v135
    v_mfma_f32_32x32x16_bf16 v[160:175], v[192:195], v[56:59], 0
    buffer_load_dwordx4 a[236:239], v1, s[4:7], s68 offen offset:2048 sc1
    ds_write_b128 v251, v[72:75] offset:2048
    v_exp_f32 v136, v136
    v_exp_f32 v137, v137
    v_exp_f32 v138, v138
    v_exp_f32 v139, v139
    v_smfmac_f32_32x32x32_bf16 v[96:111], v[200:203], v[128:135], v246
    v_exp_f32 v140, v140
    v_exp_f32 v141, v141
    v_exp_f32 v142, v142
    v_exp_f32 v143, v143
    v_mfma_f32_32x32x16_bf16 v[160:175], v[196:199], v[60:63], v[160:175]
    ds_write_b128 v251, v[76:79] offset:3072
    v_exp_f32 v144, v144
    v_exp_f32 v145, v145
    v_exp_f32 v146, v146
    v_exp_f32 v147, v147
    v_smfmac_f32_32x32x32_bf16 v[96:111], v[204:207], v[136:143], v246
    v_exp_f32 v148, v148
    v_exp_f32 v149, v149
    v_exp_f32 v150, v150
    v_exp_f32 v151, v151
    v_mfma_f32_32x32x16_bf16 v[128:143], v[208:211], v[56:59], 0
    ds_write_b128 v252, v[80:83] offset:0
    v_exp_f32 v152, v152
    v_exp_f32 v153, v153
    v_exp_f32 v154, v154
    v_exp_f32 v155, v155
    v_smfmac_f32_32x32x32_bf16 v[96:111], v[216:219], v[144:151], v246
    v_exp_f32 v156, v156
    v_exp_f32 v157, v157
    v_exp_f32 v158, v158
    v_exp_f32 v159, v159
    v_mfma_f32_32x32x16_bf16 v[128:143], v[212:215], v[60:63], v[128:143]
    ds_write_b128 v252, v[84:87] offset:1024
    v_exp_f32 v160, v160
    v_exp_f32 v161, v161
    v_exp_f32 v162, v162
    v_exp_f32 v163, v163
    v_smfmac_f32_32x32x32_bf16 v[96:111], v[220:223], v[152:159], v246
    v_exp_f32 v164, v164
    v_exp_f32 v165, v165
    v_exp_f32 v166, v166
    v_exp_f32 v167, v167
    ds_write_b128 v252, v[88:91] offset:2048
    v_exp_f32 v168, v168
    v_exp_f32 v169, v169
    v_exp_f32 v170, v170
    v_exp_f32 v171, v171
    v_smfmac_f32_32x32x32_bf16 v[112:127], v[200:203], v[160:167], v246
    v_exp_f32 v172, v172
    v_exp_f32 v173, v173
    v_exp_f32 v174, v174
    v_exp_f32 v175, v175
    ds_write_b128 v252, v[92:95] offset:3072
    v_exp_f32 v128, v128
    v_exp_f32 v129, v129
    v_exp_f32 v130, v130
    v_exp_f32 v131, v131
    v_smfmac_f32_32x32x32_bf16 v[112:127], v[204:207], v[168:175], v246
    v_exp_f32 v132, v132
    v_exp_f32 v133, v133
    v_exp_f32 v134, v134
    v_exp_f32 v135, v135
    ds_write_b128 v253, v[96:99] offset:0
    v_exp_f32 v136, v136
    v_exp_f32 v137, v137
    v_exp_f32 v138, v138
    v_exp_f32 v139, v139
    v_smfmac_f32_32x32x32_bf16 v[112:127], v[216:219], v[128:135], v246
    v_exp_f32 v140, v140
    v_exp_f32 v141, v141
    v_exp_f32 v142, v142
    v_exp_f32 v143, v143
    ds_write_b128 v253, v[100:103] offset:1024
    s_nop 0
    v_smfmac_f32_32x32x32_bf16 v[112:127], v[220:223], v[136:143], v246
    ds_write_b128 v253, v[104:107] offset:2048
    ds_write_b128 v253, v[108:111] offset:3072
    s_lshl_b32 s18, s14, 2
    s_add_u32 s18, s18, 139264
    v_mov_b32_e64 v13, s18
    v_mov_b32 v14, 139264
    v_max3_f32 v2, v76, v92, v108
    s_nop 4
    v_max_f32 v2, v2, v124
    v_cmp_ngt_f32 vcc, 1602224128, v2
    s_nop 0
    s_and_b64 vcc, vcc, s[54:55]
    s_cselect_b32 s18, 1, 0
    v_mov_b32 v3, s18
    ds_write_b32 v13, v3
    s_waitcnt lgkmcnt(0)
    s_barrier
    ds_read_b128 v[2:5], v14
    ds_read_b128 v[64:67], v254 offset:0
    ds_read_b128 v[68:71], v254 offset:1024
    ds_read_b128 v[72:75], v254 offset:2048
    ds_read_b128 v[76:79], v254 offset:3072
    ds_read_b128 v[80:83], v254 offset:4096
    ds_read_b128 v[84:87], v254 offset:5120
    ds_read_b128 v[88:91], v254 offset:6144
    ds_read_b128 v[92:95], v254 offset:7168
    ds_read_b128 v[96:99], v254 offset:8192
    ds_read_b128 v[100:103], v254 offset:9216
    ds_read_b128 v[104:107], v254 offset:10240
    ds_read_b128 v[108:111], v254 offset:11264
    v_accvgpr_read_b32 v128, a112
    v_accvgpr_read_b32 v129, a113
    v_accvgpr_read_b32 v130, a114
    s_waitcnt lgkmcnt(12)
    v_or3_b32 v2, v2, v3, v4
    v_or_b32_e64 v2, v2, v5
    v_cmp_lt_u32 vcc, s70, v2
    s_cbranch_vccnz L_slowmax_31
    s_waitcnt lgkmcnt(8)
    v_pk_add_f32 v[112:113], v[112:113], v[64:65]
    v_pk_add_f32 v[114:115], v[114:115], v[66:67]
    v_pk_add_f32 v[116:117], v[116:117], v[68:69]
    v_pk_add_f32 v[118:119], v[118:119], v[70:71]
    v_pk_add_f32 v[120:121], v[120:121], v[72:73]
    v_pk_add_f32 v[122:123], v[122:123], v[74:75]
    v_pk_add_f32 v[124:125], v[124:125], v[76:77]
    v_pk_add_f32 v[126:127], v[126:127], v[78:79]
    s_waitcnt lgkmcnt(4)
    v_pk_add_f32 v[112:113], v[112:113], v[80:81]
    v_pk_add_f32 v[114:115], v[114:115], v[82:83]
    v_pk_add_f32 v[116:117], v[116:117], v[84:85]
    v_pk_add_f32 v[118:119], v[118:119], v[86:87]
    v_pk_add_f32 v[120:121], v[120:121], v[88:89]
    v_pk_add_f32 v[122:123], v[122:123], v[90:91]
    v_pk_add_f32 v[124:125], v[124:125], v[92:93]
    v_pk_add_f32 v[126:127], v[126:127], v[94:95]
    s_waitcnt lgkmcnt(0)
    v_pk_add_f32 v[112:113], v[112:113], v[96:97]
    v_pk_add_f32 v[114:115], v[114:115], v[98:99]
    v_pk_add_f32 v[116:117], v[116:117], v[100:101]
    v_pk_add_f32 v[118:119], v[118:119], v[102:103]
    v_pk_add_f32 v[120:121], v[120:121], v[104:105]
    v_pk_add_f32 v[122:123], v[122:123], v[106:107]
    v_pk_add_f32 v[124:125], v[124:125], v[108:109]
    v_pk_add_f32 v[126:127], v[126:127], v[110:111]
    v_mov_b32 v2, v124
    v_mov_b32 v3, v124
    s_nop 1
    v_permlane32_swap_b32 v2, v3
    v_rcp_f32 v10, v3
    s_nop 0
    v_pk_mul_f32 v[112:113], v[112:113], v[10:11] op_sel_hi:[1,0]
    v_pk_mul_f32 v[114:115], v[114:115], v[10:11] op_sel_hi:[1,0]
    v_pk_mul_f32 v[116:117], v[116:117], v[10:11] op_sel_hi:[1,0]
    v_pk_mul_f32 v[118:119], v[118:119], v[10:11] op_sel_hi:[1,0]
    v_pk_mul_f32 v[120:121], v[120:121], v[10:11] op_sel_hi:[1,0]
    v_pk_mul_f32 v[122:123], v[122:123], v[10:11] op_sel_hi:[1,0]
    v_pk_mul_f32 v[124:125], v[124:125], v[10:11] op_sel_hi:[1,0]
    v_pk_mul_f32 v[126:127], v[126:127], v[10:11] op_sel_hi:[1,0]
    v_cvt_pk_bf16_f32 v208, v112, v113
    v_cvt_pk_bf16_f32 v209, v114, v115
    v_cvt_pk_bf16_f32 v210, v116, v117
    v_cvt_pk_bf16_f32 v211, v118, v119
    v_cvt_pk_bf16_f32 v212, v120, v121
    v_cvt_pk_bf16_f32 v213, v122, v123
    v_cvt_pk_bf16_f32 v214, v124, v125
    v_cvt_pk_bf16_f32 v215, v126, v127
    s_cmp_eq_u32 s16, 0
    s_cbranch_scc0 L_slow_33
    buffer_store_dwordx2 v[208:209], v128, s[4:7], s33 offen
    buffer_store_dwordx2 v[210:211], v129, s[4:7], s33 offen
    buffer_store_dwordx2 v[212:213], v128, s[4:7], s33 offen offset:1024
    buffer_store_dwordx2 v[214:215], v130, s[4:7], s33 offen offset:1024
L_join_34:
    s_add_u32 s57, s56, 2
    v_mov_b32 v9, s57
    v_and_b32 v13, 3, v0
    v_lshlrev_b32 v13, 2, v13
    s_mul_i32 s19, s14, 7168
    s_add_u32 s19, s19, 114688
    v_add_u32 v12, 114688, v1
    s_waitcnt vmcnt(0)
    s_mov_b64 exec, 1
    s_cmp_eq_u32 s16, 0
    s_cbranch_scc0 L_slow_35
    buffer_store_dword v9, off, s[4:7], s44
L_join_36:
    s_mov_b64 exec, -1
    s_barrier
    s_add_u32 s57, s56, 2
L_poll_37:
    buffer_load_dword v5, v13, s[4:7], s45 offen sc1
    s_waitcnt vmcnt(0)
    v_cmp_ne_u32 vcc, s57, v5
    s_cbranch_vccnz L_retry_38
    s_add_u32 m0, s19, 0
    s_add_u32 s18, s34, 0
    buffer_load_dwordx4 v1, s[4:7], s18 offen offset:0 sc1 lds
    buffer_load_dwordx4 v1, s[4:7], s18 offen offset:1024 sc1 lds
    buffer_load_dwordx4 v1, s[4:7], s18 offen offset:2048 sc1 lds
    buffer_load_dwordx4 v1, s[4:7], s18 offen offset:3072 sc1 lds
    s_add_u32 m0, s19, 4096
    s_add_u32 s18, s34, 4096
    buffer_load_dwordx4 v1, s[4:7], s18 offen offset:0 sc1 lds
    buffer_load_dwordx4 v1, s[4:7], s18 offen offset:1024 sc1 lds
    buffer_load_dwordx4 v1, s[4:7], s18 offen offset:2048 sc1 lds
    s_add_u32 s17, s14, 0
    s_and_b32 s17, s17, 3
    s_add_u32 s17, s17, 0
    s_mul_i32 s17, s17, 7168
    v_add_u32_e64 v192, s17, v12
    s_add_u32 s17, s14, 1
    s_and_b32 s17, s17, 3
    s_add_u32 s17, s17, 0
    s_mul_i32 s17, s17, 7168
    v_add_u32 v193, s17, v12
    s_add_u32 s17, s14, 2
    s_and_b32 s17, s17, 3
    s_add_u32 s17, s17, 0
    s_mul_i32 s17, s17, 7168
    v_add_u32 v194, s17, v12
    s_add_u32 s17, s14, 3
    s_and_b32 s17, s17, 3
    s_add_u32 s17, s17, 0
    s_mul_i32 s17, s17, 7168
    v_add_u32 v195, s17, v12
    s_cmp_ge_u32 s36, 14
    s_cbranch_scc1 L_woskip_39
    s_waitcnt vmcnt(6)
    ds_read_b128 v[176:179], v192 offset:0
    s_waitcnt vmcnt(5)
    ds_read_b128 v[180:183], v192 offset:1024
    s_waitcnt vmcnt(4)
    ds_read_b128 v[184:187], v192 offset:2048
    s_waitcnt lgkmcnt(2)
    v_mfma_f32_32x32x16_bf16 v[16:31], a[128:131], v[176:179], v[16:31]
    s_waitcnt vmcnt(3)
    ds_read_b128 v[188:191], v192 offset:3072
    s_waitcnt lgkmcnt(2)
    v_mfma_f32_32x32x16_bf16 v[16:31], a[132:135], v[180:183], v[16:31]
    s_waitcnt vmcnt(2)
    ds_read_b128 v[176:179], v192 offset:4096
    s_waitcnt lgkmcnt(2)
    v_mfma_f32_32x32x16_bf16 v[16:31], a[136:139], v[184:187], v[16:31]
    s_waitcnt vmcnt(1)
    ds_read_b128 v[180:183], v192 offset:5120
    s_waitcnt lgkmcnt(2)
    v_mfma_f32_32x32x16_bf16 v[16:31], a[140:143], v[188:191], v[16:31]
    s_waitcnt vmcnt(0)
    ds_read_b128 v[184:187], v192 offset:6144
    s_waitcnt lgkmcnt(2)
    v_mfma_f32_32x32x16_bf16 v[16:31], a[144:147], v[176:179], v[16:31]
    s_barrier
    ds_read_b128 v[188:191], v193 offset:0
    s_waitcnt lgkmcnt(2)
    v_mfma_f32_32x32x16_bf16 v[16:31], a[148:151], v[180:183], v[16:31]
    ds_read_b128 v[176:179], v193 offset:1024
    s_waitcnt lgkmcnt(2)
    v_mfma_f32_32x32x16_bf16 v[16:31], a[152:155], v[184:187], v[16:31]
    ds_read_b128 v[180:183], v193 offset:2048
    s_waitcnt lgkmcnt(2)
    v_mfma_f32_32x32x16_bf16 v[16:31], a[156:159], v[188:191], v[16:31]
    ds_read_b128 v[184:187], v193 offset:3072
    s_waitcnt lgkmcnt(2)
    v_mfma_f32_32x32x16_bf16 v[16:31], a[160:163], v[176:179], v[16:31]
    ds_read_b128 v[188:191], v193 offset:4096
    s_waitcnt lgkmcnt(2)
    v_mfma_f32_32x32x16_bf16 v[16:31], a[164:167], v[180:183], v[16:31]
    ds_read_b128 v[176:179], v193 offset:5120
    s_waitcnt lgkmcnt(2)
    v_mfma_f32_32x32x16_bf16 v[16:31], a[168:171], v[184:187], v[16:31]
    ds_read_b128 v[180:183], v193 offset:6144
    s_waitcnt lgkmcnt(2)
    v_mfma_f32_32x32x16_bf16 v[16:31], a[172:175], v[188:191], v[16:31]
    ds_read_b128 v[184:187], v194 offset:0
    s_waitcnt lgkmcnt(2)
    v_mfma_f32_32x32x16_bf16 v[16:31], a[176:179], v[176:179], v[16:31]
    ds_read_b128 v[188:191], v194 offset:1024
    s_waitcnt lgkmcnt(2)
    v_mfma_f32_32x32x16_bf16 v[16:31], a[180:183], v[180:183], v[16:31]
    ds_read_b128 v[176:179], v194 offset:2048
    s_waitcnt lgkmcnt(2)
    v_mfma_f32_32x32x16_bf16 v[16:31], a[184:187], v[184:187], v[16:31]
    ds_read_b128 v[180:183], v194 offset:3072
    s_waitcnt lgkmcnt(2)
    v_mfma_f32_32x32x16_bf16 v[16:31], a[188:191], v[188:191], v[16:31]
    ds_read_b128 v[184:187], v194 offset:4096
    s_waitcnt lgkmcnt(2)
    v_mfma_f32_32x32x16_bf16 v[16:31], a[192:195], v[176:179], v[16:31]
    ds_read_b128 v[188:191], v194 offset:5120
    s_waitcnt lgkmcnt(2)
    v_mfma_f32_32x32x16_bf16 v[16:31], a[196:199], v[180:183], v[16:31]
    ds_read_b128 v[176:179], v194 offset:6144
    s_waitcnt lgkmcnt(2)
    v_mfma_f32_32x32x16_bf16 v[16:31], a[200:203], v[184:187], v[16:31]
    ds_read_b128 v[180:183], v195 offset:0
    s_waitcnt lgkmcnt(2)
    v_mfma_f32_32x32x16_bf16 v[16:31], a[204:207], v[188:191], v[16:31]
    ds_read_b128 v[184:187], v195 offset:1024
    s_waitcnt lgkmcnt(2)
    v_mfma_f32_32x32x16_bf16 v[16:31], a[208:211], v[176:179], v[16:31]
    ds_read_b128 v[188:191], v195 offset:2048
    s_waitcnt lgkmcnt(2)
    v_mfma_f32_32x32x16_bf16 v[16:31], a[212:215], v[180:183], v[16:31]
    ds_read_b128 v[176:179], v195 offset:3072
    s_waitcnt lgkmcnt(2)
    v_mfma_f32_32x32x16_bf16 v[16:31], a[216:219], v[184:187], v[16:31]
    ds_read_b128 v[180:183], v195 offset:4096
    s_waitcnt lgkmcnt(2)
    v_mfma_f32_32x32x16_bf16 v[16:31], a[220:223], v[188:191], v[16:31]
    ds_read_b128 v[184:187], v195 offset:5120
    s_waitcnt lgkmcnt(2)
    v_mfma_f32_32x32x16_bf16 v[16:31], a[224:227], v[176:179], v[16:31]
    ds_read_b128 v[188:191], v195 offset:6144
    s_waitcnt lgkmcnt(2)
    v_mfma_f32_32x32x16_bf16 v[16:31], a[228:231], v[180:183], v[16:31]
    s_waitcnt lgkmcnt(1)
    v_mfma_f32_32x32x16_bf16 v[16:31], a[232:235], v[184:187], v[16:31]
    s_waitcnt lgkmcnt(0)
    v_mfma_f32_32x32x16_bf16 v[16:31], a[236:239], v[188:191], v[16:31]
    v_and_b32 v13, 31, v0
    v_lshlrev_b32 v13, 4, v13
    s_nop 9
    v_cvt_pk_bf16_f32 v208, v16, v17
    v_cvt_pk_bf16_f32 v209, v18, v19
    v_cvt_pk_bf16_f32 v210, v20, v21
    v_cvt_pk_bf16_f32 v211, v22, v23
    v_cvt_pk_bf16_f32 v212, v24, v25
    v_cvt_pk_bf16_f32 v213, v26, v27
    v_cvt_pk_bf16_f32 v214, v28, v29
    v_cvt_pk_bf16_f32 v215, v30, v31
    s_cmp_eq_u32 s16, 0
    s_cbranch_scc0 L_slow_41
    buffer_store_dwordx4 v[208:211], v1, s[4:7], s35 offen
    buffer_store_dwordx4 v[212:215], v1, s[4:7], s35 offen offset:1024
L_join_42:
    v_pk_mul_f32 v[4:5], v[16:17], v[16:17]
    v_pk_add_f32 v[2:3], v[16:17], v[18:19]
    v_pk_fma_f32 v[4:5], v[18:19], v[18:19], v[4:5]
    v_pk_fma_f32 v[4:5], v[20:21], v[20:21], v[4:5]
    v_pk_add_f32 v[2:3], v[2:3], v[20:21]
    v_pk_fma_f32 v[4:5], v[22:23], v[22:23], v[4:5]
    v_pk_add_f32 v[2:3], v[2:3], v[22:23]
    v_pk_fma_f32 v[4:5], v[24:25], v[24:25], v[4:5]
    v_pk_add_f32 v[2:3], v[2:3], v[24:25]
    v_pk_fma_f32 v[4:5], v[26:27], v[26:27], v[4:5]
    v_pk_add_f32 v[2:3], v[2:3], v[26:27]
    v_pk_fma_f32 v[4:5], v[28:29], v[28:29], v[4:5]
    v_pk_add_f32 v[2:3], v[2:3], v[28:29]
    v_pk_fma_f32 v[4:5], v[30:31], v[30:31], v[4:5]
    v_pk_add_f32 v[2:3], v[2:3], v[30:31]
    v_add_f32 v2, v2, v3
    v_add_f32 v3, v4, v5
    v_mov_b32 v4, v2
    v_mov_b32_e64 v5, v3
    s_nop 0
    v_permlane32_swap_b32 v2, v4
    v_permlane32_swap_b32 v3, v5
    v_pk_add_f32 v[4:5], v[4:5], v[2:3]
    s_cmp_eq_u32 s16, 0
    s_cbranch_scc0 L_slow_43
    buffer_store_dwordx2 v[4:5], v13, s[4:7], s58 offen
L_join_44:
    s_add_u32 s57, s56, 2
    v_mov_b32 v9, s57
    s_waitcnt vmcnt(0)
    s_mov_b64 exec, 1
    s_cmp_eq_u32 s16, 0
    s_cbranch_scc0 L_slow_45
    buffer_store_dword v9, off, s[4:7], s46
L_join_46:
    s_mov_b64 exec, -1
L_wojoin_40:
    v_and_b32 v2, 15, v0
    v_min_u32 v2, 13, v2
    v_lshlrev_b32 v2, 2, v2
    s_barrier
    s_add_u32 s57, s56, 2
L_poll_47:
    buffer_load_dword v5, v2, s[4:7], s47 offen sc1
    s_waitcnt vmcnt(0)
    v_cmp_ne_u32 vcc, s57, v5
    s_cbranch_vccnz L_retry_48
    s_add_u32 s66, s30, 0
    buffer_load_dwordx4 v[32:35], v1, s[4:7], s66 offen offset:0 sc1
    buffer_load_dwordx4 v[36:39], v1, s[4:7], s66 offen offset:1024 sc1
    buffer_load_dwordx4 v[40:43], v1, s[4:7], s66 offen offset:2048 sc1
    buffer_load_dwordx4 v[44:47], v1, s[4:7], s66 offen offset:3072 sc1
    s_add_u32 s66, s30, 4096
    buffer_load_dwordx4 v[48:51], v1, s[4:7], s66 offen offset:0 sc1
    buffer_load_dwordx4 v[52:55], v1, s[4:7], s66 offen offset:1024 sc1
    buffer_load_dwordx4 v[56:59], v1, s[4:7], s66 offen offset:2048 sc1
    buffer_load_dwordx4 v[60:63], v1, s[4:7], s66 offen offset:3072 sc1
    v_and_b32 v2, 31, v0
    v_lshrrev_b32 v3, 5, v0
    s_lshl_b32 s17, s14, 5
    v_add_u32 v4, s17, v2
    v_and_b32_e64 v5, 9, v0
    v_bfe_u32 v12, v0, 1, 1
    v_lshl_or_b32 v5, v12, 2, v5
    v_bfe_u32 v12, v0, 2, 1
    v_lshl_or_b32 v5, v12, 1, v5
    v_xor_b32 v5, v5, v3
    v_lshlrev_b32 v5, 3, v5
    v_lshl_add_u32 v5, v4, 7, v5
    v_add_u32 v248, 86016, v5
    v_bfe_u32 v5, v0, 1, 3
    v_xor_b32 v5, v5, v3
    v_lshlrev_b32 v5, 3, v5
    v_lshl_add_u32 v5, v4, 6, v5
    v_add_u32 v249, 102400, v5
    v_bfe_u32 v2, v0, 2, 2
    v_lshrrev_b32_e64 v3, 4, v0
    v_lshl_add_u32 v4, v3, 3, v2
    v_bfe_u32 v5, v0, 4, 1
    v_lshlrev_b32_e64 v5, 3, v5
    v_bfe_u32 v12, v0, 3, 1
    v_lshl_or_b32 v5, v12, 2, v5
    v_bfe_u32 v12, v0, 2, 1
    v_or_b32 v5, v5, v12
    v_and_b32 v12, 3, v0
    s_lshr_b32 s17, s14, 1
    s_lshl_b32 s17, s17, 3
    v_or_b32 v12, s17, v12
    v_xor_b32 v5, v5, v12
    v_lshlrev_b32_e64 v5, 3, v5
    v_lshl_add_u32 v5, v4, 7, v5
    v_add_u32 v250, 86016, v5
    v_xor_b32_e64 v251, 16, v250
    v_add_u32 v251, 512, v251
    v_xor_b32 v252, 32, v250
    v_xor_b32 v253, 32, v251
    v_bfe_u32 v5, v0, 4, 1
    v_lshlrev_b32_e64 v5, 2, v5
    v_bfe_u32 v12, v0, 3, 1
    v_or_b32 v5, v5, v12
    v_and_b32 v12, 3, v0
    s_and_b32 s17, s14, 1
    s_lshl_b32 s17, s17, 2
    v_or_b32 v12, s17, v12
    v_xor_b32 v5, v5, v12
    v_lshlrev_b32_e64 v5, 3, v5
    v_lshl_add_u32 v5, v4, 6, v5
    v_add_u32 v254, 102400, v5
    v_xor_b32_e64 v255, 16, v254
    v_add_u32 v255, 256, v255
    s_add_u32 s37, s37, 0x100000
    s_add_u32 s38, s38, 0x100000
    s_add_u32 s40, s40, 0x20000
    s_add_u32 s41, s41, 0x20000
    ds_read_b128 v[176:179], v1 offset:0
    ds_read_b128 v[180:183], v1 offset:28672
    ds_read_b128 v[184:187], v1 offset:1024
    ds_read_b128 v[188:191], v1 offset:29696
    v_lshrrev_b32 v3, 5, v0
    v_and_b32 v4, 31, v0
    v_lshlrev_b32_e64 v4, 4, v4
    v_mul_u32_u24 v14, 1536, v3
    v_add_u32_e64 v14, v14, v4
    v_lshl_add_u32 v4, v3, 3, v4
    s_waitcnt vmcnt(7) lgkmcnt(2)
    v_mfma_f32_32x32x16_bf16 v[144:159], v[176:179], v[32:35], 0
    s_add_u32 s66, s30, 8192
    buffer_load_dwordx4 v[64:67], v1, s[4:7], s66 offen offset:0 sc1
    ds_read_b128 v[192:195], v1 offset:2048
    v_mfma_f32_32x32x16_bf16 v[160:175], v[180:183], v[32:35], 0
    ds_read_b128 v[196:199], v1 offset:30720
    s_waitcnt vmcnt(7) lgkmcnt(2)
    v_mfma_f32_32x32x16_bf16 v[144:159], v[184:187], v[36:39], v[144:159]
    buffer_load_dwordx4 v[68:71], v1, s[4:7], s66 offen offset:1024 sc1
    ds_read_b128 v[176:179], v1 offset:3072
    v_mfma_f32_32x32x16_bf16 v[160:175], v[188:191], v[36:39], v[160:175]
    ds_read_b128 v[180:183], v1 offset:31744
    s_waitcnt vmcnt(7) lgkmcnt(2)
    v_mfma_f32_32x32x16_bf16 v[144:159], v[192:195], v[40:43], v[144:159]
    buffer_load_dwordx4 v[72:75], v1, s[4:7], s66 offen offset:2048 sc1
    ds_read_b128 v[184:187], v1 offset:4096
    v_mfma_f32_32x32x16_bf16 v[160:175], v[196:199], v[40:43], v[160:175]
    ds_read_b128 v[188:191], v1 offset:32768
    s_waitcnt vmcnt(7) lgkmcnt(2)
    v_mfma_f32_32x32x16_bf16 v[144:159], v[176:179], v[44:47], v[144:159]
    buffer_load_dwordx4 v[76:79], v1, s[4:7], s66 offen offset:3072 sc1
    ds_read_b128 v[192:195], v1 offset:5120
    v_mfma_f32_32x32x16_bf16 v[160:175], v[180:183], v[44:47], v[160:175]
    ds_read_b128 v[196:199], v1 offset:33792
    s_waitcnt vmcnt(7) lgkmcnt(2)
    v_mfma_f32_32x32x16_bf16 v[144:159], v[184:187], v[48:51], v[144:159]
    s_add_u32 s66, s30, 12288
    buffer_load_dwordx4 v[80:83], v1, s[4:7], s66 offen offset:0 sc1
    ds_read_b128 v[176:179], v1 offset:6144
    v_mfma_f32_32x32x16_bf16 v[160:175], v[188:191], v[48:51], v[160:175]
    ds_read_b128 v[180:183], v1 offset:34816
    s_waitcnt vmcnt(7) lgkmcnt(2)
    v_mfma_f32_32x32x16_bf16 v[144:159], v[192:195], v[52:55], v[144:159]
    buffer_load_dwordx4 v[84:87], v1, s[4:7], s66 offen offset:1024 sc1
    ds_read_b128 v[184:187], v1 offset:7168
    v_mfma_f32_32x32x16_bf16 v[160:175], v[196:199], v[52:55], v[160:175]
    ds_read_b128 v[188:191], v1 offset:35840
    s_waitcnt vmcnt(7) lgkmcnt(2)
    v_mfma_f32_32x32x16_bf16 v[144:159], v[176:179], v[56:59], v[144:159]
    buffer_load_dwordx4 v[88:91], v1, s[4:7], s66 offen offset:2048 sc1
    ds_read_b128 v[192:195], v1 offset:8192
    v_mfma_f32_32x32x16_bf16 v[160:175], v[180:183], v[56:59], v[160:175]
    ds_read_b128 v[196:199], v1 offset:36864
    s_waitcnt vmcnt(7) lgkmcnt(2)
    v_mfma_f32_32x32x16_bf16 v[144:159], v[184:187], v[60:63], v[144:159]
    buffer_load_dwordx4 v[92:95], v1, s[4:7], s66 offen offset:3072 sc1
    ds_read_b128 v[176:179], v1 offset:9216
    v_mfma_f32_32x32x16_bf16 v[160:175], v[188:191], v[60:63], v[160:175]
    ds_read_b128 v[180:183], v1 offset:37888
    s_waitcnt vmcnt(7) lgkmcnt(2)
    v_mfma_f32_32x32x16_bf16 v[144:159], v[192:195], v[64:67], v[144:159]
    s_add_u32 s66, s30, 16384
    buffer_load_dwordx4 v[96:99], v1, s[4:7], s66 offen offset:0 sc1
    ds_read_b128 v[184:187], v1 offset:10240
    v_mfma_f32_32x32x16_bf16 v[160:175], v[196:199], v[64:67], v[160:175]
    ds_read_b128 v[188:191], v1 offset:38912
    s_waitcnt vmcnt(7) lgkmcnt(2)
    v_mfma_f32_32x32x16_bf16 v[144:159], v[176:179], v[68:71], v[144:159]
    buffer_load_dwordx4 v[100:103], v1, s[4:7], s66 offen offset:1024 sc1
    ds_read_b128 v[192:195], v1 offset:11264
    v_mfma_f32_32x32x16_bf16 v[160:175], v[180:183], v[68:71], v[160:175]
    ds_read_b128 v[196:199], v1 offset:39936
    s_waitcnt vmcnt(7) lgkmcnt(2)
    v_mfma_f32_32x32x16_bf16 v[144:159], v[184:187], v[72:75], v[144:159]
    buffer_load_dwordx4 v[104:107], v1, s[4:7], s66 offen offset:2048 sc1
    ds_read_b128 v[176:179], v1 offset:12288
    v_lshrrev_b32 v13, 5, v0
    v_lshlrev_b32_e64 v13, 4, v13
    v_add_u32 v13, 147456, v13
    ds_read_b128 v[208:211], v13 offset:0
    v_mfma_f32_32x32x16_bf16 v[160:175], v[188:191], v[72:75], v[160:175]
    ds_read_b128 v[180:183], v1 offset:40960
    s_waitcnt vmcnt(7) lgkmcnt(3)
    v_mfma_f32_32x32x16_bf16 v[144:159], v[192:195], v[76:79], v[144:159]
    buffer_load_dwordx4 v[108:111], v1, s[4:7], s66 offen offset:3072 sc1
    ds_read_b128 v[184:187], v1 offset:13312
    ds_read_b128 v[212:215], v13 offset:32
    v_mfma_f32_32x32x16_bf16 v[160:175], v[196:199], v[76:79], v[160:175]
    ds_read_b128 v[188:191], v1 offset:41984
    s_waitcnt vmcnt(7) lgkmcnt(3)
    v_mfma_f32_32x32x16_bf16 v[144:159], v[176:179], v[80:83], v[144:159]
    s_add_u32 s66, s30, 20480
    buffer_load_dwordx4 v[112:115], v1, s[4:7], s66 offen offset:0 sc1
    ds_read_b128 v[192:195], v1 offset:14336
    ds_read_b128 v[216:219], v13 offset:64
    v_mfma_f32_32x32x16_bf16 v[160:175], v[180:183], v[80:83], v[160:175]
    ds_read_b128 v[196:199], v1 offset:43008
    s_waitcnt vmcnt(7) lgkmcnt(3)
    v_mfma_f32_32x32x16_bf16 v[144:159], v[184:187], v[84:87], v[144:159]
    buffer_load_dwordx4 v[116:119], v1, s[4:7], s66 offen offset:1024 sc1
    ds_read_b128 v[176:179], v1 offset:15360
    ds_read_b128 v[220:223], v13 offset:96
    v_mfma_f32_32x32x16_bf16 v[160:175], v[188:191], v[84:87], v[160:175]
    ds_read_b128 v[180:183], v1 offset:44032
    s_waitcnt vmcnt(7) lgkmcnt(3)
    v_mfma_f32_32x32x16_bf16 v[144:159], v[192:195], v[88:91], v[144:159]
    buffer_load_dwordx4 v[120:123], v1, s[4:7], s66 offen offset:2048 sc1
    ds_read_b128 v[184:187], v1 offset:16384
    v_lshrrev_b32 v13, 5, v0
    v_lshlrev_b32 v13, 4, v13
    v_add_u32 v13, 147456, v13
    ds_read_b128 v[224:227], v13 offset:128
    v_mfma_f32_32x32x16_bf16 v[160:175], v[196:199], v[88:91], v[160:175]
    ds_read_b128 v[188:191], v1 offset:45056
    s_waitcnt vmcnt(7) lgkmcnt(3)
    v_mfma_f32_32x32x16_bf16 v[144:159], v[176:179], v[92:95], v[144:159]
    buffer_load_dwordx4 v[124:127], v1, s[4:7], s66 offen offset:3072 sc1
    ds_read_b128 v[192:195], v1 offset:17408
    ds_read_b128 v[228:231], v13 offset:160
    v_mfma_f32_32x32x16_bf16 v[160:175], v[180:183], v[92:95], v[160:175]
    ds_read_b128 v[196:199], v1 offset:46080
    s_waitcnt vmcnt(7) lgkmcnt(3)
    v_mfma_f32_32x32x16_bf16 v[144:159], v[184:187], v[96:99], v[144:159]
    s_add_u32 s66, s30, 24576
    buffer_load_dwordx4 v[128:131], v1, s[4:7], s66 offen offset:0 sc1
    ds_read_b128 v[176:179], v1 offset:18432
    ds_read_b128 v[232:235], v13 offset:192
    v_mfma_f32_32x32x16_bf16 v[160:175], v[188:191], v[96:99], v[160:175]
    ds_read_b128 v[180:183], v1 offset:47104
    s_waitcnt vmcnt(7) lgkmcnt(3)
    v_mfma_f32_32x32x16_bf16 v[144:159], v[192:195], v[100:103], v[144:159]
    buffer_load_dwordx4 v[132:135], v1, s[4:7], s66 offen offset:1024 sc1
    ds_read_b128 v[184:187], v1 offset:19456
    ds_read_b128 v[236:239], v13 offset:224
    v_mfma_f32_32x32x16_bf16 v[160:175], v[196:199], v[100:103], v[160:175]
    ds_read_b128 v[188:191], v1 offset:48128
    s_waitcnt vmcnt(7) lgkmcnt(3)
    v_mfma_f32_32x32x16_bf16 v[144:159], v[176:179], v[104:107], v[144:159]
    buffer_load_dwordx4 v[136:139], v1, s[4:7], s66 offen offset:2048 sc1
    ds_read_b128 v[192:195], v1 offset:20480
    v_mfma_f32_32x32x16_bf16 v[160:175], v[180:183], v[104:107], v[160:175]
    ds_read_b128 v[196:199], v1 offset:49152
    s_waitcnt vmcnt(7) lgkmcnt(2)
    v_mfma_f32_32x32x16_bf16 v[144:159], v[184:187], v[108:111], v[144:159]
    buffer_load_dwordx4 v[140:143], v1, s[4:7], s66 offen offset:3072 sc1
    ds_read_b128 v[176:179], v1 offset:21504
    v_mfma_f32_32x32x16_bf16 v[160:175], v[188:191], v[108:111], v[160:175]
    ds_read_b128 v[180:183], v1 offset:50176
    s_waitcnt vmcnt(7) lgkmcnt(2)
    v_mfma_f32_32x32x16_bf16 v[144:159], v[192:195], v[112:115], v[144:159]
    buffer_load_dwordx4 v[200:203], v14, s[4:7], s59 offen offset:0 sc1
    ds_read_b128 v[184:187], v1 offset:22528
    v_mfma_f32_32x32x16_bf16 v[160:175], v[196:199], v[112:115], v[160:175]
    ds_read_b128 v[188:191], v1 offset:51200
    buffer_load_dwordx4 v[240:243], v14, s[4:7], s59 offen offset:512 sc1
    s_waitcnt vmcnt(8) lgkmcnt(2)
    v_mfma_f32_32x32x16_bf16 v[144:159], v[176:179], v[116:119], v[144:159]
    buffer_load_dwordx4 v[244:247], v14, s[4:7], s59 offen offset:1024 sc1
    ds_read_b128 v[192:195], v1 offset:23552
    v_mfma_f32_32x32x16_bf16 v[160:175], v[180:183], v[116:119], v[160:175]
    ds_read_b128 v[196:199], v1 offset:52224
    buffer_load_dwordx2 v[204:205], v4, s[4:7], s59 offen offset:3072 sc1
    s_waitcnt vmcnt(9) lgkmcnt(2)
    v_mfma_f32_32x32x16_bf16 v[144:159], v[184:187], v[120:123], v[144:159]
    s_add_u32 m0, s50, 57344
    s_add_u32 s67, s31, 50176
    buffer_load_dwordx4 v15, s[4:7], s67 offen sc1 lds
    ds_read_b128 v[176:179], v1 offset:24576
    v_mfma_f32_32x32x16_bf16 v[160:175], v[188:191], v[120:123], v[160:175]
    ds_read_b128 v[180:183], v1 offset:53248
    s_add_u32 m0, s50, 61440
    s_add_u32 s67, s31, 53760
    buffer_load_dwordx4 v15, s[4:7], s67 offen sc1 lds
    s_waitcnt vmcnt(10) lgkmcnt(2)
    v_mfma_f32_32x32x16_bf16 v[144:159], v[192:195], v[124:127], v[144:159]
    s_add_u32 m0, s50, 65536
    s_add_u32 s67, s31, 57344
    buffer_load_dwordx4 v15, s[4:7], s67 offen sc1 lds
    ds_read_b128 v[184:187], v1 offset:25600
    v_mfma_f32_32x32x16_bf16 v[160:175], v[196:199], v[124:127], v[160:175]
    ds_read_b128 v[188:191], v1 offset:54272
    s_add_u32 m0, s50, 69632
    s_add_u32 s67, s31, 60928
    buffer_load_dwordx4 v15, s[4:7], s67 offen sc1 lds
    s_waitcnt vmcnt(11) lgkmcnt(2)
    v_mfma_f32_32x32x16_bf16 v[144:159], v[176:179], v[128:131], v[144:159]
    s_add_u32 m0, s50, 73728
    s_add_u32 s67, s31, 64512
    buffer_load_dwordx4 v15, s[4:7], s67 offen sc1 lds
    ds_read_b128 v[192:195], v1 offset:26624
    v_mfma_f32_32x32x16_bf16 v[160:175], v[180:183], v[128:131], v[160:175]
    ds_read_b128 v[196:199], v1 offset:55296
    s_add_u32 m0, s50, 77824
    s_add_u32 s67, s31, 68096
    buffer_load_dwordx4 v15, s[4:7], s67 offen sc1 lds
    s_waitcnt vmcnt(12) lgkmcnt(2)
    v_mfma_f32_32x32x16_bf16 v[144:159], v[184:187], v[132:135], v[144:159]
    s_add_u32 m0, s50, 81920
    s_add_u32 s67, s31, 71680
    buffer_load_dwordx4 v15, s[4:7], s67 offen sc1 lds
    ds_read_b128 v[176:179], v1 offset:27648
    v_mfma_f32_32x32x16_bf16 v[160:175], v[188:191], v[132:135], v[160:175]
    ds_read_b128 v[180:183], v1 offset:56320
    s_waitcnt vmcnt(12) lgkmcnt(2)
    v_mfma_f32_32x32x16_bf16 v[144:159], v[192:195], v[136:139], v[144:159]
    v_mfma_f32_32x32x16_bf16 v[160:175], v[196:199], v[136:139], v[160:175]
    s_waitcnt vmcnt(11) lgkmcnt(0)
    v_mfma_f32_32x32x16_bf16 v[144:159], v[176:179], v[140:143], v[144:159]
    v_mfma_f32_32x32x16_bf16 v[160:175], v[180:183], v[140:143], v[160:175]
    s_waitcnt vmcnt(7)
    v_pk_add_f32 v[200:201], v[200:201], v[240:241]
    v_pk_add_f32 v[202:203], v[202:203], v[242:243]
    v_pk_add_f32 v[244:245], v[244:245], v[204:205]
    v_pk_add_f32 v[200:201], v[200:201], v[246:247]
    v_pk_add_f32 v[244:245], v[244:245], v[202:203]
    v_pk_add_f32 v[200:201], v[200:201], v[244:245]
    v_mov_b32 v206, v200
    v_mov_b32_e64 v207, v201
    s_nop 0
    v_permlane32_swap_b32 v200, v206
    v_permlane32_swap_b32 v201, v207
    v_pk_add_f32 v[206:207], v[206:207], v[200:201]
    v_mul_f32 v5, 991054117, v206
    v_mul_f32 v2, 991054117, v207
    v_fma_f32 v2, -v5, v5, v2
    v_max_f32_e64 v2, 0, v2
    v_add_f32 v2, 925353388, v2
    v_rsq_f32 v8, v2
    s_nop 0
    v_mul_f32_e64 v206, v206, v8
    v_pk_mul_f32 v[224:225], v[224:225], v[206:207] op_sel_hi:[1,0]
    v_pk_mul_f32 v[226:227], v[226:227], v[206:207] op_sel_hi:[1,0]
    v_pk_mul_f32 v[228:229], v[228:229], v[206:207] op_sel_hi:[1,0]
    v_pk_mul_f32 v[230:231], v[230:231], v[206:207] op_sel_hi:[1,0]
    v_pk_mul_f32 v[232:233], v[232:233], v[206:207] op_sel_hi:[1,0]
    v_pk_mul_f32 v[234:235], v[234:235], v[206:207] op_sel_hi:[1,0]
    v_pk_mul_f32 v[236:237], v[236:237], v[206:207] op_sel_hi:[1,0]
    v_pk_mul_f32 v[238:239], v[238:239], v[206:207] op_sel_hi:[1,0]
    v_pk_mul_f32 v[208:209], v[208:209], v[206:207] op_sel_hi:[1,0]
    v_pk_mul_f32 v[210:211], v[210:211], v[206:207] op_sel_hi:[1,0]
    v_pk_mul_f32 v[212:213], v[212:213], v[206:207] op_sel_hi:[1,0]
    v_pk_mul_f32 v[214:215], v[214:215], v[206:207] op_sel_hi:[1,0]
    v_pk_mul_f32 v[216:217], v[216:217], v[206:207] op_sel_hi:[1,0]
    v_pk_mul_f32 v[218:219], v[218:219], v[206:207] op_sel_hi:[1,0]
    v_pk_mul_f32 v[220:221], v[220:221], v[206:207] op_sel_hi:[1,0]
    v_pk_mul_f32 v[222:223], v[222:223], v[206:207] op_sel_hi:[1,0]
    s_barrier
    v_pk_fma_f32 v[160:161], v[160:161], v[8:9], v[224:225] op_sel_hi:[1,0,1]
    v_pk_fma_f32 v[162:163], v[162:163], v[8:9], v[226:227] op_sel_hi:[1,0,1]
    v_pk_fma_f32 v[164:165], v[164:165], v[8:9], v[228:229] op_sel_hi:[1,0,1]
    v_pk_fma_f32 v[166:167], v[166:167], v[8:9], v[230:231] op_sel_hi:[1,0,1]
    v_pk_fma_f32 v[168:169], v[168:169], v[8:9], v[232:233] op_sel_hi:[1,0,1]
    v_pk_fma_f32 v[170:171], v[170:171], v[8:9], v[234:235] op_sel_hi:[1,0,1]
    v_pk_fma_f32 v[172:173], v[172:173], v[8:9], v[236:237] op_sel_hi:[1,0,1]
    v_pk_fma_f32 v[174:175], v[174:175], v[8:9], v[238:239] op_sel_hi:[1,0,1]
    s_mov_b64 exec, s[54:55]
    v_mov_b32 v172, 1.0
    s_mov_b64 exec, -1
    v_cvt_pk_bf16_f32 v176, v160, v161
    v_cvt_pk_bf16_f32 v177, v162, v163
    v_cvt_pk_bf16_f32 v178, v164, v165
    s_add_u32 m0, s50, 0
    s_add_u32 s67, s32, 0
    buffer_load_dwordx4 v15, s[4:7], s67 offen sc1 lds
    v_cvt_pk_bf16_f32 v179, v166, v167
    v_cvt_pk_bf16_f32 v180, v168, v169
    v_cvt_pk_bf16_f32 v181, v170, v171
    v_cvt_pk_bf16_f32 v182, v172, v173
    v_cvt_pk_bf16_f32 v183, v174, v175
    ds_write_b64 v249, v[176:177]
    v_xor_b32_e64 v12, 16, v249
    ds_write_b64 v12, v[178:179]
    v_xor_b32_e64 v12, 32, v249
    ds_write_b64 v12, v[180:181]
    v_xor_b32_e64 v12, 48, v249
    ds_write_b64 v12, v[182:183]
    v_pk_fma_f32 v[144:145], v[144:145], v[8:9], v[208:209] op_sel_hi:[1,0,1]
    v_pk_fma_f32 v[146:147], v[146:147], v[8:9], v[210:211] op_sel_hi:[1,0,1]
    v_pk_fma_f32 v[148:149], v[148:149], v[8:9], v[212:213] op_sel_hi:[1,0,1]
    s_add_u32 m0, s50, 4096
    s_add_u32 s67, s32, 3584
    buffer_load_dwordx4 v15, s[4:7], s67 offen sc1 lds
    v_pk_fma_f32 v[150:151], v[150:151], v[8:9], v[214:215] op_sel_hi:[1,0,1]
    v_pk_fma_f32 v[152:153], v[152:153], v[8:9], v[216:217] op_sel_hi:[1,0,1]
    v_pk_fma_f32 v[154:155], v[154:155], v[8:9], v[218:219] op_sel_hi:[1,0,1]
    v_pk_fma_f32 v[156:157], v[156:157], v[8:9], v[220:221] op_sel_hi:[1,0,1]
    v_pk_fma_f32 v[158:159], v[158:159], v[8:9], v[222:223] op_sel_hi:[1,0,1]
    s_mov_b64 exec, s[54:55]
    v_mov_b32 v156, v144
    v_mov_b32 v157, v144
    v_mov_b32 v158, v144
    v_mov_b32 v159, v144
    s_mov_b64 exec, -1
    v_max3_f32 v2, v144, v145, v146
    v_max3_f32 v2, v2, v147, v148
    v_max3_f32 v2, v2, v149, v150
    v_max3_f32 v2, v2, v151, v152
    v_max3_f32 v2, v2, v153, v154
    v_max3_f32 v2, v2, v155, v156
    s_add_u32 m0, s50, 8192
    s_add_u32 s67, s32, 7168
    buffer_load_dwordx4 v15, s[4:7], s67 offen sc1 lds
    v_max3_f32 v2, v2, v157, v158
    v_max3_f32 v2, v2, v159, v159
    v_min3_f32 v4, v144, v145, v146
    v_min3_f32 v4, v4, v147, v148
    v_min3_f32 v4, v4, v149, v150
    v_min3_f32 v4, v4, v151, v152
    v_min3_f32 v4, v4, v153, v154
    v_min3_f32 v4, v4, v155, v156
    v_min3_f32 v4, v4, v157, v158
    v_min3_f32 v4, v4, v159, v159
    v_mov_b32_e64 v3, v2
    s_add_u32 m0, s50, 12288
    s_add_u32 s67, s32, 10752
    buffer_load_dwordx4 v15, s[4:7], s67 offen sc1 lds
    v_mov_b32 v5, v4
    v_permlane32_swap_b32 v2, v3
    s_nop 0
    v_permlane32_swap_b32 v4, v5
    v_max_f32 v10, v2, v3
    v_min_f32 v11, v4, v5
    v_pk_add_f32 v[208:209], v[144:145], v[10:11] op_sel_hi:[1,0] neg_lo:[0,1] neg_hi:[0,1]
    v_pk_add_f32 v[224:225], v[144:145], v[10:11] op_sel:[0,1] op_sel_hi:[1,1] neg_lo:[1,0] neg_hi:[1,0]
    v_pk_add_f32 v[210:211], v[146:147], v[10:11] op_sel_hi:[1,0] neg_lo:[0,1] neg_hi:[0,1]
    v_pk_add_f32 v[226:227], v[146:147], v[10:11] op_sel:[0,1] op_sel_hi:[1,1] neg_lo:[1,0] neg_hi:[1,0]
    v_pk_add_f32 v[212:213], v[148:149], v[10:11] op_sel_hi:[1,0] neg_lo:[0,1] neg_hi:[0,1]
    v_pk_add_f32 v[228:229], v[148:149], v[10:11] op_sel:[0,1] op_sel_hi:[1,1] neg_lo:[1,0] neg_hi:[1,0]
    s_add_u32 m0, s50, 16384
    s_add_u32 s67, s32, 14336
    buffer_load_dwordx4 v15, s[4:7], s67 offen sc1 lds
    v_pk_add_f32 v[214:215], v[150:151], v[10:11] op_sel_hi:[1,0] neg_lo:[0,1] neg_hi:[0,1]
    v_pk_add_f32 v[230:231], v[150:151], v[10:11] op_sel:[0,1] op_sel_hi:[1,1] neg_lo:[1,0] neg_hi:[1,0]
    v_pk_add_f32 v[216:217], v[152:153], v[10:11] op_sel_hi:[1,0] neg_lo:[0,1] neg_hi:[0,1]
    v_pk_add_f32 v[232:233], v[152:153], v[10:11] op_sel:[0,1] op_sel_hi:[1,1] neg_lo:[1,0] neg_hi:[1,0]
    v_pk_add_f32 v[218:219], v[154:155], v[10:11] op_sel_hi:[1,0] neg_lo:[0,1] neg_hi:[0,1]
    v_pk_add_f32 v[234:235], v[154:155], v[10:11] op_sel:[0,1] op_sel_hi:[1,1] neg_lo:[1,0] neg_hi:[1,0]
    v_pk_add_f32 v[220:221], v[156:157], v[10:11] op_sel_hi:[1,0] neg_lo:[0,1] neg_hi:[0,1]
    v_pk_add_f32 v[236:237], v[156:157], v[10:11] op_sel:[0,1] op_sel_hi:[1,1] neg_lo:[1,0] neg_hi:[1,0]
    v_pk_add_f32 v[222:223], v[158:159], v[10:11] op_sel_hi:[1,0] neg_lo:[0,1] neg_hi:[0,1]
    v_pk_add_f32 v[238:239], v[158:159], v[10:11] op_sel:[0,1] op_sel_hi:[1,1] neg_lo:[1,0] neg_hi:[1,0]
    v_exp_f32_e64 v208, v208
    s_add_u32 m0, s50, 20480
    s_add_u32 s67, s32, 17920
    buffer_load_dwordx4 v15, s[4:7], s67 offen sc1 lds
    v_exp_f32 v224, v224
    v_exp_f32 v209, v209
    v_exp_f32 v225, v225
    v_exp_f32 v210, v210
    v_exp_f32 v226, v226
    v_exp_f32 v211, v211
    v_exp_f32 v227, v227
    v_exp_f32 v212, v212
    v_exp_f32 v228, v228
    v_exp_f32 v213, v213
    v_exp_f32_e64 v229, v229
    s_add_u32 m0, s50, 24576
    s_add_u32 s67, s32, 21504
    buffer_load_dwordx4 v15, s[4:7], s67 offen sc1 lds
    v_exp_f32 v214, v214
    v_exp_f32 v230, v230
    v_exp_f32 v215, v215
    v_exp_f32 v231, v231
    v_exp_f32 v216, v216
    v_exp_f32 v232, v232
    v_exp_f32 v217, v217
    v_exp_f32 v233, v233
    v_exp_f32 v218, v218
    v_exp_f32 v234, v234
    v_exp_f32_e64 v219, v219
    s_add_u32 m0, s50, 28672
    s_add_u32 s67, s32, 25088
    buffer_load_dwordx4 v15, s[4:7], s67 offen sc1 lds
    v_exp_f32 v235, v235
    v_exp_f32 v220, v220
    v_exp_f32 v236, v236
    v_exp_f32 v221, v221
    v_exp_f32 v237, v237
    v_exp_f32 v222, v222
    v_exp_f32 v238, v238
    v_exp_f32 v223, v223
    v_exp_f32 v239, v239
    s_mov_b64 exec, s[54:55]
    v_mov_b32 v220, 0
    v_mov_b32 v236, 0
    v_mov_b32 v221, 0
    v_mov_b32 v237, 0
    v_mov_b32 v222, 0
    v_mov_b32 v238, 0
    v_mov_b32 v223, 0
    v_mov_b32_e64 v239, 0
    s_mov_b64 exec, -1
    v_pk_add_f32 v[2:3], v[208:209], v[210:211]
    v_pk_add_f32 v[4:5], v[224:225], v[226:227]
    s_add_u32 m0, s50, 32768
    s_add_u32 s67, s32, 28672
    buffer_load_dwordx4 v15, s[4:7], s67 offen sc1 lds
    v_pk_add_f32 v[2:3], v[2:3], v[212:213]
    v_pk_add_f32 v[4:5], v[4:5], v[228:229]
    v_pk_add_f32 v[2:3], v[2:3], v[214:215]
    v_pk_add_f32 v[4:5], v[4:5], v[230:231]
    v_pk_add_f32 v[2:3], v[2:3], v[216:217]
    v_pk_add_f32 v[4:5], v[4:5], v[232:233]
    v_pk_add_f32 v[2:3], v[2:3], v[218:219]
    v_pk_add_f32 v[4:5], v[4:5], v[234:235]
    v_pk_add_f32 v[2:3], v[2:3], v[220:221]
    v_pk_add_f32 v[4:5], v[4:5], v[236:237]
    v_pk_add_f32 v[2:3], v[2:3], v[222:223]
    s_add_u32 m0, s50, 36864
    s_add_u32 s67, s32, 32256
    buffer_load_dwordx4 v15, s[4:7], s67 offen sc1 lds
    v_pk_add_f32 v[4:5], v[4:5], v[238:239]
    v_add_f32 v2, v2, v3
    v_add_f32 v4, v4, v5
    v_mov_b32 v3, v2
    v_mov_b32 v5, v4
    s_nop 0
    v_permlane32_swap_b32 v2, v3
    v_permlane32_swap_b32 v4, v5
    v_add_f32 v2, v2, v3
    v_add_f32 v4, v4, v5
    v_rcp_f32 v10, v2
    v_rcp_f32_e64 v11, v4
    s_add_u32 m0, s50, 40960
    s_add_u32 s67, s32, 35840
    buffer_load_dwordx4 v15, s[4:7], s67 offen sc1 lds
    v_pk_mul_f32 v[208:209], v[208:209], v[10:11] op_sel_hi:[1,0]
    v_pk_mul_f32 v[210:211], v[210:211], v[10:11] op_sel_hi:[1,0]
    v_cvt_pk_bf16_f32 v176, v208, v209
    v_cvt_pk_bf16_f32 v177, v210, v211
    ds_write_b64 v248, v[176:177]
    v_pk_mul_f32 v[212:213], v[212:213], v[10:11] op_sel_hi:[1,0]
    v_pk_mul_f32 v[214:215], v[214:215], v[10:11] op_sel_hi:[1,0]
    v_cvt_pk_bf16_f32 v178, v212, v213
    v_cvt_pk_bf16_f32 v179, v214, v215
    v_xor_b32_e64 v13, 16, v248
    ds_write_b64 v13, v[178:179]
    v_pk_mul_f32 v[216:217], v[216:217], v[10:11] op_sel_hi:[1,0]
    v_pk_mul_f32 v[218:219], v[218:219], v[10:11] op_sel_hi:[1,0]
    s_add_u32 m0, s50, 45056
    s_add_u32 s67, s32, 39424
    buffer_load_dwordx4 v15, s[4:7], s67 offen sc1 lds
    v_cvt_pk_bf16_f32 v180, v216, v217
    v_cvt_pk_bf16_f32 v181, v218, v219
    v_xor_b32_e64 v12, 32, v248
    ds_write_b64 v12, v[180:181]
    v_pk_mul_f32 v[220:221], v[220:221], v[10:11] op_sel_hi:[1,0]
    v_pk_mul_f32 v[222:223], v[222:223], v[10:11] op_sel_hi:[1,0]
    v_cvt_pk_bf16_f32 v182, v220, v221
    v_cvt_pk_bf16_f32 v183, v222, v223
    v_xor_b32_e64 v13, 48, v248
    ds_write_b64 v13, v[182:183]
    v_pk_mul_f32 v[224:225], v[224:225], v[10:11] op_sel:[0,1] op_sel_hi:[1,1]
    v_pk_mul_f32 v[226:227], v[226:227], v[10:11] op_sel:[0,1] op_sel_hi:[1,1]
    v_cvt_pk_bf16_f32 v184, v224, v225
    s_add_u32 m0, s50, 49152
    s_add_u32 s67, s32, 43008
    buffer_load_dwordx4 v15, s[4:7], s67 offen sc1 lds
    v_cvt_pk_bf16_f32 v185, v226, v227
    v_xor_b32_e64 v12, 64, v248
    ds_write_b64 v12, v[184:185]
    v_pk_mul_f32 v[228:229], v[228:229], v[10:11] op_sel:[0,1] op_sel_hi:[1,1]
    v_pk_mul_f32 v[230:231], v[230:231], v[10:11] op_sel:[0,1] op_sel_hi:[1,1]
    v_cvt_pk_bf16_f32 v186, v228, v229
    v_cvt_pk_bf16_f32 v187, v230, v231
    v_xor_b32 v13, 80, v248
    ds_write_b64 v13, v[186:187]
    v_pk_mul_f32 v[232:233], v[232:233], v[10:11] op_sel:[0,1] op_sel_hi:[1,1]
    v_pk_mul_f32 v[234:235], v[234:235], v[10:11] op_sel:[0,1] op_sel_hi:[1,1]
    v_cvt_pk_bf16_f32 v188, v232, v233
    v_cvt_pk_bf16_f32 v189, v234, v235
    s_add_u32 m0, s50, 53248
    s_add_u32 s67, s32, 46592
    buffer_load_dwordx4 v15, s[4:7], s67 offen sc1 lds
    v_xor_b32 v12, 96, v248
    ds_write_b64 v12, v[188:189]
    v_pk_mul_f32 v[236:237], v[236:237], v[10:11] op_sel:[0,1] op_sel_hi:[1,1]
    v_pk_mul_f32 v[238:239], v[238:239], v[10:11] op_sel:[0,1] op_sel_hi:[1,1]
    v_cvt_pk_bf16_f32 v190, v236, v237
    v_cvt_pk_bf16_f32 v191, v238, v239
    v_xor_b32 v13, 112, v248
    ds_write_b64 v13, v[190:191]
    v_lshrrev_b32_e64 v2, 5, v0
    v_bfe_u32 v3, v0, 4, 1
    v_and_b32_e64 v4, 15, v0
    v_lshl_or_b32 v4, v3, 5, v4
    v_lshlrev_b32_e64 v4, 4, v4
    v_lshl_or_b32 v4, v2, 10, v4
    s_lshr_b32 s17, s14, 1
    s_lshl_b32 s17, s17, 11
    s_and_b32 s18, s14, 1
    s_lshl_b32 s18, s18, 8
    s_add_u32 s17, s17, s18
    s_add_u32 s19, s17, s37
    v_mov_b32 v9, s56
    s_waitcnt lgkmcnt(0)
    s_waitcnt vmcnt(14)
    s_barrier
    ds_read_b64_tr_b16 v[208:209], v250 offset:0
    ds_read_b64_tr_b16 v[210:211], v251 offset:0
    ds_read_b64_tr_b16 v[212:213], v252 offset:0
    ds_read_b64_tr_b16 v[214:215], v253 offset:0
    ds_read_b64_tr_b16 v[216:217], v254 offset:0
    ds_read_b64_tr_b16 v[218:219], v255 offset:0
    ds_read_b64_tr_b16 v[220:221], v250 offset:4096
    ds_read_b64_tr_b16 v[222:223], v251 offset:4096
    ds_read_b64_tr_b16 v[224:225], v252 offset:4096
    ds_read_b64_tr_b16 v[226:227], v253 offset:4096
    ds_read_b64_tr_b16 v[228:229], v254 offset:2048
    ds_read_b64_tr_b16 v[230:231], v255 offset:2048
    s_waitcnt lgkmcnt(6)
    v_mfma_f32_16x16x32_bf16 v[160:163], v[208:211], v[216:219], 0
    v_mfma_f32_16x16x32_bf16 v[164:167], v[212:215], v[216:219], 0
    ds_read_b64_tr_b16 v[208:209], v250 offset:8192
    ds_read_b64_tr_b16 v[210:211], v251 offset:8192
    ds_read_b64_tr_b16 v[212:213], v252 offset:8192
    ds_read_b64_tr_b16 v[214:215], v253 offset:8192
    ds_read_b64_tr_b16 v[216:217], v254 offset:4096
    ds_read_b64_tr_b16 v[218:219], v255 offset:4096
    s_waitcnt lgkmcnt(6)
    v_mfma_f32_16x16x32_bf16 v[160:163], v[220:223], v[228:231], v[160:163]
    v_mfma_f32_16x16x32_bf16 v[164:167], v[224:227], v[228:231], v[164:167]
    ds_read_b64_tr_b16 v[220:221], v250 offset:12288
    ds_read_b64_tr_b16 v[222:223], v251 offset:12288
    ds_read_b64_tr_b16 v[224:225], v252 offset:12288
    ds_read_b64_tr_b16 v[226:227], v253 offset:12288
    ds_read_b64_tr_b16 v[228:229], v254 offset:6144
    ds_read_b64_tr_b16 v[230:231], v255 offset:6144
    s_waitcnt lgkmcnt(6)
    v_mfma_f32_16x16x32_bf16 v[160:163], v[208:211], v[216:219], v[160:163]
    v_mfma_f32_16x16x32_bf16 v[164:167], v[212:215], v[216:219], v[164:167]
    s_waitcnt lgkmcnt(0)
    v_mfma_f32_16x16x32_bf16 v[160:163], v[220:223], v[228:231], v[160:163]
    v_mfma_f32_16x16x32_bf16 v[164:167], v[224:227], v[228:231], v[164:167]
    v_add_u32 v12, 32768, v1
    ds_read_b128 v[176:179], v12 offset:24576
    ds_read_b128 v[180:183], v12 offset:25600
    ds_read_b128 v[184:187], v12 offset:26624
    s_nop 2
    v_cvt_pk_bf16_f32 v232, v160, v161
    v_cvt_pk_bf16_f32 v233, v162, v163
    v_cvt_pk_bf16_f32 v234, v164, v165
    v_cvt_pk_bf16_f32 v235, v166, v167
    s_nop 0
    v_permlane32_swap_b32 v232, v234
    v_permlane32_swap_b32 v233, v235
    buffer_store_dwordx4 v[232:235], v4, s[4:7], s19 offen sc1
    s_waitcnt lgkmcnt(2)
    v_mfma_f32_32x32x16_bf16 v[144:159], v[176:179], v[32:35], 0
    ds_read_b128 v[188:191], v12 offset:27648
    s_waitcnt lgkmcnt(2)
    v_mfma_f32_32x32x16_bf16 v[144:159], v[180:183], v[36:39], v[144:159]
    ds_read_b128 v[176:179], v12 offset:28672
    s_waitcnt lgkmcnt(2)
    v_mfma_f32_32x32x16_bf16 v[144:159], v[184:187], v[40:43], v[144:159]
    ds_read_b128 v[180:183], v12 offset:29696
    s_waitcnt lgkmcnt(2)
    v_mfma_f32_32x32x16_bf16 v[144:159], v[188:191], v[44:47], v[144:159]
    ds_read_b128 v[184:187], v12 offset:30720
    s_waitcnt lgkmcnt(2)
    v_mfma_f32_32x32x16_bf16 v[144:159], v[176:179], v[48:51], v[144:159]
    ds_read_b128 v[188:191], v12 offset:31744
    s_waitcnt lgkmcnt(2)
    v_mfma_f32_32x32x16_bf16 v[144:159], v[180:183], v[52:55], v[144:159]
    ds_read_b128 v[176:179], v12 offset:32768
    v_lshrrev_b32 v13, 5, v0
    v_lshlrev_b32 v13, 4, v13
    v_add_u32 v13, 147456, v13
    ds_read_b128 v[208:211], v13 offset:256
    s_waitcnt lgkmcnt(3)
    v_mfma_f32_32x32x16_bf16 v[144:159], v[184:187], v[56:59], v[144:159]
    ds_read_b128 v[180:183], v12 offset:33792
    ds_read_b128 v[212:215], v13 offset:288
    s_waitcnt lgkmcnt(4)
    v_mfma_f32_32x32x16_bf16 v[144:159], v[188:191], v[60:63], v[144:159]
    ds_read_b128 v[184:187], v12 offset:34816
    ds_read_b128 v[216:219], v13 offset:320
    s_waitcnt lgkmcnt(5)
    v_mfma_f32_32x32x16_bf16 v[144:159], v[176:179], v[64:67], v[144:159]
    ds_read_b128 v[188:191], v12 offset:35840
    ds_read_b128 v[220:223], v13 offset:352
    s_waitcnt lgkmcnt(5)
    v_mfma_f32_32x32x16_bf16 v[144:159], v[180:183], v[68:71], v[144:159]
    ds_read_b128 v[176:179], v12 offset:36864
    s_waitcnt lgkmcnt(4)
    v_mfma_f32_32x32x16_bf16 v[144:159], v[184:187], v[72:75], v[144:159]
    ds_read_b128 v[180:183], v12 offset:37888
    s_waitcnt lgkmcnt(3)
    v_mfma_f32_32x32x16_bf16 v[144:159], v[188:191], v[76:79], v[144:159]
    ds_read_b128 v[184:187], v12 offset:38912
    s_waitcnt lgkmcnt(3)
    v_mul_f32_e64 v208, v208, v206
    s_waitcnt lgkmcnt(2)
    v_mfma_f32_32x32x16_bf16 v[144:159], v[176:179], v[80:83], v[144:159]
    ds_read_b128 v[188:191], v12 offset:39936
    v_mul_f32 v209, v209, v206
    s_waitcnt lgkmcnt(2)
    v_mfma_f32_32x32x16_bf16 v[144:159], v[180:183], v[84:87], v[144:159]
    ds_read_b128 v[176:179], v12 offset:40960
    v_mul_f32 v210, v210, v206
    s_waitcnt lgkmcnt(2)
    v_mfma_f32_32x32x16_bf16 v[144:159], v[184:187], v[88:91], v[144:159]
    ds_read_b128 v[180:183], v12 offset:41984
    v_mul_f32 v211, v211, v206
    s_waitcnt lgkmcnt(2)
    v_mfma_f32_32x32x16_bf16 v[144:159], v[188:191], v[92:95], v[144:159]
    ds_read_b128 v[184:187], v12 offset:43008
    v_mul_f32 v212, v212, v206
    s_waitcnt lgkmcnt(2)
    v_mfma_f32_32x32x16_bf16 v[144:159], v[176:179], v[96:99], v[144:159]
    ds_read_b128 v[188:191], v12 offset:44032
    v_mul_f32 v213, v213, v206
    s_waitcnt lgkmcnt(2)
    v_mfma_f32_32x32x16_bf16 v[144:159], v[180:183], v[100:103], v[144:159]
    ds_read_b128 v[176:179], v12 offset:45056
    v_mul_f32 v214, v214, v206
    s_waitcnt lgkmcnt(2)
    v_mfma_f32_32x32x16_bf16 v[144:159], v[184:187], v[104:107], v[144:159]
    ds_read_b128 v[180:183], v12 offset:46080
    v_mul_f32 v215, v215, v206
    s_waitcnt lgkmcnt(2)
    v_mfma_f32_32x32x16_bf16 v[144:159], v[188:191], v[108:111], v[144:159]
    ds_read_b128 v[184:187], v12 offset:47104
    v_mul_f32 v216, v216, v206
    s_waitcnt lgkmcnt(2)
    v_mfma_f32_32x32x16_bf16 v[144:159], v[176:179], v[112:115], v[144:159]
    ds_read_b128 v[188:191], v12 offset:48128
    v_mul_f32 v217, v217, v206
    s_waitcnt lgkmcnt(2)
    v_mfma_f32_32x32x16_bf16 v[144:159], v[180:183], v[116:119], v[144:159]
    ds_read_b128 v[176:179], v12 offset:49152
    v_mul_f32 v218, v218, v206
    s_waitcnt lgkmcnt(2)
    v_mfma_f32_32x32x16_bf16 v[144:159], v[184:187], v[120:123], v[144:159]
    ds_read_b128 v[180:183], v12 offset:50176
    v_mul_f32_e64 v219, v219, v206
    s_waitcnt vmcnt(0)
    s_mov_b64 exec, 1
    buffer_store_dword v9, off, s[4:7], s40 sc1
    s_mov_b64 exec, -1
    s_waitcnt lgkmcnt(2)
    v_mfma_f32_32x32x16_bf16 v[144:159], v[188:191], v[124:127], v[144:159]
    ds_read_b128 v[184:187], v12 offset:51200
    v_mul_f32 v220, v220, v206
    s_waitcnt lgkmcnt(2)
    v_mfma_f32_32x32x16_bf16 v[144:159], v[176:179], v[128:131], v[144:159]
    ds_read_b128 v[188:191], v12 offset:52224
    v_mul_f32 v221, v221, v206
    s_waitcnt lgkmcnt(2)
    v_mfma_f32_32x32x16_bf16 v[144:159], v[180:183], v[132:135], v[144:159]
    v_mul_f32 v222, v222, v206
    s_waitcnt lgkmcnt(1)
    v_mfma_f32_32x32x16_bf16 v[144:159], v[184:187], v[136:139], v[144:159]
    v_mul_f32 v223, v223, v206
    s_waitcnt lgkmcnt(0)
    v_mfma_f32_32x32x16_bf16 v[144:159], v[188:191], v[140:143], v[144:159]
    s_barrier
    v_and_b32 v176, 15, v0
    v_lshlrev_b32_e64 v176, 7, v176
    s_mul_i32 s67, s13, 1792
    s_add_u32 s67, s67, s33
    v_mov_b32 v177, s67
    v_mov_b32_e64 v178, s35
    v_cndmask_b32 v177, v177, v178, s[54:55]
    s_and_b32 s67, s60, 1
    s_lshl_b32 s67, s67, 8
    s_add_u32 s67, s67, s58
    v_add_u32 v176, v176, v177
    v_writelane_b32 v176, s67, 16
    s_add_u32 s67, s67, 128
    v_writelane_b32 v176, s67, 17
    buffer_load_dword v6, v176, s[4:7], 0 offen sc1
    s_getpc_b64 s[28:29]
L_pc_49:
    s_lshr_b32 s67, s2, 3
    s_lshl_b32 s67, s67, 2
    s_add_u32 s67, s67, s14
    s_lshl_b32 s67, s67, 7
    s_add_u32 s67, s67, 1024
    s_min_u32 s67, s67, interleave_layers__linear_kernel_hedgehog__mha_block__prompt_kernel_last-L_pc_49-4
    v_mov_b32 v176, s67
    global_load_dword v6, v176, s[28:29]
    v_and_b32 v182, 31, v0
    v_lshlrev_b32 v182, 7, v182
    v_pk_fma_f32 v[144:145], v[144:145], v[8:9], v[208:209] op_sel_hi:[1,0,1]
    v_pk_fma_f32 v[146:147], v[146:147], v[8:9], v[210:211] op_sel_hi:[1,0,1]
    v_pk_fma_f32 v[148:149], v[148:149], v[8:9], v[212:213] op_sel_hi:[1,0,1]
    v_pk_fma_f32 v[150:151], v[150:151], v[8:9], v[214:215] op_sel_hi:[1,0,1]
    v_pk_fma_f32 v[152:153], v[152:153], v[8:9], v[216:217] op_sel_hi:[1,0,1]
    v_pk_fma_f32 v[154:155], v[154:155], v[8:9], v[218:219] op_sel_hi:[1,0,1]
    v_pk_fma_f32 v[156:157], v[156:157], v[8:9], v[220:221] op_sel_hi:[1,0,1]
    v_pk_fma_f32 v[158:159], v[158:159], v[8:9], v[222:223] op_sel_hi:[1,0,1]
    s_mov_b64 exec, s[54:55]
    v_mov_b32 v156, v144
    v_mov_b32 v157, v144
    v_mov_b32 v158, v144
    v_mov_b32 v159, v144
    s_mov_b64 exec, -1
    v_max3_f32 v2, v144, v145, v146
    v_max3_f32 v2, v2, v147, v148
    s_add_u32 m0, s50, 57344
    s_add_u32 s67, s32, 50176
    buffer_load_dwordx4 v15, s[4:7], s67 offen sc1 lds
    v_max3_f32 v2, v2, v149, v150
    v_max3_f32 v2, v2, v151, v152
    v_max3_f32 v2, v2, v153, v154
    v_max3_f32 v2, v2, v155, v156
    v_max3_f32 v2, v2, v157, v158
    v_max3_f32 v2, v2, v159, v159
    v_min3_f32 v4, v144, v145, v146
    v_min3_f32 v4, v4, v147, v148
    v_min3_f32 v4, v4, v149, v150
    v_min3_f32 v4, v4, v151, v152
    s_add_u32 m0, s50, 61440
    s_add_u32 s67, s32, 53760
    buffer_load_dwordx4 v15, s[4:7], s67 offen sc1 lds
    v_min3_f32 v4, v4, v153, v154
    v_min3_f32 v4, v4, v155, v156
    v_min3_f32 v4, v4, v157, v158
    v_min3_f32 v4, v4, v159, v159
    v_mov_b32 v3, v2
    v_mov_b32 v5, v4
    s_nop 0
    v_permlane32_swap_b32 v2, v3
    v_permlane32_swap_b32 v4, v5
    v_max_f32 v10, v2, v3
    v_min_f32_e64 v11, v4, v5
    s_add_u32 m0, s50, 65536
    s_add_u32 s67, s32, 57344
    buffer_load_dwordx4 v15, s[4:7], s67 offen sc1 lds
    v_pk_add_f32 v[208:209], v[144:145], v[10:11] op_sel_hi:[1,0] neg_lo:[0,1] neg_hi:[0,1]
    v_pk_add_f32 v[224:225], v[144:145], v[10:11] op_sel:[0,1] op_sel_hi:[1,1] neg_lo:[1,0] neg_hi:[1,0]
    v_pk_add_f32 v[210:211], v[146:147], v[10:11] op_sel_hi:[1,0] neg_lo:[0,1] neg_hi:[0,1]
    v_pk_add_f32 v[226:227], v[146:147], v[10:11] op_sel:[0,1] op_sel_hi:[1,1] neg_lo:[1,0] neg_hi:[1,0]
    v_pk_add_f32 v[212:213], v[148:149], v[10:11] op_sel_hi:[1,0] neg_lo:[0,1] neg_hi:[0,1]
    v_pk_add_f32 v[228:229], v[148:149], v[10:11] op_sel:[0,1] op_sel_hi:[1,1] neg_lo:[1,0] neg_hi:[1,0]
    v_pk_add_f32 v[214:215], v[150:151], v[10:11] op_sel_hi:[1,0] neg_lo:[0,1] neg_hi:[0,1]
    v_pk_add_f32 v[230:231], v[150:151], v[10:11] op_sel:[0,1] op_sel_hi:[1,1] neg_lo:[1,0] neg_hi:[1,0]
    v_pk_add_f32 v[216:217], v[152:153], v[10:11] op_sel_hi:[1,0] neg_lo:[0,1] neg_hi:[0,1]
    v_pk_add_f32 v[232:233], v[152:153], v[10:11] op_sel:[0,1] op_sel_hi:[1,1] neg_lo:[1,0] neg_hi:[1,0]
    s_add_u32 m0, s50, 69632
    s_add_u32 s67, s32, 60928
    buffer_load_dwordx4 v15, s[4:7], s67 offen sc1 lds
    v_pk_add_f32 v[218:219], v[154:155], v[10:11] op_sel_hi:[1,0] neg_lo:[0,1] neg_hi:[0,1]
    v_pk_add_f32 v[234:235], v[154:155], v[10:11] op_sel:[0,1] op_sel_hi:[1,1] neg_lo:[1,0] neg_hi:[1,0]
    v_pk_add_f32 v[220:221], v[156:157], v[10:11] op_sel_hi:[1,0] neg_lo:[0,1] neg_hi:[0,1]
    v_pk_add_f32 v[236:237], v[156:157], v[10:11] op_sel:[0,1] op_sel_hi:[1,1] neg_lo:[1,0] neg_hi:[1,0]
    v_pk_add_f32 v[222:223], v[158:159], v[10:11] op_sel_hi:[1,0] neg_lo:[0,1] neg_hi:[0,1]
    v_pk_add_f32 v[238:239], v[158:159], v[10:11] op_sel:[0,1] op_sel_hi:[1,1] neg_lo:[1,0] neg_hi:[1,0]
    v_exp_f32 v208, v208
    v_exp_f32 v224, v224
    v_exp_f32 v209, v209
    v_exp_f32 v225, v225
    v_exp_f32 v210, v210
    v_exp_f32 v226, v226
    v_exp_f32 v211, v211
    v_exp_f32 v227, v227
    v_exp_f32 v212, v212
    v_exp_f32 v228, v228
    v_exp_f32 v213, v213
    v_exp_f32 v229, v229
    v_exp_f32 v214, v214
    v_exp_f32 v230, v230
    v_exp_f32 v215, v215
    v_exp_f32 v231, v231
    v_exp_f32 v216, v216
    v_exp_f32 v232, v232
    v_exp_f32 v217, v217
    v_exp_f32 v233, v233
    v_exp_f32 v218, v218
    v_exp_f32 v234, v234
    v_exp_f32 v219, v219
    v_exp_f32 v235, v235
    v_exp_f32 v220, v220
    v_exp_f32 v236, v236
    v_exp_f32 v221, v221
    v_exp_f32 v237, v237
    v_exp_f32 v222, v222
    v_exp_f32 v238, v238
    v_exp_f32 v223, v223
    v_exp_f32 v239, v239
    s_mov_b64 exec, s[54:55]
    v_mov_b32 v220, 0
    v_mov_b32 v236, 0
    v_mov_b32 v221, 0
    v_mov_b32 v237, 0
    v_mov_b32 v222, 0
    v_mov_b32 v238, 0
    v_mov_b32 v223, 0
    v_mov_b32 v239, 0
    s_mov_b64 exec, -1
    v_pk_add_f32 v[2:3], v[208:209], v[210:211]
    v_pk_add_f32 v[4:5], v[224:225], v[226:227]
    v_pk_add_f32 v[2:3], v[2:3], v[212:213]
    v_pk_add_f32 v[4:5], v[4:5], v[228:229]
    v_pk_add_f32 v[2:3], v[2:3], v[214:215]
    v_pk_add_f32 v[4:5], v[4:5], v[230:231]
    v_pk_add_f32 v[2:3], v[2:3], v[216:217]
    v_pk_add_f32 v[4:5], v[4:5], v[232:233]
    v_pk_add_f32 v[2:3], v[2:3], v[218:219]
    v_pk_add_f32 v[4:5], v[4:5], v[234:235]
    v_pk_add_f32 v[2:3], v[2:3], v[220:221]
    v_pk_add_f32 v[4:5], v[4:5], v[236:237]
    v_pk_add_f32 v[2:3], v[2:3], v[222:223]
    v_pk_add_f32 v[4:5], v[4:5], v[238:239]
    v_add_f32 v2, v2, v3
    v_add_f32 v4, v4, v5
    v_mov_b32 v3, v2
    v_mov_b32 v5, v4
    s_nop 0
    v_permlane32_swap_b32 v2, v3
    v_permlane32_swap_b32 v4, v5
    v_add_f32 v2, v2, v3
    v_add_f32 v4, v4, v5
    v_rcp_f32 v10, v2
    v_rcp_f32 v11, v4
    s_nop 0
    v_pk_mul_f32 v[208:209], v[208:209], v[10:11] op_sel_hi:[1,0]
    v_pk_mul_f32 v[210:211], v[210:211], v[10:11] op_sel_hi:[1,0]
    v_cvt_pk_bf16_f32 v240, v208, v209
    v_cvt_pk_bf16_f32 v241, v210, v211
    v_pk_mul_f32 v[212:213], v[212:213], v[10:11] op_sel_hi:[1,0]
    v_pk_mul_f32 v[214:215], v[214:215], v[10:11] op_sel_hi:[1,0]
    v_cvt_pk_bf16_f32 v242, v212, v213
    v_cvt_pk_bf16_f32 v243, v214, v215
    v_pk_mul_f32 v[216:217], v[216:217], v[10:11] op_sel_hi:[1,0]
    v_pk_mul_f32 v[218:219], v[218:219], v[10:11] op_sel_hi:[1,0]
    v_cvt_pk_bf16_f32 v244, v216, v217
    v_cvt_pk_bf16_f32 v245, v218, v219
    v_pk_mul_f32 v[220:221], v[220:221], v[10:11] op_sel_hi:[1,0]
    v_pk_mul_f32 v[222:223], v[222:223], v[10:11] op_sel_hi:[1,0]
    v_cvt_pk_bf16_f32 v246, v220, v221
    v_cvt_pk_bf16_f32 v247, v222, v223
    v_pk_mul_f32 v[224:225], v[224:225], v[10:11] op_sel:[0,1] op_sel_hi:[1,1]
    v_pk_mul_f32 v[226:227], v[226:227], v[10:11] op_sel:[0,1] op_sel_hi:[1,1]
    v_cvt_pk_bf16_f32 v248, v224, v225
    v_cvt_pk_bf16_f32 v249, v226, v227
    v_pk_mul_f32 v[228:229], v[228:229], v[10:11] op_sel:[0,1] op_sel_hi:[1,1]
    v_pk_mul_f32 v[230:231], v[230:231], v[10:11] op_sel:[0,1] op_sel_hi:[1,1]
    v_cvt_pk_bf16_f32 v250, v228, v229
    v_cvt_pk_bf16_f32 v251, v230, v231
    v_pk_mul_f32 v[232:233], v[232:233], v[10:11] op_sel:[0,1] op_sel_hi:[1,1]
    v_pk_mul_f32 v[234:235], v[234:235], v[10:11] op_sel:[0,1] op_sel_hi:[1,1]
    v_cvt_pk_bf16_f32 v252, v232, v233
    v_cvt_pk_bf16_f32 v253, v234, v235
    v_pk_mul_f32 v[236:237], v[236:237], v[10:11] op_sel:[0,1] op_sel_hi:[1,1]
    v_pk_mul_f32 v[238:239], v[238:239], v[10:11] op_sel:[0,1] op_sel_hi:[1,1]
    v_cvt_pk_bf16_f32 v254, v236, v237
    v_cvt_pk_bf16_f32 v255, v238, v239
    buffer_load_dword v9, v182, s[4:7], s41 offen sc1
    s_add_u32 s17, s50, 110592
    v_add_u32_e64 v12, s17, v1
    v_add_u32 v13, 110592, v1
    v_accvgpr_read_b32 v192, a112
    v_accvgpr_read_b32 v193, a113
    v_accvgpr_read_b32 v194, a114
    s_waitcnt vmcnt(0)
    v_cmp_ne_u32 vcc, s56, v9
    s_cbranch_vccnz L_kvpwait_51
L_kvpok_50:
    s_xor_b32 s18, s38, 0
    buffer_load_dwordx4 v[32:35], v1, s[4:7], s18 offen sc1
    s_xor_b32 s18, s38, 4096
    buffer_load_dwordx4 v[36:39], v1, s[4:7], s18 offen sc1
    s_xor_b32 s18, s38, 8192
    buffer_load_dwordx4 v[40:43], v1, s[4:7], s18 offen sc1
    s_xor_b32 s18, s38, 12288
    buffer_load_dwordx4 v[44:47], v1, s[4:7], s18 offen sc1
    s_xor_b32 s18, s38, 16384
    buffer_load_dwordx4 v[48:51], v1, s[4:7], s18 offen sc1
    s_xor_b32 s18, s38, 20480
    buffer_load_dwordx4 v[52:55], v1, s[4:7], s18 offen sc1
    s_xor_b32 s18, s38, 24576
    buffer_load_dwordx4 v[56:59], v1, s[4:7], s18 offen sc1
    s_xor_b32 s18, s38, 28672
    buffer_load_dwordx4 v[60:63], v1, s[4:7], s18 offen sc1
    s_xor_b32 s18, s38, 32768
    buffer_load_dwordx4 v[64:67], v1, s[4:7], s18 offen sc1
    s_xor_b32 s18, s38, 36864
    buffer_load_dwordx4 v[68:71], v1, s[4:7], s18 offen sc1
    s_xor_b32 s18, s38, 40960
    buffer_load_dwordx4 v[72:75], v1, s[4:7], s18 offen sc1
    s_xor_b32 s18, s38, 45056
    buffer_load_dwordx4 v[76:79], v1, s[4:7], s18 offen sc1
    s_xor_b32 s18, s38, 49152
    buffer_load_dwordx4 v[80:83], v1, s[4:7], s18 offen sc1
    s_xor_b32 s18, s38, 53248
    buffer_load_dwordx4 v[84:87], v1, s[4:7], s18 offen sc1
    s_xor_b32 s18, s38, 57344
    buffer_load_dwordx4 v[88:91], v1, s[4:7], s18 offen sc1
    s_xor_b32 s18, s38, 61440
    buffer_load_dwordx4 v[92:95], v1, s[4:7], s18 offen sc1
    s_waitcnt vmcnt(15)
    v_lshlrev_b32 v160, 16, v32
    v_and_b32 v161, 0xffff0000, v32
    v_lshlrev_b32_e64 v162, 16, v33
    v_and_b32 v163, 0xffff0000, v33
    v_lshlrev_b32_e64 v164, 16, v34
    v_and_b32 v165, 0xffff0000, v34
    v_lshlrev_b32_e64 v166, 16, v35
    v_and_b32 v167, 0xffff0000, v35
    s_waitcnt vmcnt(14)
    v_lshlrev_b32 v168, 16, v36
    v_and_b32 v169, 0xffff0000, v36
    v_pk_add_f32 v[160:161], v[160:161], v[168:169]
    v_lshlrev_b32_e64 v170, 16, v37
    v_and_b32 v171, 0xffff0000, v37
    v_pk_add_f32 v[162:163], v[162:163], v[170:171]
    v_lshlrev_b32_e64 v168, 16, v38
    v_and_b32 v169, 0xffff0000, v38
    v_pk_add_f32 v[164:165], v[164:165], v[168:169]
    v_lshlrev_b32_e64 v170, 16, v39
    v_and_b32 v171, 0xffff0000, v39
    v_pk_add_f32 v[166:167], v[166:167], v[170:171]
    s_waitcnt vmcnt(13)
    v_lshlrev_b32 v168, 16, v40
    v_and_b32 v169, 0xffff0000, v40
    v_pk_add_f32 v[160:161], v[160:161], v[168:169]
    v_lshlrev_b32_e64 v170, 16, v41
    v_and_b32 v171, 0xffff0000, v41
    v_pk_add_f32 v[162:163], v[162:163], v[170:171]
    v_lshlrev_b32_e64 v168, 16, v42
    v_and_b32 v169, 0xffff0000, v42
    v_pk_add_f32 v[164:165], v[164:165], v[168:169]
    v_lshlrev_b32_e64 v170, 16, v43
    v_and_b32 v171, 0xffff0000, v43
    v_pk_add_f32 v[166:167], v[166:167], v[170:171]
    s_waitcnt vmcnt(12)
    v_lshlrev_b32 v168, 16, v44
    v_and_b32 v169, 0xffff0000, v44
    v_pk_add_f32 v[160:161], v[160:161], v[168:169]
    v_lshlrev_b32_e64 v170, 16, v45
    v_and_b32 v171, 0xffff0000, v45
    v_pk_add_f32 v[162:163], v[162:163], v[170:171]
    v_lshlrev_b32_e64 v168, 16, v46
    v_and_b32 v169, 0xffff0000, v46
    v_pk_add_f32 v[164:165], v[164:165], v[168:169]
    v_lshlrev_b32_e64 v170, 16, v47
    v_and_b32 v171, 0xffff0000, v47
    v_pk_add_f32 v[166:167], v[166:167], v[170:171]
    s_waitcnt vmcnt(11)
    v_lshlrev_b32 v168, 16, v48
    v_and_b32 v169, 0xffff0000, v48
    v_pk_add_f32 v[160:161], v[160:161], v[168:169]
    v_lshlrev_b32_e64 v170, 16, v49
    v_and_b32 v171, 0xffff0000, v49
    v_pk_add_f32 v[162:163], v[162:163], v[170:171]
    v_lshlrev_b32_e64 v168, 16, v50
    v_and_b32 v169, 0xffff0000, v50
    v_pk_add_f32 v[164:165], v[164:165], v[168:169]
    v_lshlrev_b32_e64 v170, 16, v51
    v_and_b32 v171, 0xffff0000, v51
    v_pk_add_f32 v[166:167], v[166:167], v[170:171]
    s_waitcnt vmcnt(10)
    v_lshlrev_b32 v168, 16, v52
    v_and_b32 v169, 0xffff0000, v52
    v_pk_add_f32 v[160:161], v[160:161], v[168:169]
    v_lshlrev_b32_e64 v170, 16, v53
    v_and_b32 v171, 0xffff0000, v53
    v_pk_add_f32 v[162:163], v[162:163], v[170:171]
    v_lshlrev_b32_e64 v168, 16, v54
    v_and_b32 v169, 0xffff0000, v54
    v_pk_add_f32 v[164:165], v[164:165], v[168:169]
    v_lshlrev_b32_e64 v170, 16, v55
    v_and_b32 v171, 0xffff0000, v55
    v_pk_add_f32 v[166:167], v[166:167], v[170:171]
    s_waitcnt vmcnt(9)
    v_lshlrev_b32 v168, 16, v56
    v_and_b32 v169, 0xffff0000, v56
    v_pk_add_f32 v[160:161], v[160:161], v[168:169]
    v_lshlrev_b32_e64 v170, 16, v57
    v_and_b32 v171, 0xffff0000, v57
    v_pk_add_f32 v[162:163], v[162:163], v[170:171]
    v_lshlrev_b32_e64 v168, 16, v58
    v_and_b32 v169, 0xffff0000, v58
    v_pk_add_f32 v[164:165], v[164:165], v[168:169]
    v_lshlrev_b32_e64 v170, 16, v59
    v_and_b32 v171, 0xffff0000, v59
    v_pk_add_f32 v[166:167], v[166:167], v[170:171]
    s_waitcnt vmcnt(8)
    v_lshlrev_b32 v168, 16, v60
    v_and_b32 v169, 0xffff0000, v60
    v_pk_add_f32 v[160:161], v[160:161], v[168:169]
    v_lshlrev_b32_e64 v170, 16, v61
    v_and_b32 v171, 0xffff0000, v61
    v_pk_add_f32 v[162:163], v[162:163], v[170:171]
    v_lshlrev_b32_e64 v168, 16, v62
    v_and_b32 v169, 0xffff0000, v62
    v_pk_add_f32 v[164:165], v[164:165], v[168:169]
    v_lshlrev_b32_e64 v170, 16, v63
    v_and_b32 v171, 0xffff0000, v63
    v_pk_add_f32 v[166:167], v[166:167], v[170:171]
    s_waitcnt vmcnt(7)
    v_lshlrev_b32 v168, 16, v64
    v_and_b32 v169, 0xffff0000, v64
    v_pk_add_f32 v[160:161], v[160:161], v[168:169]
    v_lshlrev_b32_e64 v170, 16, v65
    v_and_b32 v171, 0xffff0000, v65
    v_pk_add_f32 v[162:163], v[162:163], v[170:171]
    v_lshlrev_b32_e64 v168, 16, v66
    v_and_b32 v169, 0xffff0000, v66
    v_pk_add_f32 v[164:165], v[164:165], v[168:169]
    v_lshlrev_b32_e64 v170, 16, v67
    v_and_b32 v171, 0xffff0000, v67
    v_pk_add_f32 v[166:167], v[166:167], v[170:171]
    s_waitcnt vmcnt(6)
    v_lshlrev_b32 v168, 16, v68
    v_and_b32 v169, 0xffff0000, v68
    v_pk_add_f32 v[160:161], v[160:161], v[168:169]
    v_lshlrev_b32_e64 v170, 16, v69
    v_and_b32 v171, 0xffff0000, v69
    v_pk_add_f32 v[162:163], v[162:163], v[170:171]
    v_lshlrev_b32_e64 v168, 16, v70
    v_and_b32 v169, 0xffff0000, v70
    v_pk_add_f32 v[164:165], v[164:165], v[168:169]
    v_lshlrev_b32_e64 v170, 16, v71
    v_and_b32 v171, 0xffff0000, v71
    v_pk_add_f32 v[166:167], v[166:167], v[170:171]
    s_waitcnt vmcnt(5)
    v_lshlrev_b32 v168, 16, v72
    v_and_b32 v169, 0xffff0000, v72
    v_pk_add_f32 v[160:161], v[160:161], v[168:169]
    v_lshlrev_b32_e64 v170, 16, v73
    v_and_b32 v171, 0xffff0000, v73
    v_pk_add_f32 v[162:163], v[162:163], v[170:171]
    v_lshlrev_b32_e64 v168, 16, v74
    v_and_b32 v169, 0xffff0000, v74
    v_pk_add_f32 v[164:165], v[164:165], v[168:169]
    v_lshlrev_b32_e64 v170, 16, v75
    v_and_b32 v171, 0xffff0000, v75
    v_pk_add_f32 v[166:167], v[166:167], v[170:171]
    s_waitcnt vmcnt(4)
    v_lshlrev_b32 v168, 16, v76
    v_and_b32 v169, 0xffff0000, v76
    v_pk_add_f32 v[160:161], v[160:161], v[168:169]
    v_lshlrev_b32_e64 v170, 16, v77
    v_and_b32 v171, 0xffff0000, v77
    v_pk_add_f32 v[162:163], v[162:163], v[170:171]
    v_lshlrev_b32_e64 v168, 16, v78
    v_and_b32 v169, 0xffff0000, v78
    v_pk_add_f32 v[164:165], v[164:165], v[168:169]
    v_lshlrev_b32_e64 v170, 16, v79
    v_and_b32 v171, 0xffff0000, v79
    v_pk_add_f32 v[166:167], v[166:167], v[170:171]
    s_waitcnt vmcnt(3)
    v_lshlrev_b32 v168, 16, v80
    v_and_b32 v169, 0xffff0000, v80
    v_pk_add_f32 v[160:161], v[160:161], v[168:169]
    v_lshlrev_b32_e64 v170, 16, v81
    v_and_b32 v171, 0xffff0000, v81
    v_pk_add_f32 v[162:163], v[162:163], v[170:171]
    v_lshlrev_b32_e64 v168, 16, v82
    v_and_b32 v169, 0xffff0000, v82
    v_pk_add_f32 v[164:165], v[164:165], v[168:169]
    v_lshlrev_b32_e64 v170, 16, v83
    v_and_b32 v171, 0xffff0000, v83
    v_pk_add_f32 v[166:167], v[166:167], v[170:171]
    s_waitcnt vmcnt(2)
    v_lshlrev_b32 v168, 16, v84
    v_and_b32 v169, 0xffff0000, v84
    v_pk_add_f32 v[160:161], v[160:161], v[168:169]
    v_lshlrev_b32_e64 v170, 16, v85
    v_and_b32 v171, 0xffff0000, v85
    v_pk_add_f32 v[162:163], v[162:163], v[170:171]
    v_lshlrev_b32_e64 v168, 16, v86
    v_and_b32 v169, 0xffff0000, v86
    v_pk_add_f32 v[164:165], v[164:165], v[168:169]
    v_lshlrev_b32_e64 v170, 16, v87
    v_and_b32 v171, 0xffff0000, v87
    v_pk_add_f32 v[166:167], v[166:167], v[170:171]
    s_waitcnt vmcnt(1)
    v_lshlrev_b32 v168, 16, v88
    v_and_b32 v169, 0xffff0000, v88
    v_pk_add_f32 v[160:161], v[160:161], v[168:169]
    v_lshlrev_b32_e64 v170, 16, v89
    v_and_b32 v171, 0xffff0000, v89
    v_pk_add_f32 v[162:163], v[162:163], v[170:171]
    v_lshlrev_b32_e64 v168, 16, v90
    v_and_b32 v169, 0xffff0000, v90
    v_pk_add_f32 v[164:165], v[164:165], v[168:169]
    v_lshlrev_b32_e64 v170, 16, v91
    v_and_b32 v171, 0xffff0000, v91
    v_pk_add_f32 v[166:167], v[166:167], v[170:171]
    s_waitcnt vmcnt(0)
    v_lshlrev_b32 v168, 16, v92
    v_and_b32 v169, 0xffff0000, v92
    v_pk_add_f32 v[160:161], v[160:161], v[168:169]
    v_lshlrev_b32_e64 v170, 16, v93
    v_and_b32 v171, 0xffff0000, v93
    v_pk_add_f32 v[162:163], v[162:163], v[170:171]
    v_lshlrev_b32_e64 v168, 16, v94
    v_and_b32 v169, 0xffff0000, v94
    v_pk_add_f32 v[164:165], v[164:165], v[168:169]
    v_lshlrev_b32_e64 v170, 16, v95
    v_and_b32 v171, 0xffff0000, v95
    v_pk_add_f32 v[166:167], v[166:167], v[170:171]
    v_cvt_pk_bf16_f32 v208, v160, v161
    v_cvt_pk_bf16_f32 v209, v162, v163
    v_cvt_pk_bf16_f32 v210, v164, v165
    v_cvt_pk_bf16_f32 v211, v166, v167
    ds_write_b128 v12, v[208:211]
    s_waitcnt lgkmcnt(0)
    s_barrier
    ds_read_b128 v[224:227], v13 offset:0
    ds_read_b128 v[228:231], v13 offset:1024
    ds_read_b128 v[232:235], v13 offset:2048
    ds_read_b128 v[236:239], v13 offset:3072
    s_waitcnt lgkmcnt(3)
    v_mfma_f32_32x32x16_bf16 v[144:159], v[224:227], v[240:243], 0
    s_waitcnt lgkmcnt(2)
    v_mfma_f32_32x32x16_bf16 v[144:159], v[228:231], v[244:247], v[144:159]
    s_waitcnt lgkmcnt(1)
    v_mfma_f32_32x32x16_bf16 v[144:159], v[232:235], v[248:251], v[144:159]
    s_waitcnt lgkmcnt(0)
    v_mfma_f32_32x32x16_bf16 v[144:159], v[236:239], v[252:255], v[144:159]
    s_add_u32 s57, s56, 3
    v_mov_b32 v9, s57
    v_and_b32 v13, 3, v0
    v_lshlrev_b32 v13, 2, v13
    s_mul_i32 s19, s14, 7168
    s_add_u32 s19, s19, 114688
    v_add_u32 v12, 114688, v1
    s_nop 4
    v_mov_b32 v2, v156
    v_mov_b32_e64 v3, v156
    s_nop 1
    v_permlane32_swap_b32 v2, v3
    v_add_f32 v3, 897988541, v3
    v_rcp_f32 v10, v3
    s_nop 0
    v_pk_mul_f32 v[144:145], v[144:145], v[10:11] op_sel_hi:[1,0]
    v_pk_mul_f32 v[146:147], v[146:147], v[10:11] op_sel_hi:[1,0]
    v_pk_mul_f32 v[148:149], v[148:149], v[10:11] op_sel_hi:[1,0]
    v_pk_mul_f32 v[150:151], v[150:151], v[10:11] op_sel_hi:[1,0]
    v_pk_mul_f32 v[152:153], v[152:153], v[10:11] op_sel_hi:[1,0]
    v_pk_mul_f32 v[154:155], v[154:155], v[10:11] op_sel_hi:[1,0]
    v_pk_mul_f32 v[156:157], v[156:157], v[10:11] op_sel_hi:[1,0]
    v_pk_mul_f32 v[158:159], v[158:159], v[10:11] op_sel_hi:[1,0]
    v_cvt_pk_bf16_f32 v208, v144, v145
    v_cvt_pk_bf16_f32 v209, v146, v147
    v_cvt_pk_bf16_f32 v210, v148, v149
    v_cvt_pk_bf16_f32 v211, v150, v151
    v_cvt_pk_bf16_f32 v212, v152, v153
    v_cvt_pk_bf16_f32 v213, v154, v155
    v_cvt_pk_bf16_f32 v214, v156, v157
    v_cvt_pk_bf16_f32 v215, v158, v159
    s_cmp_eq_u32 s16, 0
    s_cbranch_scc0 L_slow_52
    buffer_store_dwordx2 v[208:209], v192, s[4:7], s33 offen
    buffer_store_dwordx2 v[210:211], v193, s[4:7], s33 offen
    buffer_store_dwordx2 v[212:213], v192, s[4:7], s33 offen offset:1024
    buffer_store_dwordx2 v[214:215], v194, s[4:7], s33 offen offset:1024
L_join_53:
    s_waitcnt vmcnt(0)
    s_mov_b64 exec, 1
    s_cmp_eq_u32 s16, 0
    s_cbranch_scc0 L_slow_54
    buffer_store_dword v9, off, s[4:7], s44
L_join_55:
    s_mov_b64 exec, -1
    s_add_u32 s57, s56, 3
L_poll_56:
    buffer_load_dword v5, v13, s[4:7], s45 offen sc1
    s_waitcnt vmcnt(0)
    v_cmp_ne_u32 vcc, s57, v5
    s_cbranch_vccnz L_retry_57
    s_add_u32 m0, s19, 0
    s_add_u32 s18, s34, 0
    buffer_load_dwordx4 v1, s[4:7], s18 offen offset:0 sc1 lds
    buffer_load_dwordx4 v1, s[4:7], s18 offen offset:1024 sc1 lds
    buffer_load_dwordx4 v1, s[4:7], s18 offen offset:2048 sc1 lds
    buffer_load_dwordx4 v1, s[4:7], s18 offen offset:3072 sc1 lds
    s_add_u32 m0, s19, 4096
    s_add_u32 s18, s34, 4096
    buffer_load_dwordx4 v1, s[4:7], s18 offen offset:0 sc1 lds
    buffer_load_dwordx4 v1, s[4:7], s18 offen offset:1024 sc1 lds
    buffer_load_dwordx4 v1, s[4:7], s18 offen offset:2048 sc1 lds
    s_add_u32 s17, s14, 0
    s_and_b32 s17, s17, 3
    s_add_u32 s17, s17, 0
    s_mul_i32 s17, s17, 7168
    v_add_u32 v192, s17, v12
    s_add_u32 s17, s14, 1
    s_and_b32 s17, s17, 3
    s_add_u32 s17, s17, 0
    s_mul_i32 s17, s17, 7168
    v_add_u32 v193, s17, v12
    s_add_u32 s17, s14, 2
    s_and_b32 s17, s17, 3
    s_add_u32 s17, s17, 0
    s_mul_i32 s17, s17, 7168
    v_add_u32 v194, s17, v12
    s_add_u32 s17, s14, 3
    s_and_b32 s17, s17, 3
    s_add_u32 s17, s17, 0
    s_mul_i32 s17, s17, 7168
    v_add_u32 v195, s17, v12
    s_cmp_ge_u32 s36, 14
    s_cbranch_scc1 L_woskip_58
    s_waitcnt vmcnt(6)
    ds_read_b128 v[176:179], v192 offset:0
    s_waitcnt vmcnt(5)
    ds_read_b128 v[180:183], v192 offset:1024
    s_waitcnt vmcnt(4)
    ds_read_b128 v[184:187], v192 offset:2048
    s_waitcnt lgkmcnt(2)
    v_mfma_f32_32x32x16_bf16 v[16:31], a[0:3], v[176:179], v[16:31]
    s_waitcnt vmcnt(3)
    ds_read_b128 v[188:191], v192 offset:3072
    s_waitcnt lgkmcnt(2)
    v_mfma_f32_32x32x16_bf16 v[16:31], a[4:7], v[180:183], v[16:31]
    s_waitcnt vmcnt(2)
    ds_read_b128 v[176:179], v192 offset:4096
    s_waitcnt lgkmcnt(2)
    v_mfma_f32_32x32x16_bf16 v[16:31], a[8:11], v[184:187], v[16:31]
    s_waitcnt vmcnt(1)
    ds_read_b128 v[180:183], v192 offset:5120
    s_waitcnt lgkmcnt(2)
    v_mfma_f32_32x32x16_bf16 v[16:31], a[12:15], v[188:191], v[16:31]
    s_waitcnt vmcnt(0)
    ds_read_b128 v[184:187], v192 offset:6144
    s_waitcnt lgkmcnt(2)
    v_mfma_f32_32x32x16_bf16 v[16:31], a[16:19], v[176:179], v[16:31]
    s_barrier
    ds_read_b128 v[188:191], v193 offset:0
    s_waitcnt lgkmcnt(2)
    v_mfma_f32_32x32x16_bf16 v[16:31], a[20:23], v[180:183], v[16:31]
    ds_read_b128 v[176:179], v193 offset:1024
    s_waitcnt lgkmcnt(2)
    v_mfma_f32_32x32x16_bf16 v[16:31], a[24:27], v[184:187], v[16:31]
    s_add_u32 m0, s50, 73728
    s_add_u32 s67, s32, 64512
    buffer_load_dwordx4 v15, s[4:7], s67 offen sc1 lds
    ds_read_b128 v[180:183], v193 offset:2048
    s_waitcnt lgkmcnt(2)
    v_mfma_f32_32x32x16_bf16 v[16:31], a[28:31], v[188:191], v[16:31]
    ds_read_b128 v[184:187], v193 offset:3072
    s_waitcnt lgkmcnt(2)
    v_mfma_f32_32x32x16_bf16 v[16:31], a[32:35], v[176:179], v[16:31]
    s_add_u32 m0, s50, 77824
    s_add_u32 s67, s32, 68096
    buffer_load_dwordx4 v15, s[4:7], s67 offen sc1 lds
    ds_read_b128 v[188:191], v193 offset:4096
    s_waitcnt lgkmcnt(2)
    v_mfma_f32_32x32x16_bf16 v[16:31], a[36:39], v[180:183], v[16:31]
    ds_read_b128 v[176:179], v193 offset:5120
    s_waitcnt lgkmcnt(2)
    v_mfma_f32_32x32x16_bf16 v[16:31], a[40:43], v[184:187], v[16:31]
    s_add_u32 m0, s50, 81920
    s_add_u32 s67, s32, 71680
    buffer_load_dwordx4 v15, s[4:7], s67 offen sc1 lds
    ds_read_b128 v[180:183], v193 offset:6144
    s_waitcnt lgkmcnt(2)
    v_mfma_f32_32x32x16_bf16 v[16:31], a[44:47], v[188:191], v[16:31]
    ds_read_b128 v[184:187], v194 offset:0
    s_waitcnt lgkmcnt(2)
    v_mfma_f32_32x32x16_bf16 v[16:31], a[48:51], v[176:179], v[16:31]
    ds_read_b128 v[188:191], v194 offset:1024
    s_waitcnt lgkmcnt(2)
    v_mfma_f32_32x32x16_bf16 v[16:31], a[52:55], v[180:183], v[16:31]
    ds_read_b128 v[176:179], v194 offset:2048
    s_waitcnt lgkmcnt(2)
    v_mfma_f32_32x32x16_bf16 v[16:31], a[56:59], v[184:187], v[16:31]
    ds_read_b128 v[180:183], v194 offset:3072
    s_waitcnt lgkmcnt(2)
    v_mfma_f32_32x32x16_bf16 v[16:31], a[60:63], v[188:191], v[16:31]
    ds_read_b128 v[184:187], v194 offset:4096
    s_waitcnt lgkmcnt(2)
    v_mfma_f32_32x32x16_bf16 v[16:31], a[64:67], v[176:179], v[16:31]
    ds_read_b128 v[188:191], v194 offset:5120
    s_waitcnt lgkmcnt(2)
    v_mfma_f32_32x32x16_bf16 v[16:31], a[68:71], v[180:183], v[16:31]
    ds_read_b128 v[176:179], v194 offset:6144
    s_waitcnt lgkmcnt(2)
    v_mfma_f32_32x32x16_bf16 v[16:31], a[72:75], v[184:187], v[16:31]
    ds_read_b128 v[180:183], v195 offset:0
    s_waitcnt lgkmcnt(2)
    v_mfma_f32_32x32x16_bf16 v[16:31], a[76:79], v[188:191], v[16:31]
    ds_read_b128 v[184:187], v195 offset:1024
    s_waitcnt lgkmcnt(2)
    v_mfma_f32_32x32x16_bf16 v[16:31], a[80:83], v[176:179], v[16:31]
    ds_read_b128 v[188:191], v195 offset:2048
    s_waitcnt lgkmcnt(2)
    v_mfma_f32_32x32x16_bf16 v[16:31], a[84:87], v[180:183], v[16:31]
    ds_read_b128 v[176:179], v195 offset:3072
    s_waitcnt lgkmcnt(2)
    v_mfma_f32_32x32x16_bf16 v[16:31], a[88:91], v[184:187], v[16:31]
    ds_read_b128 v[180:183], v195 offset:4096
    s_waitcnt lgkmcnt(2)
    v_mfma_f32_32x32x16_bf16 v[16:31], a[92:95], v[188:191], v[16:31]
    ds_read_b128 v[184:187], v195 offset:5120
    s_waitcnt lgkmcnt(2)
    v_mfma_f32_32x32x16_bf16 v[16:31], a[96:99], v[176:179], v[16:31]
    ds_read_b128 v[188:191], v195 offset:6144
    s_waitcnt lgkmcnt(2)
    v_mfma_f32_32x32x16_bf16 v[16:31], a[100:103], v[180:183], v[16:31]
    s_waitcnt lgkmcnt(1)
    v_mfma_f32_32x32x16_bf16 v[16:31], a[104:107], v[184:187], v[16:31]
    s_waitcnt lgkmcnt(0)
    v_mfma_f32_32x32x16_bf16 v[16:31], a[108:111], v[188:191], v[16:31]
    v_and_b32 v13, 31, v0
    v_lshlrev_b32 v13, 4, v13
    s_nop 9
    v_cvt_pk_bf16_f32 v208, v16, v17
    v_cvt_pk_bf16_f32 v209, v18, v19
    v_cvt_pk_bf16_f32 v210, v20, v21
    v_cvt_pk_bf16_f32 v211, v22, v23
    v_cvt_pk_bf16_f32 v212, v24, v25
    v_cvt_pk_bf16_f32 v213, v26, v27
    v_cvt_pk_bf16_f32 v214, v28, v29
    v_cvt_pk_bf16_f32 v215, v30, v31
    s_cmp_eq_u32 s16, 0
    s_cbranch_scc0 L_slow_60
    buffer_store_dwordx4 v[208:211], v1, s[4:7], s35 offen
    buffer_store_dwordx4 v[212:215], v1, s[4:7], s35 offen offset:1024
L_join_61:
    v_pk_mul_f32 v[4:5], v[16:17], v[16:17]
    v_pk_add_f32 v[2:3], v[16:17], v[18:19]
    v_pk_fma_f32 v[4:5], v[18:19], v[18:19], v[4:5]
    v_pk_fma_f32 v[4:5], v[20:21], v[20:21], v[4:5]
    v_pk_add_f32 v[2:3], v[2:3], v[20:21]
    v_pk_fma_f32 v[4:5], v[22:23], v[22:23], v[4:5]
    v_pk_add_f32 v[2:3], v[2:3], v[22:23]
    v_pk_fma_f32 v[4:5], v[24:25], v[24:25], v[4:5]
    v_pk_add_f32 v[2:3], v[2:3], v[24:25]
    v_pk_fma_f32 v[4:5], v[26:27], v[26:27], v[4:5]
    v_pk_add_f32 v[2:3], v[2:3], v[26:27]
    v_pk_fma_f32 v[4:5], v[28:29], v[28:29], v[4:5]
    v_pk_add_f32 v[2:3], v[2:3], v[28:29]
    v_pk_fma_f32 v[4:5], v[30:31], v[30:31], v[4:5]
    v_pk_add_f32 v[2:3], v[2:3], v[30:31]
    v_add_f32 v2, v2, v3
    v_add_f32 v3, v4, v5
    v_mov_b32 v4, v2
    v_mov_b32_e64 v5, v3
    s_nop 0
    v_permlane32_swap_b32 v2, v4
    v_permlane32_swap_b32 v3, v5
    v_pk_add_f32 v[4:5], v[4:5], v[2:3]
    s_cmp_eq_u32 s16, 0
    s_cbranch_scc0 L_slow_62
    buffer_store_dwordx2 v[4:5], v13, s[4:7], s58 offen
L_join_63:
    s_add_u32 s57, s56, 3
    v_mov_b32 v9, s57
    s_waitcnt vmcnt(0)
    s_mov_b64 exec, 1
    s_cmp_eq_u32 s16, 0
    s_cbranch_scc0 L_slow_64
    buffer_store_dword v9, off, s[4:7], s46
L_join_65:
    s_mov_b64 exec, -1
L_wojoin_59:
    v_and_b32 v2, 15, v0
    v_min_u32 v2, 13, v2
    v_lshlrev_b32 v2, 2, v2
    s_barrier
    s_add_u32 s57, s56, 3
L_poll_66:
    buffer_load_dword v5, v2, s[4:7], s47 offen sc1
    s_waitcnt vmcnt(0)
    v_cmp_ne_u32 vcc, s57, v5
    s_cbranch_vccnz L_retry_67
    s_add_u32 s66, s30, 0
    buffer_load_dwordx4 v[32:35], v1, s[4:7], s66 offen offset:0 sc1
    buffer_load_dwordx4 v[36:39], v1, s[4:7], s66 offen offset:1024 sc1
    buffer_load_dwordx4 v[40:43], v1, s[4:7], s66 offen offset:2048 sc1
    buffer_load_dwordx4 v[44:47], v1, s[4:7], s66 offen offset:3072 sc1
    s_add_u32 s66, s30, 4096
    buffer_load_dwordx4 v[48:51], v1, s[4:7], s66 offen offset:0 sc1
    buffer_load_dwordx4 v[52:55], v1, s[4:7], s66 offen offset:1024 sc1
    buffer_load_dwordx4 v[56:59], v1, s[4:7], s66 offen offset:2048 sc1
    buffer_load_dwordx4 v[60:63], v1, s[4:7], s66 offen offset:3072 sc1
    v_and_b32 v2, 31, v0
    v_lshrrev_b32_e64 v3, 5, v0
    s_lshl_b32 s17, s14, 11
    s_add_u32 s17, s17, 139264
    v_bfe_u32 v5, v0, 1, 3
    v_xor_b32 v5, v5, v3
    v_lshlrev_b32 v5, 3, v5
    v_lshl_add_u32 v5, v2, 6, v5
    v_add_u32_e64 v248, s17, v5
    v_bfe_u32 v2, v0, 2, 2
    v_lshl_add_u32 v4, v3, 3, v2
    v_bfe_u32 v5, v0, 3, 1
    v_lshl_or_b32 v5, v3, 2, v5
    v_and_b32_e64 v12, 3, v0
    v_bfe_u32 v2, v0, 4, 1
    v_lshl_or_b32 v12, v2, 2, v12
    v_xor_b32 v5, v5, v12
    v_lshlrev_b32 v5, 3, v5
    v_lshl_add_u32 v5, v4, 6, v5
    v_add_u32 v249, s17, v5
    v_xor_b32 v250, 16, v249
    v_add_u32 v250, 256, v250
    ds_read_b128 v[176:179], v1 offset:0
    ds_read_b128 v[180:183], v1 offset:28672
    ds_read_b128 v[184:187], v1 offset:1024
    ds_read_b128 v[188:191], v1 offset:29696
    v_lshrrev_b32 v3, 5, v0
    v_and_b32 v4, 31, v0
    v_lshlrev_b32_e64 v4, 4, v4
    v_mul_u32_u24 v14, 1536, v3
    v_add_u32_e64 v14, v14, v4
    v_lshl_add_u32 v4, v3, 3, v4
    s_waitcnt vmcnt(7) lgkmcnt(2)
    v_mfma_f32_32x32x16_bf16 v[144:159], v[176:179], v[32:35], 0
    s_add_u32 s66, s30, 8192
    buffer_load_dwordx4 v[64:67], v1, s[4:7], s66 offen offset:0 sc1
    ds_read_b128 v[192:195], v1 offset:2048
    v_mfma_f32_32x32x16_bf16 v[160:175], v[180:183], v[32:35], 0
    ds_read_b128 v[196:199], v1 offset:30720
    s_waitcnt vmcnt(7) lgkmcnt(2)
    v_mfma_f32_32x32x16_bf16 v[144:159], v[184:187], v[36:39], v[144:159]
    buffer_load_dwordx4 v[68:71], v1, s[4:7], s66 offen offset:1024 sc1
    ds_read_b128 v[176:179], v1 offset:3072
    v_mfma_f32_32x32x16_bf16 v[160:175], v[188:191], v[36:39], v[160:175]
    ds_read_b128 v[180:183], v1 offset:31744
    s_waitcnt vmcnt(7) lgkmcnt(2)
    v_mfma_f32_32x32x16_bf16 v[144:159], v[192:195], v[40:43], v[144:159]
    buffer_load_dwordx4 v[72:75], v1, s[4:7], s66 offen offset:2048 sc1
    ds_read_b128 v[184:187], v1 offset:4096
    v_mfma_f32_32x32x16_bf16 v[160:175], v[196:199], v[40:43], v[160:175]
    ds_read_b128 v[188:191], v1 offset:32768
    s_waitcnt vmcnt(7) lgkmcnt(2)
    v_mfma_f32_32x32x16_bf16 v[144:159], v[176:179], v[44:47], v[144:159]
    buffer_load_dwordx4 v[76:79], v1, s[4:7], s66 offen offset:3072 sc1
    ds_read_b128 v[192:195], v1 offset:5120
    v_mfma_f32_32x32x16_bf16 v[160:175], v[180:183], v[44:47], v[160:175]
    ds_read_b128 v[196:199], v1 offset:33792
    s_waitcnt vmcnt(7) lgkmcnt(2)
    v_mfma_f32_32x32x16_bf16 v[144:159], v[184:187], v[48:51], v[144:159]
    s_add_u32 s66, s30, 12288
    buffer_load_dwordx4 v[80:83], v1, s[4:7], s66 offen offset:0 sc1
    ds_read_b128 v[176:179], v1 offset:6144
    v_mfma_f32_32x32x16_bf16 v[160:175], v[188:191], v[48:51], v[160:175]
    ds_read_b128 v[180:183], v1 offset:34816
    s_waitcnt vmcnt(7) lgkmcnt(2)
    v_mfma_f32_32x32x16_bf16 v[144:159], v[192:195], v[52:55], v[144:159]
    buffer_load_dwordx4 v[84:87], v1, s[4:7], s66 offen offset:1024 sc1
    ds_read_b128 v[184:187], v1 offset:7168
    v_mfma_f32_32x32x16_bf16 v[160:175], v[196:199], v[52:55], v[160:175]
    ds_read_b128 v[188:191], v1 offset:35840
    s_waitcnt vmcnt(7) lgkmcnt(2)
    v_mfma_f32_32x32x16_bf16 v[144:159], v[176:179], v[56:59], v[144:159]
    buffer_load_dwordx4 v[88:91], v1, s[4:7], s66 offen offset:2048 sc1
    ds_read_b128 v[192:195], v1 offset:8192
    v_mfma_f32_32x32x16_bf16 v[160:175], v[180:183], v[56:59], v[160:175]
    ds_read_b128 v[196:199], v1 offset:36864
    s_waitcnt vmcnt(7) lgkmcnt(2)
    v_mfma_f32_32x32x16_bf16 v[144:159], v[184:187], v[60:63], v[144:159]
    buffer_load_dwordx4 v[92:95], v1, s[4:7], s66 offen offset:3072 sc1
    ds_read_b128 v[176:179], v1 offset:9216
    v_mfma_f32_32x32x16_bf16 v[160:175], v[188:191], v[60:63], v[160:175]
    ds_read_b128 v[180:183], v1 offset:37888
    s_waitcnt vmcnt(7) lgkmcnt(2)
    v_mfma_f32_32x32x16_bf16 v[144:159], v[192:195], v[64:67], v[144:159]
    s_add_u32 s66, s30, 16384
    buffer_load_dwordx4 v[96:99], v1, s[4:7], s66 offen offset:0 sc1
    ds_read_b128 v[184:187], v1 offset:10240
    v_mfma_f32_32x32x16_bf16 v[160:175], v[196:199], v[64:67], v[160:175]
    ds_read_b128 v[188:191], v1 offset:38912
    s_waitcnt vmcnt(7) lgkmcnt(2)
    v_mfma_f32_32x32x16_bf16 v[144:159], v[176:179], v[68:71], v[144:159]
    buffer_load_dwordx4 v[100:103], v1, s[4:7], s66 offen offset:1024 sc1
    ds_read_b128 v[192:195], v1 offset:11264
    v_mfma_f32_32x32x16_bf16 v[160:175], v[180:183], v[68:71], v[160:175]
    ds_read_b128 v[196:199], v1 offset:39936
    s_waitcnt vmcnt(7) lgkmcnt(2)
    v_mfma_f32_32x32x16_bf16 v[144:159], v[184:187], v[72:75], v[144:159]
    buffer_load_dwordx4 v[104:107], v1, s[4:7], s66 offen offset:2048 sc1
    ds_read_b128 v[176:179], v1 offset:12288
    v_lshrrev_b32 v13, 5, v0
    v_lshlrev_b32_e64 v13, 4, v13
    v_add_u32 v13, 147456, v13
    ds_read_b128 v[208:211], v13 offset:384
    v_mfma_f32_32x32x16_bf16 v[160:175], v[188:191], v[72:75], v[160:175]
    ds_read_b128 v[180:183], v1 offset:40960
    s_waitcnt vmcnt(7) lgkmcnt(3)
    v_mfma_f32_32x32x16_bf16 v[144:159], v[192:195], v[76:79], v[144:159]
    buffer_load_dwordx4 v[108:111], v1, s[4:7], s66 offen offset:3072 sc1
    ds_read_b128 v[184:187], v1 offset:13312
    ds_read_b128 v[212:215], v13 offset:416
    v_mfma_f32_32x32x16_bf16 v[160:175], v[196:199], v[76:79], v[160:175]
    ds_read_b128 v[188:191], v1 offset:41984
    s_waitcnt vmcnt(7) lgkmcnt(3)
    v_mfma_f32_32x32x16_bf16 v[144:159], v[176:179], v[80:83], v[144:159]
    s_add_u32 s66, s30, 20480
    buffer_load_dwordx4 v[112:115], v1, s[4:7], s66 offen offset:0 sc1
    ds_read_b128 v[192:195], v1 offset:14336
    ds_read_b128 v[216:219], v13 offset:448
    v_mfma_f32_32x32x16_bf16 v[160:175], v[180:183], v[80:83], v[160:175]
    ds_read_b128 v[196:199], v1 offset:43008
    s_waitcnt vmcnt(7) lgkmcnt(3)
    v_mfma_f32_32x32x16_bf16 v[144:159], v[184:187], v[84:87], v[144:159]
    buffer_load_dwordx4 v[116:119], v1, s[4:7], s66 offen offset:1024 sc1
    ds_read_b128 v[176:179], v1 offset:15360
    ds_read_b128 v[220:223], v13 offset:480
    v_mfma_f32_32x32x16_bf16 v[160:175], v[188:191], v[84:87], v[160:175]
    ds_read_b128 v[180:183], v1 offset:44032
    s_waitcnt vmcnt(7) lgkmcnt(3)
    v_mfma_f32_32x32x16_bf16 v[144:159], v[192:195], v[88:91], v[144:159]
    buffer_load_dwordx4 v[120:123], v1, s[4:7], s66 offen offset:2048 sc1
    ds_read_b128 v[184:187], v1 offset:16384
    v_lshrrev_b32 v13, 5, v0
    v_lshlrev_b32 v13, 4, v13
    v_add_u32 v13, 147456, v13
    ds_read_b128 v[224:227], v13 offset:512
    v_mfma_f32_32x32x16_bf16 v[160:175], v[196:199], v[88:91], v[160:175]
    ds_read_b128 v[188:191], v1 offset:45056
    s_waitcnt vmcnt(7) lgkmcnt(3)
    v_mfma_f32_32x32x16_bf16 v[144:159], v[176:179], v[92:95], v[144:159]
    buffer_load_dwordx4 v[124:127], v1, s[4:7], s66 offen offset:3072 sc1
    ds_read_b128 v[192:195], v1 offset:17408
    ds_read_b128 v[228:231], v13 offset:544
    v_mfma_f32_32x32x16_bf16 v[160:175], v[180:183], v[92:95], v[160:175]
    ds_read_b128 v[196:199], v1 offset:46080
    s_waitcnt vmcnt(7) lgkmcnt(3)
    v_mfma_f32_32x32x16_bf16 v[144:159], v[184:187], v[96:99], v[144:159]
    s_add_u32 s66, s30, 24576
    buffer_load_dwordx4 v[128:131], v1, s[4:7], s66 offen offset:0 sc1
    ds_read_b128 v[176:179], v1 offset:18432
    ds_read_b128 v[232:235], v13 offset:576
    v_mfma_f32_32x32x16_bf16 v[160:175], v[188:191], v[96:99], v[160:175]
    ds_read_b128 v[180:183], v1 offset:47104
    s_waitcnt vmcnt(7) lgkmcnt(3)
    v_mfma_f32_32x32x16_bf16 v[144:159], v[192:195], v[100:103], v[144:159]
    buffer_load_dwordx4 v[132:135], v1, s[4:7], s66 offen offset:1024 sc1
    ds_read_b128 v[184:187], v1 offset:19456
    ds_read_b128 v[236:239], v13 offset:608
    v_mfma_f32_32x32x16_bf16 v[160:175], v[196:199], v[100:103], v[160:175]
    ds_read_b128 v[188:191], v1 offset:48128
    s_waitcnt vmcnt(7) lgkmcnt(3)
    v_mfma_f32_32x32x16_bf16 v[144:159], v[176:179], v[104:107], v[144:159]
    buffer_load_dwordx4 v[136:139], v1, s[4:7], s66 offen offset:2048 sc1
    ds_read_b128 v[192:195], v1 offset:20480
    v_mfma_f32_32x32x16_bf16 v[160:175], v[180:183], v[104:107], v[160:175]
    ds_read_b128 v[196:199], v1 offset:49152
    s_waitcnt vmcnt(7) lgkmcnt(2)
    v_mfma_f32_32x32x16_bf16 v[144:159], v[184:187], v[108:111], v[144:159]
    buffer_load_dwordx4 v[140:143], v1, s[4:7], s66 offen offset:3072 sc1
    ds_read_b128 v[176:179], v1 offset:21504
    v_mfma_f32_32x32x16_bf16 v[160:175], v[188:191], v[108:111], v[160:175]
    ds_read_b128 v[180:183], v1 offset:50176
    s_waitcnt vmcnt(7) lgkmcnt(2)
    v_mfma_f32_32x32x16_bf16 v[144:159], v[192:195], v[112:115], v[144:159]
    buffer_load_dwordx4 v[200:203], v14, s[4:7], s59 offen offset:0 sc1
    ds_read_b128 v[184:187], v1 offset:22528
    v_mfma_f32_32x32x16_bf16 v[160:175], v[196:199], v[112:115], v[160:175]
    ds_read_b128 v[188:191], v1 offset:51200
    buffer_load_dwordx4 v[240:243], v14, s[4:7], s59 offen offset:512 sc1
    s_waitcnt vmcnt(8) lgkmcnt(2)
    v_mfma_f32_32x32x16_bf16 v[144:159], v[176:179], v[116:119], v[144:159]
    buffer_load_dwordx4 v[244:247], v14, s[4:7], s59 offen offset:1024 sc1
    ds_read_b128 v[192:195], v1 offset:23552
    v_mfma_f32_32x32x16_bf16 v[160:175], v[180:183], v[116:119], v[160:175]
    ds_read_b128 v[196:199], v1 offset:52224
    buffer_load_dwordx2 v[204:205], v4, s[4:7], s59 offen offset:3072 sc1
    s_waitcnt vmcnt(9) lgkmcnt(2)
    v_mfma_f32_32x32x16_bf16 v[144:159], v[184:187], v[120:123], v[144:159]
    ds_read_b128 v[176:179], v1 offset:24576
    v_mfma_f32_32x32x16_bf16 v[160:175], v[188:191], v[120:123], v[160:175]
    ds_read_b128 v[180:183], v1 offset:53248
    s_waitcnt vmcnt(8) lgkmcnt(2)
    v_mfma_f32_32x32x16_bf16 v[144:159], v[192:195], v[124:127], v[144:159]
    ds_read_b128 v[184:187], v1 offset:25600
    v_mfma_f32_32x32x16_bf16 v[160:175], v[196:199], v[124:127], v[160:175]
    ds_read_b128 v[188:191], v1 offset:54272
    s_waitcnt vmcnt(7) lgkmcnt(2)
    v_mfma_f32_32x32x16_bf16 v[144:159], v[176:179], v[128:131], v[144:159]
    ds_read_b128 v[192:195], v1 offset:26624
    v_mfma_f32_32x32x16_bf16 v[160:175], v[180:183], v[128:131], v[160:175]
    ds_read_b128 v[196:199], v1 offset:55296
    s_waitcnt vmcnt(6) lgkmcnt(2)
    v_mfma_f32_32x32x16_bf16 v[144:159], v[184:187], v[132:135], v[144:159]
    ds_read_b128 v[176:179], v1 offset:27648
    v_mfma_f32_32x32x16_bf16 v[160:175], v[188:191], v[132:135], v[160:175]
    ds_read_b128 v[180:183], v1 offset:56320
    s_waitcnt vmcnt(5) lgkmcnt(2)
    v_mfma_f32_32x32x16_bf16 v[144:159], v[192:195], v[136:139], v[144:159]
    v_mfma_f32_32x32x16_bf16 v[160:175], v[196:199], v[136:139], v[160:175]
    s_waitcnt vmcnt(4) lgkmcnt(0)
    v_mfma_f32_32x32x16_bf16 v[144:159], v[176:179], v[140:143], v[144:159]
    v_mfma_f32_32x32x16_bf16 v[160:175], v[180:183], v[140:143], v[160:175]
    s_waitcnt vmcnt(0)
    v_pk_add_f32 v[200:201], v[200:201], v[240:241]
    v_pk_add_f32 v[202:203], v[202:203], v[242:243]
    v_pk_add_f32 v[244:245], v[244:245], v[204:205]
    v_pk_add_f32 v[200:201], v[200:201], v[246:247]
    v_pk_add_f32 v[244:245], v[244:245], v[202:203]
    v_pk_add_f32 v[200:201], v[200:201], v[244:245]
    v_mov_b32 v206, v200
    v_mov_b32_e64 v207, v201
    s_nop 0
    v_permlane32_swap_b32 v200, v206
    v_permlane32_swap_b32 v201, v207
    v_pk_add_f32 v[206:207], v[206:207], v[200:201]
    v_mul_f32 v5, 991054117, v206
    v_mul_f32 v2, 991054117, v207
    v_fma_f32 v2, -v5, v5, v2
    v_max_f32_e64 v2, 0, v2
    v_add_f32 v2, 925353388, v2
    v_rsq_f32 v8, v2
    s_nop 0
    v_mul_f32_e64 v206, v206, v8
    v_pk_mul_f32 v[224:225], v[224:225], v[206:207] op_sel_hi:[1,0]
    v_pk_mul_f32 v[226:227], v[226:227], v[206:207] op_sel_hi:[1,0]
    v_pk_mul_f32 v[228:229], v[228:229], v[206:207] op_sel_hi:[1,0]
    v_pk_mul_f32 v[230:231], v[230:231], v[206:207] op_sel_hi:[1,0]
    v_pk_mul_f32 v[232:233], v[232:233], v[206:207] op_sel_hi:[1,0]
    v_pk_mul_f32 v[234:235], v[234:235], v[206:207] op_sel_hi:[1,0]
    v_pk_mul_f32 v[236:237], v[236:237], v[206:207] op_sel_hi:[1,0]
    v_pk_mul_f32 v[238:239], v[238:239], v[206:207] op_sel_hi:[1,0]
    v_pk_mul_f32 v[208:209], v[208:209], v[206:207] op_sel_hi:[1,0]
    v_pk_mul_f32 v[210:211], v[210:211], v[206:207] op_sel_hi:[1,0]
    v_pk_mul_f32 v[212:213], v[212:213], v[206:207] op_sel_hi:[1,0]
    v_pk_mul_f32 v[214:215], v[214:215], v[206:207] op_sel_hi:[1,0]
    v_pk_mul_f32 v[216:217], v[216:217], v[206:207] op_sel_hi:[1,0]
    v_pk_mul_f32 v[218:219], v[218:219], v[206:207] op_sel_hi:[1,0]
    v_pk_mul_f32 v[220:221], v[220:221], v[206:207] op_sel_hi:[1,0]
    v_pk_mul_f32 v[222:223], v[222:223], v[206:207] op_sel_hi:[1,0]
    v_pk_fma_f32 v[160:161], v[160:161], v[8:9], v[224:225] op_sel_hi:[1,0,1]
    v_pk_fma_f32 v[162:163], v[162:163], v[8:9], v[226:227] op_sel_hi:[1,0,1]
    v_pk_fma_f32 v[164:165], v[164:165], v[8:9], v[228:229] op_sel_hi:[1,0,1]
    v_pk_fma_f32 v[166:167], v[166:167], v[8:9], v[230:231] op_sel_hi:[1,0,1]
    v_pk_fma_f32 v[168:169], v[168:169], v[8:9], v[232:233] op_sel_hi:[1,0,1]
    v_pk_fma_f32 v[170:171], v[170:171], v[8:9], v[234:235] op_sel_hi:[1,0,1]
    v_pk_fma_f32 v[172:173], v[172:173], v[8:9], v[236:237] op_sel_hi:[1,0,1]
    v_pk_fma_f32 v[174:175], v[174:175], v[8:9], v[238:239] op_sel_hi:[1,0,1]
    s_mov_b64 exec, s[54:55]
    v_mov_b32_e64 v172, 1.0
    s_mov_b64 exec, -1
    v_cvt_pk_bf16_f32 v176, v160, v161
    v_cvt_pk_bf16_f32 v177, v162, v163
    v_cvt_pk_bf16_f32 v178, v164, v165
    v_cvt_pk_bf16_f32 v179, v166, v167
    v_cvt_pk_bf16_f32 v180, v168, v169
    v_cvt_pk_bf16_f32 v181, v170, v171
    v_cvt_pk_bf16_f32 v182, v172, v173
    v_cvt_pk_bf16_f32 v183, v174, v175
    ds_write_b64 v248, v[176:177]
    v_xor_b32_e64 v12, 16, v248
    ds_write_b64 v12, v[178:179]
    v_xor_b32_e64 v12, 32, v248
    ds_write_b64 v12, v[180:181]
    v_xor_b32_e64 v12, 48, v248
    ds_write_b64 v12, v[182:183]
    v_pk_fma_f32 v[144:145], v[144:145], v[8:9], v[208:209] op_sel_hi:[1,0,1]
    v_pk_fma_f32 v[146:147], v[146:147], v[8:9], v[210:211] op_sel_hi:[1,0,1]
    v_pk_fma_f32 v[148:149], v[148:149], v[8:9], v[212:213] op_sel_hi:[1,0,1]
    v_pk_fma_f32 v[150:151], v[150:151], v[8:9], v[214:215] op_sel_hi:[1,0,1]
    v_pk_fma_f32 v[152:153], v[152:153], v[8:9], v[216:217] op_sel_hi:[1,0,1]
    v_pk_fma_f32 v[154:155], v[154:155], v[8:9], v[218:219] op_sel_hi:[1,0,1]
    v_pk_fma_f32 v[156:157], v[156:157], v[8:9], v[220:221] op_sel_hi:[1,0,1]
    v_pk_fma_f32 v[158:159], v[158:159], v[8:9], v[222:223] op_sel_hi:[1,0,1]
    s_waitcnt lgkmcnt(0)
    ds_read_b64_tr_b16 v[232:233], v249 offset:0
    ds_read_b64_tr_b16 v[234:235], v250 offset:0
    ds_read_b64_tr_b16 v[236:237], v249 offset:1024
    ds_read_b64_tr_b16 v[238:239], v250 offset:1024
    s_mov_b64 exec, s[54:55]
    v_mov_b32 v156, 1.0
    v_mov_b32 v157, 1.0
    v_mov_b32 v158, 1.0
    s_mov_b64 exec, -1
    v_cvt_pk_bf16_f32 v224, v144, v145
    v_cvt_pk_bf16_f32 v225, v146, v147
    v_cvt_pk_bf16_f32 v226, v148, v149
    v_cvt_pk_bf16_f32 v227, v150, v151
    v_cvt_pk_bf16_f32 v228, v152, v153
    v_cvt_pk_bf16_f32 v229, v154, v155
    v_cvt_pk_bf16_f32 v230, v156, v157
    v_cvt_pk_bf16_f32 v231, v158, v159
    s_add_u32 s39, s39, 0x400000
    s_add_u32 s42, s42, 0x20000
    s_add_u32 s43, s43, 0x20000
    s_waitcnt lgkmcnt(0)
    v_add_u32 v12, 32768, v1
    ds_read_b128 v[176:179], v12 offset:24576
    ds_read_b128 v[180:183], v12 offset:25600
    ds_read_b128 v[184:187], v12 offset:26624
    buffer_store_dwordx4 v[232:235], v1, s[4:7], s39 offen offset:2048 sc1
    buffer_store_dwordx4 v[236:239], v1, s[4:7], s39 offen offset:3072 sc1
    buffer_store_dwordx4 v[224:227], v1, s[4:7], s39 offen offset:0 sc1
    buffer_store_dwordx4 v[228:231], v1, s[4:7], s39 offen offset:1024 sc1
    v_mov_b32_e64 v9, s56
    s_waitcnt lgkmcnt(2)
    v_mfma_f32_32x32x16_bf16 v[144:159], v[176:179], v[32:35], 0
    ds_read_b128 v[188:191], v12 offset:27648
    s_add_u32 s17, s14, 1
    s_and_b32 s17, s17, 3
    s_lshl_b32 s18, s17, 11
    s_add_u32 s18, s18, 155648
    v_add_u32 v242, s18, v1
    s_mul_i32 s17, s17, 12288
    s_add_u32 s17, s17, 86016
    v_add_u32 v251, s17, v1
    s_waitcnt lgkmcnt(2)
    v_mfma_f32_32x32x16_bf16 v[144:159], v[180:183], v[36:39], v[144:159]
    ds_read_b128 v[176:179], v12 offset:28672
    s_add_u32 s17, s14, 2
    s_and_b32 s17, s17, 3
    s_lshl_b32 s18, s17, 11
    s_add_u32 s18, s18, 155648
    v_add_u32 v243, s18, v1
    s_mul_i32 s17, s17, 12288
    s_add_u32 s17, s17, 90112
    v_add_u32 v252, s17, v1
    s_waitcnt lgkmcnt(2)
    v_mfma_f32_32x32x16_bf16 v[144:159], v[184:187], v[40:43], v[144:159]
    ds_read_b128 v[180:183], v12 offset:29696
    s_add_u32 s17, s14, 3
    s_and_b32 s17, s17, 3
    s_lshl_b32 s18, s17, 11
    s_add_u32 s18, s18, 155648
    v_add_u32 v244, s18, v1
    s_mul_i32 s17, s17, 12288
    s_add_u32 s17, s17, 94208
    v_add_u32 v253, s17, v1
    s_waitcnt lgkmcnt(2)
    v_mfma_f32_32x32x16_bf16 v[144:159], v[188:191], v[44:47], v[144:159]
    ds_read_b128 v[184:187], v12 offset:30720
    s_lshl_b32 s17, s14, 11
    s_add_u32 s17, s17, 155648
    v_add_u32 v245, s17, v1
    s_mul_i32 s17, s14, 12288
    s_add_u32 s17, s17, 86016
    v_add_u32 v254, s17, v1
    s_waitcnt lgkmcnt(2)
    v_mfma_f32_32x32x16_bf16 v[144:159], v[176:179], v[48:51], v[144:159]
    ds_read_b128 v[188:191], v12 offset:31744
    s_andn2_b32 s64, s39, 0x4000
    s_and_b32 s17, s12, 14
    s_and_b32 s18, s12, 1
    s_xor_b32 s18, s18, 1
    v_and_b32 v247, 15, v0
    v_med3_u32 v241, v247, 2, 4
    v_xor_b32 v241, s17, v241
    v_mov_b32 v2, s18
    v_cmp_gt_u32 vcc, 5, v247
    s_nop 1
    v_cndmask_b32 v247, v247, v2, vcc
    v_xor_b32_e64 v247, s17, v247
    s_waitcnt lgkmcnt(2)
    v_mfma_f32_32x32x16_bf16 v[144:159], v[180:183], v[52:55], v[144:159]
    ds_read_b128 v[176:179], v12 offset:32768
    v_lshlrev_b32 v241, 7, v241
    v_lshlrev_b32 v247, 7, v247
    v_mov_b32 v246, 0xdddddddd
    v_lshrrev_b32 v13, 5, v0
    v_lshlrev_b32 v13, 4, v13
    v_add_u32 v13, 147456, v13
    ds_read_b128 v[208:211], v13 offset:640
    s_waitcnt lgkmcnt(3)
    v_mfma_f32_32x32x16_bf16 v[144:159], v[184:187], v[56:59], v[144:159]
    ds_read_b128 v[180:183], v12 offset:33792
    ds_read_b128 v[212:215], v13 offset:672
    s_waitcnt lgkmcnt(4)
    v_mfma_f32_32x32x16_bf16 v[144:159], v[188:191], v[60:63], v[144:159]
    ds_read_b128 v[184:187], v12 offset:34816
    ds_read_b128 v[216:219], v13 offset:704
    s_waitcnt lgkmcnt(5)
    v_mfma_f32_32x32x16_bf16 v[144:159], v[176:179], v[64:67], v[144:159]
    ds_read_b128 v[188:191], v12 offset:35840
    ds_read_b128 v[220:223], v13 offset:736
    s_waitcnt lgkmcnt(5)
    v_mfma_f32_32x32x16_bf16 v[144:159], v[180:183], v[68:71], v[144:159]
    ds_read_b128 v[176:179], v12 offset:36864
    v_mov_b32 v64, 0
    v_mov_b32 v65, 0
    v_mov_b32 v66, 0
    v_mov_b32_e64 v67, 0
    s_waitcnt lgkmcnt(4)
    v_mfma_f32_32x32x16_bf16 v[144:159], v[184:187], v[72:75], v[144:159]
    ds_read_b128 v[180:183], v12 offset:37888
    v_mov_b32 v68, 0
    v_mov_b32 v69, 0
    v_mov_b32 v70, 0
    v_mov_b32_e64 v71, 0
    s_waitcnt lgkmcnt(3)
    v_mfma_f32_32x32x16_bf16 v[144:159], v[188:191], v[76:79], v[144:159]
    ds_read_b128 v[184:187], v12 offset:38912
    v_mov_b32 v72, 0
    v_mov_b32 v73, 0
    v_mov_b32 v74, 0
    v_mov_b32 v75, 0
    s_waitcnt lgkmcnt(3)
    v_mul_f32_e64 v208, v208, v206
    s_waitcnt lgkmcnt(2)
    v_mfma_f32_32x32x16_bf16 v[144:159], v[176:179], v[80:83], v[144:159]
    ds_read_b128 v[188:191], v12 offset:39936
    v_mov_b32 v76, 0
    v_mov_b32 v77, 0
    v_mov_b32 v78, 0
    v_mov_b32 v79, 0
    v_mul_f32 v209, v209, v206
    s_waitcnt lgkmcnt(2)
    v_mfma_f32_32x32x16_bf16 v[144:159], v[180:183], v[84:87], v[144:159]
    ds_read_b128 v[176:179], v12 offset:40960
    v_mov_b32 v80, 0
    v_mov_b32 v81, 0
    v_mov_b32 v82, 0
    v_mov_b32 v83, 0
    v_mul_f32 v210, v210, v206
    s_waitcnt lgkmcnt(2)
    v_mfma_f32_32x32x16_bf16 v[144:159], v[184:187], v[88:91], v[144:159]
    ds_read_b128 v[180:183], v12 offset:41984
    v_mov_b32 v84, 0
    v_mov_b32 v85, 0
    v_mov_b32 v86, 0
    v_mov_b32 v87, 0
    v_mul_f32 v211, v211, v206
    s_waitcnt lgkmcnt(2)
    v_mfma_f32_32x32x16_bf16 v[144:159], v[188:191], v[92:95], v[144:159]
    ds_read_b128 v[184:187], v12 offset:43008
    v_mov_b32 v88, 0
    v_mov_b32 v89, 0
    v_mov_b32 v90, 0
    v_mov_b32 v91, 0
    v_mul_f32 v212, v212, v206
    s_waitcnt lgkmcnt(2)
    v_mfma_f32_32x32x16_bf16 v[144:159], v[176:179], v[96:99], v[144:159]
    ds_read_b128 v[188:191], v12 offset:44032
    v_mov_b32 v92, 0
    v_mov_b32 v93, 0
    v_mov_b32 v94, 0
    v_mov_b32 v95, 0
    v_mul_f32 v213, v213, v206
    s_waitcnt lgkmcnt(2)
    v_mfma_f32_32x32x16_bf16 v[144:159], v[180:183], v[100:103], v[144:159]
    ds_read_b128 v[176:179], v12 offset:45056
    v_mov_b32 v96, 0
    v_mov_b32 v97, 0
    v_mov_b32 v98, 0
    v_mov_b32 v99, 0
    v_mul_f32 v214, v214, v206
    s_waitcnt lgkmcnt(2)
    v_mfma_f32_32x32x16_bf16 v[144:159], v[184:187], v[104:107], v[144:159]
    ds_read_b128 v[180:183], v12 offset:46080
    v_mov_b32 v100, 0
    v_mov_b32 v101, 0
    v_mov_b32 v102, 0
    v_mov_b32 v103, 0
    v_mul_f32 v215, v215, v206
    s_waitcnt lgkmcnt(2)
    v_mfma_f32_32x32x16_bf16 v[144:159], v[188:191], v[108:111], v[144:159]
    ds_read_b128 v[184:187], v12 offset:47104
    v_mov_b32 v104, 0
    v_mov_b32 v105, 0
    v_mov_b32 v106, 0
    v_mov_b32 v107, 0
    v_mul_f32 v216, v216, v206
    s_waitcnt lgkmcnt(2)
    v_mfma_f32_32x32x16_bf16 v[144:159], v[176:179], v[112:115], v[144:159]
    ds_read_b128 v[188:191], v12 offset:48128
    v_mov_b32 v108, 0
    v_mov_b32 v109, 0
    v_mov_b32 v110, 0
    v_mov_b32 v111, 0
    v_mul_f32 v217, v217, v206
    s_waitcnt lgkmcnt(2)
    v_mfma_f32_32x32x16_bf16 v[144:159], v[180:183], v[116:119], v[144:159]
    ds_read_b128 v[176:179], v12 offset:49152
    v_mov_b32 v112, 0
    v_mov_b32 v113, 0
    v_mov_b32 v114, 0
    v_mov_b32 v115, 0
    v_mul_f32 v218, v218, v206
    s_waitcnt lgkmcnt(2)
    v_mfma_f32_32x32x16_bf16 v[144:159], v[184:187], v[120:123], v[144:159]
    ds_read_b128 v[180:183], v12 offset:50176
    v_mov_b32 v116, 0
    v_mov_b32 v117, 0
    v_mov_b32 v118, 0
    v_mov_b32 v119, 0
    v_mul_f32_e64 v219, v219, v206
    s_waitcnt vmcnt(0)
    s_mov_b64 exec, 1
    buffer_store_dword v9, off, s[4:7], s42 sc1
    s_mov_b64 exec, -1
    s_waitcnt lgkmcnt(2)
    v_mfma_f32_32x32x16_bf16 v[144:159], v[188:191], v[124:127], v[144:159]
    ds_read_b128 v[184:187], v12 offset:51200
    v_mov_b32 v120, 0
    v_mov_b32 v121, 0
    v_mov_b32 v122, 0
    v_mov_b32 v123, 0
    v_mul_f32 v220, v220, v206
    s_waitcnt lgkmcnt(2)
    v_mfma_f32_32x32x16_bf16 v[144:159], v[176:179], v[128:131], v[144:159]
    ds_read_b128 v[188:191], v12 offset:52224
    v_mov_b32 v124, 0
    v_mov_b32 v125, 0
    v_mov_b32 v126, 0
    v_mov_b32 v127, 0
    v_mul_f32 v221, v221, v206
    s_waitcnt lgkmcnt(2)
    v_mfma_f32_32x32x16_bf16 v[144:159], v[180:183], v[132:135], v[144:159]
    v_mul_f32 v222, v222, v206
    s_waitcnt lgkmcnt(1)
    v_mfma_f32_32x32x16_bf16 v[144:159], v[184:187], v[136:139], v[144:159]
    v_mul_f32 v223, v223, v206
    s_waitcnt lgkmcnt(0)
    v_mfma_f32_32x32x16_bf16 v[144:159], v[188:191], v[140:143], v[144:159]
    s_nop 11
    v_pk_fma_f32 v[144:145], v[144:145], v[8:9], v[208:209] op_sel_hi:[1,0,1]
    v_pk_fma_f32 v[146:147], v[146:147], v[8:9], v[210:211] op_sel_hi:[1,0,1]
    v_pk_fma_f32 v[148:149], v[148:149], v[8:9], v[212:213] op_sel_hi:[1,0,1]
    v_pk_fma_f32 v[150:151], v[150:151], v[8:9], v[214:215] op_sel_hi:[1,0,1]
    v_pk_fma_f32 v[152:153], v[152:153], v[8:9], v[216:217] op_sel_hi:[1,0,1]
    v_pk_fma_f32 v[154:155], v[154:155], v[8:9], v[218:219] op_sel_hi:[1,0,1]
    v_pk_fma_f32 v[156:157], v[156:157], v[8:9], v[220:221] op_sel_hi:[1,0,1]
    v_pk_fma_f32 v[158:159], v[158:159], v[8:9], v[222:223] op_sel_hi:[1,0,1]
    v_cvt_pk_bf16_f32 v56, v144, v145
    v_cvt_pk_bf16_f32 v57, v146, v147
    v_cvt_pk_bf16_f32 v58, v148, v149
    v_cvt_pk_bf16_f32 v59, v150, v151
    v_cvt_pk_bf16_f32 v60, v152, v153
    v_cvt_pk_bf16_f32 v61, v154, v155
    v_cvt_pk_bf16_f32 v62, v156, v157
    v_cvt_pk_bf16_f32 v63, v158, v159
    s_mov_b32 s70, 0
    v_mfma_f32_32x32x16_bf16 v[160:175], v[224:227], v[56:59], 0
    v_mfma_f32_32x32x16_bf16 v[160:175], v[228:231], v[60:63], v[160:175]
    s_nop 11
    v_max3_f32 v240, v160, v161, v162
    v_max3_f32 v240, v240, v163, v164
    v_max3_f32 v240, v240, v165, v166
    v_max3_f32 v240, v240, v167, v168
    v_max3_f32 v240, v240, v169, v170
    v_max3_f32 v240, v240, v171, v172
    v_max3_f32 v240, v240, v173, v174
    v_max3_f32 v240, v240, v175, v175
    v_mov_b32 v4, v240
    s_nop 1
    v_permlane32_swap_b32 v240, v4
    v_max_f32_e64 v240, v240, v4
L_attn_68:
    v_xor_b32 v2, 0x80000000, v240
    v_and_b32 v3, 0xffff0000, v2
    v_sub_f32_e64 v2, v2, v3
    v_and_b32 v4, 0xffff0000, v2
    v_sub_f32 v2, v2, v4
    v_lshrrev_b32 v3, 16, v3
    s_mov_b64 exec, s[54:55]
    v_or_b32 v62, v3, v4
    v_lshrrev_b32 v63, 16, v2
    s_mov_b64 exec, -1
    ds_write_b128 v245, v[56:59]
    ds_write_b128 v245, v[60:63] offset:1024
    s_waitcnt lgkmcnt(0)
    s_barrier
    ds_read_b128 v[32:35], v242
    ds_read_b128 v[36:39], v242 offset:1024
    ds_read_b128 v[40:43], v243
    ds_read_b128 v[44:47], v243 offset:1024
    ds_read_b128 v[48:51], v244
    ds_read_b128 v[52:55], v244 offset:1024
    buffer_load_dword v9, v241, s[4:7], s43 offen sc1
    s_waitcnt lgkmcnt(4)
    v_mfma_f32_32x32x16_bf16 v[128:143], v[224:227], v[32:35], 0
    v_mfma_f32_32x32x16_bf16 v[128:143], v[228:231], v[36:39], v[128:143]
    s_waitcnt lgkmcnt(2)
    v_mfma_f32_32x32x16_bf16 v[144:159], v[224:227], v[40:43], 0
    v_mfma_f32_32x32x16_bf16 v[144:159], v[228:231], v[44:47], v[144:159]
    s_nop 8
    v_exp_f32 v128, v128
    v_exp_f32 v129, v129
    v_exp_f32 v130, v130
    v_exp_f32 v131, v131
    v_exp_f32 v132, v132
    v_exp_f32 v133, v133
    v_exp_f32 v134, v134
    v_exp_f32 v135, v135
    s_waitcnt lgkmcnt(0)
    v_mfma_f32_32x32x16_bf16 v[160:175], v[224:227], v[48:51], 0
    v_exp_f32 v136, v136
    v_exp_f32 v137, v137
    v_exp_f32 v138, v138
    v_exp_f32 v139, v139
    v_smfmac_f32_32x32x32_bf16 v[64:79], v[232:235], v[128:135], v246
    v_exp_f32 v140, v140
    v_exp_f32 v141, v141
    v_exp_f32 v142, v142
    v_exp_f32 v143, v143
    v_mfma_f32_32x32x16_bf16 v[160:175], v[228:231], v[52:55], v[160:175]
    s_waitcnt vmcnt(0)
    v_cmp_ne_u32 vcc, s56, v9
    s_cbranch_vccnz L_kvwait_70
L_kvok_69:
    s_xor_b32 s69, s64, 32768
    buffer_load_dwordx4 v[176:179], v1, s[4:7], s69 offen offset:0 sc1
    v_exp_f32 v144, v144
    v_exp_f32 v145, v145
    v_exp_f32 v146, v146
    v_exp_f32_e64 v147, v147
    v_smfmac_f32_32x32x32_bf16 v[64:79], v[236:239], v[136:143], v246
    buffer_load_dwordx4 v[180:183], v1, s[4:7], s69 offen offset:1024 sc1
    v_exp_f32 v148, v148
    v_exp_f32 v149, v149
    v_exp_f32 v150, v150
    v_exp_f32 v151, v151
    v_mfma_f32_32x32x16_bf16 v[128:143], v[224:227], v[56:59], 0
    buffer_load_dwordx4 v[184:187], v1, s[4:7], s69 offen offset:2048 sc1
    v_exp_f32 v152, v152
    v_exp_f32 v153, v153
    v_exp_f32 v154, v154
    v_exp_f32 v155, v155
    v_smfmac_f32_32x32x32_bf16 v[80:95], v[232:235], v[144:151], v246
    buffer_load_dwordx4 v[188:191], v1, s[4:7], s69 offen offset:3072 sc1
    v_exp_f32 v156, v156
    v_exp_f32 v157, v157
    v_exp_f32 v158, v158
    v_exp_f32 v159, v159
    v_mfma_f32_32x32x16_bf16 v[128:143], v[228:231], v[60:63], v[128:143]
    s_xor_b32 s69, s64, 49152
    buffer_load_dwordx4 v[192:195], v1, s[4:7], s69 offen offset:0 sc1
    v_exp_f32 v160, v160
    v_exp_f32 v161, v161
    v_exp_f32 v162, v162
    v_exp_f32 v163, v163
    v_smfmac_f32_32x32x32_bf16 v[80:95], v[236:239], v[152:159], v246
    buffer_load_dwordx4 v[196:199], v1, s[4:7], s69 offen offset:1024 sc1
    v_exp_f32 v164, v164
    v_exp_f32 v165, v165
    v_exp_f32 v166, v166
    v_exp_f32 v167, v167
    v_exp_f32 v168, v168
    v_exp_f32 v169, v169
    v_exp_f32 v170, v170
    v_exp_f32 v171, v171
    v_smfmac_f32_32x32x32_bf16 v[96:111], v[232:235], v[160:167], v246
    v_exp_f32 v172, v172
    v_exp_f32 v173, v173
    v_exp_f32 v174, v174
    v_exp_f32 v175, v175
    buffer_load_dwordx4 v[200:203], v1, s[4:7], s69 offen offset:2048 sc1
    v_exp_f32 v128, v128
    v_exp_f32 v129, v129
    v_exp_f32 v130, v130
    v_exp_f32 v131, v131
    v_smfmac_f32_32x32x32_bf16 v[96:111], v[236:239], v[168:175], v246
    buffer_load_dwordx4 v[204:207], v1, s[4:7], s69 offen offset:3072 sc1
    v_exp_f32 v132, v132
    v_exp_f32 v133, v133
    v_exp_f32 v134, v134
    v_exp_f32 v135, v135
    v_exp_f32 v136, v136
    v_exp_f32 v137, v137
    v_exp_f32 v138, v138
    v_exp_f32 v139, v139
    v_smfmac_f32_32x32x32_bf16 v[112:127], v[232:235], v[128:135], v246
    v_exp_f32 v140, v140
    v_exp_f32 v141, v141
    v_exp_f32 v142, v142
    v_exp_f32 v143, v143
    s_xor_b32 s69, s64, 65536
    buffer_load_dwordx4 v[208:211], v1, s[4:7], s69 offen offset:0 sc1
    s_waitcnt vmcnt(7)
    v_mfma_f32_32x32x16_bf16 v[144:159], v[176:179], v[32:35], 0
    v_mfma_f32_32x32x16_bf16 v[144:159], v[180:183], v[36:39], v[144:159]
    v_mfma_f32_32x32x16_bf16 v[160:175], v[176:179], v[40:43], 0
    v_mfma_f32_32x32x16_bf16 v[160:175], v[180:183], v[44:47], v[160:175]
    s_nop 9
    v_exp_f32 v144, v144
    v_exp_f32 v145, v145
    v_exp_f32 v146, v146
    v_exp_f32 v147, v147
    v_smfmac_f32_32x32x32_bf16 v[112:127], v[236:239], v[136:143], v246
    v_exp_f32 v148, v148
    v_exp_f32 v149, v149
    v_exp_f32 v150, v150
    v_exp_f32 v151, v151
    v_mfma_f32_32x32x16_bf16 v[128:143], v[176:179], v[48:51], 0
    v_exp_f32 v152, v152
    v_exp_f32 v153, v153
    v_exp_f32 v154, v154
    v_exp_f32_e64 v155, v155
    s_waitcnt vmcnt(5)
    v_smfmac_f32_32x32x32_bf16 v[64:79], v[184:187], v[144:151], v246
    v_exp_f32 v156, v156
    v_exp_f32 v157, v157
    v_exp_f32 v158, v158
    v_exp_f32 v159, v159
    v_mfma_f32_32x32x16_bf16 v[128:143], v[180:183], v[52:55], v[128:143]
    buffer_load_dword v9, v247, s[4:7], s43 offen sc1
    buffer_load_dwordx4 v[212:215], v1, s[4:7], s69 offen offset:1024 sc1
    v_exp_f32 v160, v160
    v_exp_f32 v161, v161
    v_exp_f32 v162, v162
    v_exp_f32 v163, v163
    v_smfmac_f32_32x32x32_bf16 v[64:79], v[188:191], v[152:159], v246
    v_exp_f32 v164, v164
    v_exp_f32 v165, v165
    v_exp_f32 v166, v166
    v_exp_f32 v167, v167
    v_mfma_f32_32x32x16_bf16 v[144:159], v[176:179], v[56:59], 0
    v_exp_f32 v168, v168
    v_exp_f32 v169, v169
    v_exp_f32 v170, v170
    v_exp_f32 v171, v171
    v_smfmac_f32_32x32x32_bf16 v[80:95], v[184:187], v[160:167], v246
    v_exp_f32 v172, v172
    v_exp_f32 v173, v173
    v_exp_f32 v174, v174
    v_exp_f32 v175, v175
    v_mfma_f32_32x32x16_bf16 v[144:159], v[180:183], v[60:63], v[144:159]
    buffer_load_dwordx4 v[216:219], v1, s[4:7], s69 offen offset:2048 sc1
    v_exp_f32 v128, v128
    v_exp_f32 v129, v129
    v_exp_f32 v130, v130
    v_exp_f32 v131, v131
    v_smfmac_f32_32x32x32_bf16 v[80:95], v[188:191], v[168:175], v246
    v_exp_f32 v132, v132
    v_exp_f32 v133, v133
    v_exp_f32 v134, v134
    v_exp_f32_e64 v135, v135
    s_waitcnt vmcnt(6)
    v_mfma_f32_32x32x16_bf16 v[160:175], v[192:195], v[32:35], 0
    v_exp_f32 v136, v136
    v_exp_f32 v137, v137
    v_exp_f32 v138, v138
    v_exp_f32 v139, v139
    v_smfmac_f32_32x32x32_bf16 v[96:111], v[184:187], v[128:135], v246
    v_exp_f32 v140, v140
    v_exp_f32 v141, v141
    v_exp_f32 v142, v142
    v_exp_f32 v143, v143
    v_mfma_f32_32x32x16_bf16 v[160:175], v[196:199], v[36:39], v[160:175]
    buffer_load_dwordx4 v[220:223], v1, s[4:7], s69 offen offset:3072 sc1
    v_exp_f32 v144, v144
    v_exp_f32 v145, v145
    v_exp_f32 v146, v146
    v_exp_f32 v147, v147
    v_smfmac_f32_32x32x32_bf16 v[96:111], v[188:191], v[136:143], v246
    v_exp_f32 v148, v148
    v_exp_f32 v149, v149
    v_exp_f32 v150, v150
    v_exp_f32 v151, v151
    v_mfma_f32_32x32x16_bf16 v[128:143], v[192:195], v[40:43], 0
    v_exp_f32 v152, v152
    v_exp_f32 v153, v153
    v_exp_f32 v154, v154
    v_exp_f32 v155, v155
    v_smfmac_f32_32x32x32_bf16 v[112:127], v[184:187], v[144:151], v246
    v_exp_f32 v156, v156
    v_exp_f32 v157, v157
    v_exp_f32 v158, v158
    v_exp_f32 v159, v159
    v_mfma_f32_32x32x16_bf16 v[128:143], v[196:199], v[44:47], v[128:143]
    s_waitcnt vmcnt(3)
    v_cmp_ne_u32 vcc, s56, v9
    s_cbranch_vccnz L_kvwait_72
L_kvok_71:
    s_xor_b32 s69, s64, 81920
    buffer_load_dwordx4 v[224:227], v1, s[4:7], s69 offen offset:0 sc1
    v_exp_f32 v160, v160
    v_exp_f32 v161, v161
    v_exp_f32 v162, v162
    v_exp_f32_e64 v163, v163
    v_smfmac_f32_32x32x32_bf16 v[112:127], v[188:191], v[152:159], v246
    buffer_load_dwordx4 v[228:231], v1, s[4:7], s69 offen offset:1024 sc1
    v_exp_f32 v164, v164
    v_exp_f32 v165, v165
    v_exp_f32 v166, v166
    v_exp_f32 v167, v167
    v_mfma_f32_32x32x16_bf16 v[144:159], v[192:195], v[48:51], 0
    v_exp_f32 v168, v168
    v_exp_f32 v169, v169
    v_exp_f32 v170, v170
    v_exp_f32 v171, v171
    v_smfmac_f32_32x32x32_bf16 v[64:79], v[200:203], v[160:167], v246
    v_exp_f32 v172, v172
    v_exp_f32 v173, v173
    v_exp_f32 v174, v174
    v_exp_f32 v175, v175
    v_mfma_f32_32x32x16_bf16 v[144:159], v[196:199], v[52:55], v[144:159]
    buffer_load_dwordx4 v[232:235], v1, s[4:7], s69 offen offset:2048 sc1
    v_exp_f32 v128, v128
    v_exp_f32 v129, v129
    v_exp_f32 v130, v130
    v_exp_f32 v131, v131
    v_smfmac_f32_32x32x32_bf16 v[64:79], v[204:207], v[168:175], v246
    buffer_load_dwordx4 v[236:239], v1, s[4:7], s69 offen offset:3072 sc1
    v_exp_f32 v132, v132
    v_exp_f32 v133, v133
    v_exp_f32 v134, v134
    v_exp_f32 v135, v135
    v_mfma_f32_32x32x16_bf16 v[160:175], v[192:195], v[56:59], 0
    v_exp_f32 v136, v136
    v_exp_f32 v137, v137
    v_exp_f32 v138, v138
    v_exp_f32 v139, v139
    v_smfmac_f32_32x32x32_bf16 v[80:95], v[200:203], v[128:135], v246
    v_exp_f32 v140, v140
    v_exp_f32 v141, v141
    v_exp_f32 v142, v142
    v_exp_f32 v143, v143
    v_mfma_f32_32x32x16_bf16 v[160:175], v[196:199], v[60:63], v[160:175]
    s_xor_b32 s69, s64, 98304
    buffer_load_dwordx4 v[176:179], v1, s[4:7], s69 offen offset:0 sc1
    v_exp_f32 v144, v144
    v_exp_f32 v145, v145
    v_exp_f32 v146, v146
    v_exp_f32 v147, v147
    v_smfmac_f32_32x32x32_bf16 v[80:95], v[204:207], v[136:143], v246
    buffer_load_dwordx4 v[180:183], v1, s[4:7], s69 offen offset:1024 sc1
    v_exp_f32 v148, v148
    v_exp_f32 v149, v149
    v_exp_f32 v150, v150
    v_exp_f32_e64 v151, v151
    s_waitcnt vmcnt(8)
    v_mfma_f32_32x32x16_bf16 v[128:143], v[208:211], v[32:35], 0
    v_exp_f32 v152, v152
    v_exp_f32 v153, v153
    v_exp_f32 v154, v154
    v_exp_f32 v155, v155
    v_smfmac_f32_32x32x32_bf16 v[96:111], v[200:203], v[144:151], v246
    v_exp_f32 v156, v156
    v_exp_f32 v157, v157
    v_exp_f32 v158, v158
    v_exp_f32 v159, v159
    v_mfma_f32_32x32x16_bf16 v[128:143], v[212:215], v[36:39], v[128:143]
    buffer_load_dwordx4 v[184:187], v1, s[4:7], s69 offen offset:2048 sc1
    v_exp_f32 v160, v160
    v_exp_f32 v161, v161
    v_exp_f32 v162, v162
    v_exp_f32 v163, v163
    v_smfmac_f32_32x32x32_bf16 v[96:111], v[204:207], v[152:159], v246
    buffer_load_dwordx4 v[188:191], v1, s[4:7], s69 offen offset:3072 sc1
    v_exp_f32 v164, v164
    v_exp_f32 v165, v165
    v_exp_f32 v166, v166
    v_exp_f32 v167, v167
    v_mfma_f32_32x32x16_bf16 v[144:159], v[208:211], v[40:43], 0
    v_exp_f32 v168, v168
    v_exp_f32 v169, v169
    v_exp_f32 v170, v170
    v_exp_f32 v171, v171
    v_smfmac_f32_32x32x32_bf16 v[112:127], v[200:203], v[160:167], v246
    v_exp_f32 v172, v172
    v_exp_f32 v173, v173
    v_exp_f32 v174, v174
    v_exp_f32 v175, v175
    v_mfma_f32_32x32x16_bf16 v[144:159], v[212:215], v[44:47], v[144:159]
    v_exp_f32 v128, v128
    v_exp_f32 v129, v129
    v_exp_f32 v130, v130
    v_exp_f32 v131, v131
    v_smfmac_f32_32x32x32_bf16 v[112:127], v[204:207], v[168:175], v246
    s_xor_b32 s69, s64, 114688
    buffer_load_dwordx4 v[192:195], v1, s[4:7], s69 offen offset:0 sc1
    v_exp_f32 v132, v132
    v_exp_f32 v133, v133
    v_exp_f32 v134, v134
    v_exp_f32 v135, v135
    v_mfma_f32_32x32x16_bf16 v[160:175], v[208:211], v[48:51], 0
    v_exp_f32 v136, v136
    v_exp_f32 v137, v137
    v_exp_f32 v138, v138
    v_exp_f32_e64 v139, v139
    s_waitcnt vmcnt(9)
    v_smfmac_f32_32x32x32_bf16 v[64:79], v[216:219], v[128:135], v246
    v_exp_f32 v140, v140
    v_exp_f32 v141, v141
    v_exp_f32 v142, v142
    v_exp_f32 v143, v143
    v_mfma_f32_32x32x16_bf16 v[160:175], v[212:215], v[52:55], v[160:175]
    buffer_load_dwordx4 v[196:199], v1, s[4:7], s69 offen offset:1024 sc1
    v_exp_f32 v144, v144
    v_exp_f32 v145, v145
    v_exp_f32 v146, v146
    v_exp_f32 v147, v147
    v_smfmac_f32_32x32x32_bf16 v[64:79], v[220:223], v[136:143], v246
    v_exp_f32 v148, v148
    v_exp_f32 v149, v149
    v_exp_f32 v150, v150
    v_exp_f32 v151, v151
    v_mfma_f32_32x32x16_bf16 v[128:143], v[208:211], v[56:59], 0
    v_exp_f32 v152, v152
    v_exp_f32 v153, v153
    v_exp_f32 v154, v154
    v_exp_f32 v155, v155
    v_smfmac_f32_32x32x32_bf16 v[80:95], v[216:219], v[144:151], v246
    v_exp_f32 v156, v156
    v_exp_f32 v157, v157
    v_exp_f32 v158, v158
    v_exp_f32 v159, v159
    v_mfma_f32_32x32x16_bf16 v[128:143], v[212:215], v[60:63], v[128:143]
    buffer_load_dwordx4 v[200:203], v1, s[4:7], s69 offen offset:2048 sc1
    v_exp_f32 v160, v160
    v_exp_f32 v161, v161
    v_exp_f32 v162, v162
    v_exp_f32 v163, v163
    v_smfmac_f32_32x32x32_bf16 v[80:95], v[220:223], v[152:159], v246
    v_exp_f32 v164, v164
    v_exp_f32 v165, v165
    v_exp_f32 v166, v166
    v_exp_f32_e64 v167, v167
    s_waitcnt vmcnt(9)
    v_mfma_f32_32x32x16_bf16 v[144:159], v[224:227], v[32:35], 0
    v_exp_f32 v168, v168
    v_exp_f32 v169, v169
    v_exp_f32 v170, v170
    v_exp_f32 v171, v171
    v_smfmac_f32_32x32x32_bf16 v[96:111], v[216:219], v[160:167], v246
    v_exp_f32 v172, v172
    v_exp_f32 v173, v173
    v_exp_f32 v174, v174
    v_exp_f32 v175, v175
    v_mfma_f32_32x32x16_bf16 v[144:159], v[228:231], v[36:39], v[144:159]
    buffer_load_dwordx4 v[204:207], v1, s[4:7], s69 offen offset:3072 sc1
    v_exp_f32 v128, v128
    v_exp_f32 v129, v129
    v_exp_f32 v130, v130
    v_exp_f32 v131, v131
    v_smfmac_f32_32x32x32_bf16 v[96:111], v[220:223], v[168:175], v246
    v_exp_f32 v132, v132
    v_exp_f32 v133, v133
    v_exp_f32 v134, v134
    v_exp_f32 v135, v135
    v_mfma_f32_32x32x16_bf16 v[160:175], v[224:227], v[40:43], 0
    v_exp_f32 v136, v136
    v_exp_f32 v137, v137
    v_exp_f32 v138, v138
    v_exp_f32 v139, v139
    v_smfmac_f32_32x32x32_bf16 v[112:127], v[216:219], v[128:135], v246
    v_exp_f32 v140, v140
    v_exp_f32 v141, v141
    v_exp_f32 v142, v142
    v_exp_f32 v143, v143
    v_mfma_f32_32x32x16_bf16 v[160:175], v[228:231], v[44:47], v[160:175]
    v_exp_f32 v144, v144
    v_exp_f32 v145, v145
    v_exp_f32 v146, v146
    v_exp_f32 v147, v147
    v_smfmac_f32_32x32x32_bf16 v[112:127], v[220:223], v[136:143], v246
    s_xor_b32 s69, s64, 131072
    buffer_load_dwordx4 v[208:211], v1, s[4:7], s69 offen offset:0 sc1
    v_exp_f32 v148, v148
    v_exp_f32 v149, v149
    v_exp_f32 v150, v150
    v_exp_f32 v151, v151
    v_mfma_f32_32x32x16_bf16 v[128:143], v[224:227], v[48:51], 0
    v_exp_f32 v152, v152
    v_exp_f32 v153, v153
    v_exp_f32 v154, v154
    v_exp_f32_e64 v155, v155
    s_waitcnt vmcnt(9)
    v_smfmac_f32_32x32x32_bf16 v[64:79], v[232:235], v[144:151], v246
    v_exp_f32 v156, v156
    v_exp_f32 v157, v157
    v_exp_f32 v158, v158
    v_exp_f32 v159, v159
    v_mfma_f32_32x32x16_bf16 v[128:143], v[228:231], v[52:55], v[128:143]
    buffer_load_dwordx4 v[212:215], v1, s[4:7], s69 offen offset:1024 sc1
    v_exp_f32 v160, v160
    v_exp_f32 v161, v161
    v_exp_f32 v162, v162
    v_exp_f32 v163, v163
    v_smfmac_f32_32x32x32_bf16 v[64:79], v[236:239], v[152:159], v246
    v_exp_f32 v164, v164
    v_exp_f32 v165, v165
    v_exp_f32 v166, v166
    v_exp_f32 v167, v167
    v_mfma_f32_32x32x16_bf16 v[144:159], v[224:227], v[56:59], 0
    v_exp_f32 v168, v168
    v_exp_f32 v169, v169
    v_exp_f32 v170, v170
    v_exp_f32 v171, v171
    v_smfmac_f32_32x32x32_bf16 v[80:95], v[232:235], v[160:167], v246
    v_exp_f32 v172, v172
    v_exp_f32 v173, v173
    v_exp_f32 v174, v174
    v_exp_f32 v175, v175
    v_mfma_f32_32x32x16_bf16 v[144:159], v[228:231], v[60:63], v[144:159]
    buffer_load_dwordx4 v[216:219], v1, s[4:7], s69 offen offset:2048 sc1
    v_exp_f32 v128, v128
    v_exp_f32 v129, v129
    v_exp_f32 v130, v130
    v_exp_f32 v131, v131
    v_smfmac_f32_32x32x32_bf16 v[80:95], v[236:239], v[168:175], v246
    v_exp_f32 v132, v132
    v_exp_f32 v133, v133
    v_exp_f32 v134, v134
    v_exp_f32_e64 v135, v135
    s_waitcnt vmcnt(9)
    v_mfma_f32_32x32x16_bf16 v[160:175], v[176:179], v[32:35], 0
    v_exp_f32 v136, v136
    v_exp_f32 v137, v137
    v_exp_f32 v138, v138
    v_exp_f32 v139, v139
    v_smfmac_f32_32x32x32_bf16 v[96:111], v[232:235], v[128:135], v246
    v_exp_f32 v140, v140
    v_exp_f32 v141, v141
    v_exp_f32 v142, v142
    v_exp_f32 v143, v143
    v_mfma_f32_32x32x16_bf16 v[160:175], v[180:183], v[36:39], v[160:175]
    buffer_load_dwordx4 v[220:223], v1, s[4:7], s69 offen offset:3072 sc1
    v_exp_f32 v144, v144
    v_exp_f32 v145, v145
    v_exp_f32 v146, v146
    v_exp_f32 v147, v147
    v_smfmac_f32_32x32x32_bf16 v[96:111], v[236:239], v[136:143], v246
    v_exp_f32 v148, v148
    v_exp_f32 v149, v149
    v_exp_f32 v150, v150
    v_exp_f32 v151, v151
    v_mfma_f32_32x32x16_bf16 v[128:143], v[176:179], v[40:43], 0
    v_exp_f32 v152, v152
    v_exp_f32 v153, v153
    v_exp_f32 v154, v154
    v_exp_f32 v155, v155
    v_smfmac_f32_32x32x32_bf16 v[112:127], v[232:235], v[144:151], v246
    v_exp_f32 v156, v156
    v_exp_f32 v157, v157
    v_exp_f32 v158, v158
    v_exp_f32 v159, v159
    v_mfma_f32_32x32x16_bf16 v[128:143], v[180:183], v[44:47], v[128:143]
    v_exp_f32 v160, v160
    v_exp_f32 v161, v161
    v_exp_f32 v162, v162
    v_exp_f32 v163, v163
    v_smfmac_f32_32x32x32_bf16 v[112:127], v[236:239], v[152:159], v246
    s_xor_b32 s69, s64, 147456
    buffer_load_dwordx4 v[224:227], v1, s[4:7], s69 offen offset:0 sc1
    v_exp_f32 v164, v164
    v_exp_f32 v165, v165
    v_exp_f32 v166, v166
    v_exp_f32 v167, v167
    v_mfma_f32_32x32x16_bf16 v[144:159], v[176:179], v[48:51], 0
    v_exp_f32 v168, v168
    v_exp_f32 v169, v169
    v_exp_f32 v170, v170
    v_exp_f32_e64 v171, v171
    s_waitcnt vmcnt(9)
    v_smfmac_f32_32x32x32_bf16 v[64:79], v[184:187], v[160:167], v246
    v_exp_f32 v172, v172
    v_exp_f32 v173, v173
    v_exp_f32 v174, v174
    v_exp_f32 v175, v175
    v_mfma_f32_32x32x16_bf16 v[144:159], v[180:183], v[52:55], v[144:159]
    buffer_load_dwordx4 v[228:231], v1, s[4:7], s69 offen offset:1024 sc1
    v_exp_f32 v128, v128
    v_exp_f32 v129, v129
    v_exp_f32 v130, v130
    v_exp_f32 v131, v131
    v_smfmac_f32_32x32x32_bf16 v[64:79], v[188:191], v[168:175], v246
    v_exp_f32 v132, v132
    v_exp_f32 v133, v133
    v_exp_f32 v134, v134
    v_exp_f32 v135, v135
    v_mfma_f32_32x32x16_bf16 v[160:175], v[176:179], v[56:59], 0
    v_exp_f32 v136, v136
    v_exp_f32 v137, v137
    v_exp_f32 v138, v138
    v_exp_f32 v139, v139
    v_smfmac_f32_32x32x32_bf16 v[80:95], v[184:187], v[128:135], v246
    v_exp_f32 v140, v140
    v_exp_f32 v141, v141
    v_exp_f32 v142, v142
    v_exp_f32 v143, v143
    v_mfma_f32_32x32x16_bf16 v[160:175], v[180:183], v[60:63], v[160:175]
    buffer_load_dwordx4 v[232:235], v1, s[4:7], s69 offen offset:2048 sc1
    v_exp_f32 v144, v144
    v_exp_f32 v145, v145
    v_exp_f32 v146, v146
    v_exp_f32 v147, v147
    v_smfmac_f32_32x32x32_bf16 v[80:95], v[188:191], v[136:143], v246
    v_exp_f32 v148, v148
    v_exp_f32 v149, v149
    v_exp_f32 v150, v150
    v_exp_f32_e64 v151, v151
    s_waitcnt vmcnt(9)
    v_mfma_f32_32x32x16_bf16 v[128:143], v[192:195], v[32:35], 0
    v_exp_f32 v152, v152
    v_exp_f32 v153, v153
    v_exp_f32 v154, v154
    v_exp_f32 v155, v155
    v_smfmac_f32_32x32x32_bf16 v[96:111], v[184:187], v[144:151], v246
    v_exp_f32 v156, v156
    v_exp_f32 v157, v157
    v_exp_f32 v158, v158
    v_exp_f32 v159, v159
    v_mfma_f32_32x32x16_bf16 v[128:143], v[196:199], v[36:39], v[128:143]
    buffer_load_dwordx4 v[236:239], v1, s[4:7], s69 offen offset:3072 sc1
    v_exp_f32 v160, v160
    v_exp_f32 v161, v161
    v_exp_f32 v162, v162
    v_exp_f32 v163, v163
    v_smfmac_f32_32x32x32_bf16 v[96:111], v[188:191], v[152:159], v246
    v_exp_f32 v164, v164
    v_exp_f32 v165, v165
    v_exp_f32 v166, v166
    v_exp_f32 v167, v167
    v_mfma_f32_32x32x16_bf16 v[144:159], v[192:195], v[40:43], 0
    v_exp_f32 v168, v168
    v_exp_f32 v169, v169
    v_exp_f32 v170, v170
    v_exp_f32 v171, v171
    v_smfmac_f32_32x32x32_bf16 v[112:127], v[184:187], v[160:167], v246
    v_exp_f32 v172, v172
    v_exp_f32 v173, v173
    v_exp_f32 v174, v174
    v_exp_f32 v175, v175
    v_mfma_f32_32x32x16_bf16 v[144:159], v[196:199], v[44:47], v[144:159]
    v_exp_f32 v128, v128
    v_exp_f32 v129, v129
    v_exp_f32 v130, v130
    v_exp_f32 v131, v131
    v_smfmac_f32_32x32x32_bf16 v[112:127], v[188:191], v[168:175], v246
    s_xor_b32 s69, s64, 163840
    buffer_load_dwordx4 v[176:179], v1, s[4:7], s69 offen offset:0 sc1
    v_exp_f32 v132, v132
    v_exp_f32 v133, v133
    v_exp_f32 v134, v134
    v_exp_f32 v135, v135
    v_mfma_f32_32x32x16_bf16 v[160:175], v[192:195], v[48:51], 0
    v_exp_f32 v136, v136
    v_exp_f32 v137, v137
    v_exp_f32 v138, v138
    v_exp_f32_e64 v139, v139
    s_waitcnt vmcnt(9)
    v_smfmac_f32_32x32x32_bf16 v[64:79], v[200:203], v[128:135], v246
    v_exp_f32 v140, v140
    v_exp_f32 v141, v141
    v_exp_f32 v142, v142
    v_exp_f32 v143, v143
    v_mfma_f32_32x32x16_bf16 v[160:175], v[196:199], v[52:55], v[160:175]
    buffer_load_dwordx4 v[180:183], v1, s[4:7], s69 offen offset:1024 sc1
    v_exp_f32 v144, v144
    v_exp_f32 v145, v145
    v_exp_f32 v146, v146
    v_exp_f32 v147, v147
    v_smfmac_f32_32x32x32_bf16 v[64:79], v[204:207], v[136:143], v246
    v_exp_f32 v148, v148
    v_exp_f32 v149, v149
    v_exp_f32 v150, v150
    v_exp_f32 v151, v151
    v_mfma_f32_32x32x16_bf16 v[128:143], v[192:195], v[56:59], 0
    v_exp_f32 v152, v152
    v_exp_f32 v153, v153
    v_exp_f32 v154, v154
    v_exp_f32 v155, v155
    v_smfmac_f32_32x32x32_bf16 v[80:95], v[200:203], v[144:151], v246
    v_exp_f32 v156, v156
    v_exp_f32 v157, v157
    v_exp_f32 v158, v158
    v_exp_f32 v159, v159
    v_mfma_f32_32x32x16_bf16 v[128:143], v[196:199], v[60:63], v[128:143]
    buffer_load_dwordx4 v[184:187], v1, s[4:7], s69 offen offset:2048 sc1
    v_exp_f32 v160, v160
    v_exp_f32 v161, v161
    v_exp_f32 v162, v162
    v_exp_f32 v163, v163
    v_smfmac_f32_32x32x32_bf16 v[80:95], v[204:207], v[152:159], v246
    v_exp_f32 v164, v164
    v_exp_f32 v165, v165
    v_exp_f32 v166, v166
    v_exp_f32_e64 v167, v167
    s_waitcnt vmcnt(9)
    v_mfma_f32_32x32x16_bf16 v[144:159], v[208:211], v[32:35], 0
    v_exp_f32 v168, v168
    v_exp_f32 v169, v169
    v_exp_f32 v170, v170
    v_exp_f32 v171, v171
    v_smfmac_f32_32x32x32_bf16 v[96:111], v[200:203], v[160:167], v246
    v_exp_f32 v172, v172
    v_exp_f32 v173, v173
    v_exp_f32 v174, v174
    v_exp_f32 v175, v175
    v_mfma_f32_32x32x16_bf16 v[144:159], v[212:215], v[36:39], v[144:159]
    buffer_load_dwordx4 v[188:191], v1, s[4:7], s69 offen offset:3072 sc1
    v_exp_f32 v128, v128
    v_exp_f32 v129, v129
    v_exp_f32 v130, v130
    v_exp_f32 v131, v131
    v_smfmac_f32_32x32x32_bf16 v[96:111], v[204:207], v[168:175], v246
    v_exp_f32 v132, v132
    v_exp_f32 v133, v133
    v_exp_f32 v134, v134
    v_exp_f32 v135, v135
    v_mfma_f32_32x32x16_bf16 v[160:175], v[208:211], v[40:43], 0
    v_exp_f32 v136, v136
    v_exp_f32 v137, v137
    v_exp_f32 v138, v138
    v_exp_f32 v139, v139
    v_smfmac_f32_32x32x32_bf16 v[112:127], v[200:203], v[128:135], v246
    v_exp_f32 v140, v140
    v_exp_f32 v141, v141
    v_exp_f32 v142, v142
    v_exp_f32 v143, v143
    v_mfma_f32_32x32x16_bf16 v[160:175], v[212:215], v[44:47], v[160:175]
    v_exp_f32 v144, v144
    v_exp_f32 v145, v145
    v_exp_f32 v146, v146
    v_exp_f32 v147, v147
    v_smfmac_f32_32x32x32_bf16 v[112:127], v[204:207], v[136:143], v246
    s_xor_b32 s69, s64, 180224
    buffer_load_dwordx4 v[192:195], v1, s[4:7], s69 offen offset:0 sc1
    v_exp_f32 v148, v148
    v_exp_f32 v149, v149
    v_exp_f32 v150, v150
    v_exp_f32 v151, v151
    v_mfma_f32_32x32x16_bf16 v[128:143], v[208:211], v[48:51], 0
    v_exp_f32 v152, v152
    v_exp_f32 v153, v153
    v_exp_f32 v154, v154
    v_exp_f32_e64 v155, v155
    s_waitcnt vmcnt(9)
    v_smfmac_f32_32x32x32_bf16 v[64:79], v[216:219], v[144:151], v246
    v_exp_f32 v156, v156
    v_exp_f32 v157, v157
    v_exp_f32 v158, v158
    v_exp_f32 v159, v159
    v_mfma_f32_32x32x16_bf16 v[128:143], v[212:215], v[52:55], v[128:143]
    buffer_load_dwordx4 v[196:199], v1, s[4:7], s69 offen offset:1024 sc1
    v_exp_f32 v160, v160
    v_exp_f32 v161, v161
    v_exp_f32 v162, v162
    v_exp_f32 v163, v163
    v_smfmac_f32_32x32x32_bf16 v[64:79], v[220:223], v[152:159], v246
    v_exp_f32 v164, v164
    v_exp_f32 v165, v165
    v_exp_f32 v166, v166
    v_exp_f32 v167, v167
    v_mfma_f32_32x32x16_bf16 v[144:159], v[208:211], v[56:59], 0
    v_exp_f32 v168, v168
    v_exp_f32 v169, v169
    v_exp_f32 v170, v170
    v_exp_f32 v171, v171
    v_smfmac_f32_32x32x32_bf16 v[80:95], v[216:219], v[160:167], v246
    v_exp_f32 v172, v172
    v_exp_f32 v173, v173
    v_exp_f32 v174, v174
    v_exp_f32 v175, v175
    v_mfma_f32_32x32x16_bf16 v[144:159], v[212:215], v[60:63], v[144:159]
    buffer_load_dwordx4 v[200:203], v1, s[4:7], s69 offen offset:2048 sc1
    v_exp_f32 v128, v128
    v_exp_f32 v129, v129
    v_exp_f32 v130, v130
    v_exp_f32 v131, v131
    v_smfmac_f32_32x32x32_bf16 v[80:95], v[220:223], v[168:175], v246
    v_exp_f32 v132, v132
    v_exp_f32 v133, v133
    v_exp_f32 v134, v134
    v_exp_f32_e64 v135, v135
    s_waitcnt vmcnt(9)
    v_mfma_f32_32x32x16_bf16 v[160:175], v[224:227], v[32:35], 0
    v_exp_f32 v136, v136
    v_exp_f32 v137, v137
    v_exp_f32 v138, v138
    v_exp_f32 v139, v139
    v_smfmac_f32_32x32x32_bf16 v[96:111], v[216:219], v[128:135], v246
    v_exp_f32 v140, v140
    v_exp_f32 v141, v141
    v_exp_f32 v142, v142
    v_exp_f32 v143, v143
    v_mfma_f32_32x32x16_bf16 v[160:175], v[228:231], v[36:39], v[160:175]
    buffer_load_dwordx4 v[204:207], v1, s[4:7], s69 offen offset:3072 sc1
    v_exp_f32 v144, v144
    v_exp_f32 v145, v145
    v_exp_f32 v146, v146
    v_exp_f32 v147, v147
    v_smfmac_f32_32x32x32_bf16 v[96:111], v[220:223], v[136:143], v246
    v_exp_f32 v148, v148
    v_exp_f32 v149, v149
    v_exp_f32 v150, v150
    v_exp_f32 v151, v151
    v_mfma_f32_32x32x16_bf16 v[128:143], v[224:227], v[40:43], 0
    v_exp_f32 v152, v152
    v_exp_f32 v153, v153
    v_exp_f32 v154, v154
    v_exp_f32 v155, v155
    v_smfmac_f32_32x32x32_bf16 v[112:127], v[216:219], v[144:151], v246
    v_exp_f32 v156, v156
    v_exp_f32 v157, v157
    v_exp_f32 v158, v158
    v_exp_f32 v159, v159
    v_mfma_f32_32x32x16_bf16 v[128:143], v[228:231], v[44:47], v[128:143]
    v_exp_f32 v160, v160
    v_exp_f32 v161, v161
    v_exp_f32 v162, v162
    v_exp_f32 v163, v163
    v_smfmac_f32_32x32x32_bf16 v[112:127], v[220:223], v[152:159], v246
    s_xor_b32 s69, s64, 196608
    buffer_load_dwordx4 v[208:211], v1, s[4:7], s69 offen offset:0 sc1
    v_exp_f32 v164, v164
    v_exp_f32 v165, v165
    v_exp_f32 v166, v166
    v_exp_f32 v167, v167
    v_mfma_f32_32x32x16_bf16 v[144:159], v[224:227], v[48:51], 0
    v_exp_f32 v168, v168
    v_exp_f32 v169, v169
    v_exp_f32 v170, v170
    v_exp_f32_e64 v171, v171
    s_waitcnt vmcnt(9)
    v_smfmac_f32_32x32x32_bf16 v[64:79], v[232:235], v[160:167], v246
    v_exp_f32 v172, v172
    v_exp_f32 v173, v173
    v_exp_f32 v174, v174
    v_exp_f32 v175, v175
    v_mfma_f32_32x32x16_bf16 v[144:159], v[228:231], v[52:55], v[144:159]
    buffer_load_dwordx4 v[212:215], v1, s[4:7], s69 offen offset:1024 sc1
    v_exp_f32 v128, v128
    v_exp_f32 v129, v129
    v_exp_f32 v130, v130
    v_exp_f32 v131, v131
    v_smfmac_f32_32x32x32_bf16 v[64:79], v[236:239], v[168:175], v246
    v_exp_f32 v132, v132
    v_exp_f32 v133, v133
    v_exp_f32 v134, v134
    v_exp_f32 v135, v135
    v_mfma_f32_32x32x16_bf16 v[160:175], v[224:227], v[56:59], 0
    v_exp_f32 v136, v136
    v_exp_f32 v137, v137
    v_exp_f32 v138, v138
    v_exp_f32 v139, v139
    v_smfmac_f32_32x32x32_bf16 v[80:95], v[232:235], v[128:135], v246
    v_exp_f32 v140, v140
    v_exp_f32 v141, v141
    v_exp_f32 v142, v142
    v_exp_f32 v143, v143
    v_mfma_f32_32x32x16_bf16 v[160:175], v[228:231], v[60:63], v[160:175]
    buffer_load_dwordx4 v[216:219], v1, s[4:7], s69 offen offset:2048 sc1
    v_exp_f32 v144, v144
    v_exp_f32 v145, v145
    v_exp_f32 v146, v146
    v_exp_f32 v147, v147
    v_smfmac_f32_32x32x32_bf16 v[80:95], v[236:239], v[136:143], v246
    v_exp_f32 v148, v148
    v_exp_f32 v149, v149
    v_exp_f32 v150, v150
    v_exp_f32_e64 v151, v151
    s_waitcnt vmcnt(9)
    v_mfma_f32_32x32x16_bf16 v[128:143], v[176:179], v[32:35], 0
    v_exp_f32 v152, v152
    v_exp_f32 v153, v153
    v_exp_f32 v154, v154
    v_exp_f32 v155, v155
    v_smfmac_f32_32x32x32_bf16 v[96:111], v[232:235], v[144:151], v246
    v_exp_f32 v156, v156
    v_exp_f32 v157, v157
    v_exp_f32 v158, v158
    v_exp_f32 v159, v159
    v_mfma_f32_32x32x16_bf16 v[128:143], v[180:183], v[36:39], v[128:143]
    buffer_load_dwordx4 v[220:223], v1, s[4:7], s69 offen offset:3072 sc1
    v_exp_f32 v160, v160
    v_exp_f32 v161, v161
    v_exp_f32 v162, v162
    v_exp_f32 v163, v163
    v_smfmac_f32_32x32x32_bf16 v[96:111], v[236:239], v[152:159], v246
    v_exp_f32 v164, v164
    v_exp_f32 v165, v165
    v_exp_f32 v166, v166
    v_exp_f32 v167, v167
    v_mfma_f32_32x32x16_bf16 v[144:159], v[176:179], v[40:43], 0
    v_exp_f32 v168, v168
    v_exp_f32 v169, v169
    v_exp_f32 v170, v170
    v_exp_f32 v171, v171
    v_smfmac_f32_32x32x32_bf16 v[112:127], v[232:235], v[160:167], v246
    v_exp_f32 v172, v172
    v_exp_f32 v173, v173
    v_exp_f32 v174, v174
    v_exp_f32 v175, v175
    v_mfma_f32_32x32x16_bf16 v[144:159], v[180:183], v[44:47], v[144:159]
    v_exp_f32 v128, v128
    v_exp_f32 v129, v129
    v_exp_f32 v130, v130
    v_exp_f32 v131, v131
    v_smfmac_f32_32x32x32_bf16 v[112:127], v[236:239], v[168:175], v246
    s_xor_b32 s69, s64, 212992
    buffer_load_dwordx4 v[224:227], v1, s[4:7], s69 offen offset:0 sc1
    v_exp_f32 v132, v132
    v_exp_f32 v133, v133
    v_exp_f32 v134, v134
    v_exp_f32 v135, v135
    v_mfma_f32_32x32x16_bf16 v[160:175], v[176:179], v[48:51], 0
    v_exp_f32 v136, v136
    v_exp_f32 v137, v137
    v_exp_f32 v138, v138
    v_exp_f32_e64 v139, v139
    s_waitcnt vmcnt(9)
    v_smfmac_f32_32x32x32_bf16 v[64:79], v[184:187], v[128:135], v246
    v_exp_f32 v140, v140
    v_exp_f32 v141, v141
    v_exp_f32 v142, v142
    v_exp_f32 v143, v143
    v_mfma_f32_32x32x16_bf16 v[160:175], v[180:183], v[52:55], v[160:175]
    buffer_load_dwordx4 v[228:231], v1, s[4:7], s69 offen offset:1024 sc1
    v_exp_f32 v144, v144
    v_exp_f32 v145, v145
    v_exp_f32 v146, v146
    v_exp_f32 v147, v147
    v_smfmac_f32_32x32x32_bf16 v[64:79], v[188:191], v[136:143], v246
    v_exp_f32 v148, v148
    v_exp_f32 v149, v149
    v_exp_f32 v150, v150
    v_exp_f32 v151, v151
    v_mfma_f32_32x32x16_bf16 v[128:143], v[176:179], v[56:59], 0
    v_exp_f32 v152, v152
    v_exp_f32 v153, v153
    v_exp_f32 v154, v154
    v_exp_f32 v155, v155
    v_smfmac_f32_32x32x32_bf16 v[80:95], v[184:187], v[144:151], v246
    v_exp_f32 v156, v156
    v_exp_f32 v157, v157
    v_exp_f32 v158, v158
    v_exp_f32 v159, v159
    v_mfma_f32_32x32x16_bf16 v[128:143], v[180:183], v[60:63], v[128:143]
    buffer_load_dwordx4 v[232:235], v1, s[4:7], s69 offen offset:2048 sc1
    v_exp_f32 v160, v160
    v_exp_f32 v161, v161
    v_exp_f32 v162, v162
    v_exp_f32 v163, v163
    v_smfmac_f32_32x32x32_bf16 v[80:95], v[188:191], v[152:159], v246
    v_exp_f32 v164, v164
    v_exp_f32 v165, v165
    v_exp_f32 v166, v166
    v_exp_f32_e64 v167, v167
    s_waitcnt vmcnt(9)
    v_mfma_f32_32x32x16_bf16 v[144:159], v[192:195], v[32:35], 0
    v_exp_f32 v168, v168
    v_exp_f32 v169, v169
    v_exp_f32 v170, v170
    v_exp_f32 v171, v171
    v_smfmac_f32_32x32x32_bf16 v[96:111], v[184:187], v[160:167], v246
    v_exp_f32 v172, v172
    v_exp_f32 v173, v173
    v_exp_f32 v174, v174
    v_exp_f32 v175, v175
    v_mfma_f32_32x32x16_bf16 v[144:159], v[196:199], v[36:39], v[144:159]
    buffer_load_dwordx4 v[236:239], v1, s[4:7], s69 offen offset:3072 sc1
    v_exp_f32 v128, v128
    v_exp_f32 v129, v129
    v_exp_f32 v130, v130
    v_exp_f32 v131, v131
    v_smfmac_f32_32x32x32_bf16 v[96:111], v[188:191], v[168:175], v246
    v_exp_f32 v132, v132
    v_exp_f32 v133, v133
    v_exp_f32 v134, v134
    v_exp_f32 v135, v135
    v_mfma_f32_32x32x16_bf16 v[160:175], v[192:195], v[40:43], 0
    v_exp_f32 v136, v136
    v_exp_f32 v137, v137
    v_exp_f32 v138, v138
    v_exp_f32 v139, v139
    v_smfmac_f32_32x32x32_bf16 v[112:127], v[184:187], v[128:135], v246
    v_exp_f32 v140, v140
    v_exp_f32 v141, v141
    v_exp_f32 v142, v142
    v_exp_f32 v143, v143
    v_mfma_f32_32x32x16_bf16 v[160:175], v[196:199], v[44:47], v[160:175]
    v_exp_f32 v144, v144
    v_exp_f32 v145, v145
    v_exp_f32 v146, v146
    v_exp_f32 v147, v147
    v_smfmac_f32_32x32x32_bf16 v[112:127], v[188:191], v[136:143], v246
    s_xor_b32 s69, s64, 229376
    buffer_load_dwordx4 v[176:179], v1, s[4:7], s69 offen offset:0 sc1
    v_exp_f32 v148, v148
    v_exp_f32 v149, v149
    v_exp_f32 v150, v150
    v_exp_f32 v151, v151
    v_mfma_f32_32x32x16_bf16 v[128:143], v[192:195], v[48:51], 0
    v_exp_f32 v152, v152
    v_exp_f32 v153, v153
    v_exp_f32 v154, v154
    v_exp_f32_e64 v155, v155
    s_waitcnt vmcnt(9)
    v_smfmac_f32_32x32x32_bf16 v[64:79], v[200:203], v[144:151], v246
    v_exp_f32 v156, v156
    v_exp_f32 v157, v157
    v_exp_f32 v158, v158
    v_exp_f32 v159, v159
    v_mfma_f32_32x32x16_bf16 v[128:143], v[196:199], v[52:55], v[128:143]
    buffer_load_dwordx4 v[180:183], v1, s[4:7], s69 offen offset:1024 sc1
    v_exp_f32 v160, v160
    v_exp_f32 v161, v161
    v_exp_f32 v162, v162
    v_exp_f32 v163, v163
    v_smfmac_f32_32x32x32_bf16 v[64:79], v[204:207], v[152:159], v246
    v_exp_f32 v164, v164
    v_exp_f32 v165, v165
    v_exp_f32 v166, v166
    v_exp_f32 v167, v167
    v_mfma_f32_32x32x16_bf16 v[144:159], v[192:195], v[56:59], 0
    v_exp_f32 v168, v168
    v_exp_f32 v169, v169
    v_exp_f32 v170, v170
    v_exp_f32 v171, v171
    v_smfmac_f32_32x32x32_bf16 v[80:95], v[200:203], v[160:167], v246
    v_exp_f32 v172, v172
    v_exp_f32 v173, v173
    v_exp_f32 v174, v174
    v_exp_f32 v175, v175
    v_mfma_f32_32x32x16_bf16 v[144:159], v[196:199], v[60:63], v[144:159]
    buffer_load_dwordx4 v[184:187], v1, s[4:7], s69 offen offset:2048 sc1
    v_exp_f32 v128, v128
    v_exp_f32 v129, v129
    v_exp_f32 v130, v130
    v_exp_f32 v131, v131
    v_smfmac_f32_32x32x32_bf16 v[80:95], v[204:207], v[168:175], v246
    v_exp_f32 v132, v132
    v_exp_f32 v133, v133
    v_exp_f32 v134, v134
    v_exp_f32_e64 v135, v135
    s_waitcnt vmcnt(9)
    v_mfma_f32_32x32x16_bf16 v[160:175], v[208:211], v[32:35], 0
    v_exp_f32 v136, v136
    v_exp_f32 v137, v137
    v_exp_f32 v138, v138
    v_exp_f32 v139, v139
    v_smfmac_f32_32x32x32_bf16 v[96:111], v[200:203], v[128:135], v246
    v_exp_f32 v140, v140
    v_exp_f32 v141, v141
    v_exp_f32 v142, v142
    v_exp_f32 v143, v143
    v_mfma_f32_32x32x16_bf16 v[160:175], v[212:215], v[36:39], v[160:175]
    buffer_load_dwordx4 v[188:191], v1, s[4:7], s69 offen offset:3072 sc1
    v_exp_f32 v144, v144
    v_exp_f32 v145, v145
    v_exp_f32 v146, v146
    v_exp_f32 v147, v147
    v_smfmac_f32_32x32x32_bf16 v[96:111], v[204:207], v[136:143], v246
    v_exp_f32 v148, v148
    v_exp_f32 v149, v149
    v_exp_f32 v150, v150
    v_exp_f32 v151, v151
    v_mfma_f32_32x32x16_bf16 v[128:143], v[208:211], v[40:43], 0
    v_exp_f32 v152, v152
    v_exp_f32 v153, v153
    v_exp_f32 v154, v154
    v_exp_f32 v155, v155
    v_smfmac_f32_32x32x32_bf16 v[112:127], v[200:203], v[144:151], v246
    v_exp_f32 v156, v156
    v_exp_f32 v157, v157
    v_exp_f32 v158, v158
    v_exp_f32 v159, v159
    v_mfma_f32_32x32x16_bf16 v[128:143], v[212:215], v[44:47], v[128:143]
    v_exp_f32 v160, v160
    v_exp_f32 v161, v161
    v_exp_f32 v162, v162
    v_exp_f32 v163, v163
    v_smfmac_f32_32x32x32_bf16 v[112:127], v[204:207], v[152:159], v246
    s_xor_b32 s69, s64, 245760
    buffer_load_dwordx4 v[192:195], v1, s[4:7], s69 offen offset:0 sc1
    v_exp_f32 v164, v164
    v_exp_f32 v165, v165
    v_exp_f32 v166, v166
    v_exp_f32 v167, v167
    v_mfma_f32_32x32x16_bf16 v[144:159], v[208:211], v[48:51], 0
    v_exp_f32 v168, v168
    v_exp_f32 v169, v169
    v_exp_f32 v170, v170
    v_exp_f32_e64 v171, v171
    s_waitcnt vmcnt(9)
    v_smfmac_f32_32x32x32_bf16 v[64:79], v[216:219], v[160:167], v246
    v_exp_f32 v172, v172
    v_exp_f32 v173, v173
    v_exp_f32 v174, v174
    v_exp_f32 v175, v175
    v_mfma_f32_32x32x16_bf16 v[144:159], v[212:215], v[52:55], v[144:159]
    buffer_load_dwordx4 v[196:199], v1, s[4:7], s69 offen offset:1024 sc1
    v_exp_f32 v128, v128
    v_exp_f32 v129, v129
    v_exp_f32 v130, v130
    v_exp_f32 v131, v131
    v_smfmac_f32_32x32x32_bf16 v[64:79], v[220:223], v[168:175], v246
    v_exp_f32 v132, v132
    v_exp_f32 v133, v133
    v_exp_f32 v134, v134
    v_exp_f32 v135, v135
    v_mfma_f32_32x32x16_bf16 v[160:175], v[208:211], v[56:59], 0
    v_exp_f32 v136, v136
    v_exp_f32 v137, v137
    v_exp_f32 v138, v138
    v_exp_f32 v139, v139
    v_smfmac_f32_32x32x32_bf16 v[80:95], v[216:219], v[128:135], v246
    v_exp_f32 v140, v140
    v_exp_f32 v141, v141
    v_exp_f32 v142, v142
    v_exp_f32 v143, v143
    v_mfma_f32_32x32x16_bf16 v[160:175], v[212:215], v[60:63], v[160:175]
    buffer_load_dwordx4 v[200:203], v1, s[4:7], s69 offen offset:2048 sc1
    v_exp_f32 v144, v144
    v_exp_f32 v145, v145
    v_exp_f32 v146, v146
    v_exp_f32 v147, v147
    v_smfmac_f32_32x32x32_bf16 v[80:95], v[220:223], v[136:143], v246
    v_exp_f32 v148, v148
    v_exp_f32 v149, v149
    v_exp_f32 v150, v150
    v_exp_f32_e64 v151, v151
    s_waitcnt vmcnt(9)
    v_mfma_f32_32x32x16_bf16 v[128:143], v[224:227], v[32:35], 0
    v_exp_f32 v152, v152
    v_exp_f32 v153, v153
    v_exp_f32 v154, v154
    v_exp_f32 v155, v155
    v_smfmac_f32_32x32x32_bf16 v[96:111], v[216:219], v[144:151], v246
    v_exp_f32 v156, v156
    v_exp_f32 v157, v157
    v_exp_f32 v158, v158
    v_exp_f32 v159, v159
    v_mfma_f32_32x32x16_bf16 v[128:143], v[228:231], v[36:39], v[128:143]
    buffer_load_dwordx4 v[204:207], v1, s[4:7], s69 offen offset:3072 sc1
    v_exp_f32 v160, v160
    v_exp_f32 v161, v161
    v_exp_f32 v162, v162
    v_exp_f32 v163, v163
    v_smfmac_f32_32x32x32_bf16 v[96:111], v[220:223], v[152:159], v246
    v_exp_f32 v164, v164
    v_exp_f32 v165, v165
    v_exp_f32 v166, v166
    v_exp_f32 v167, v167
    v_mfma_f32_32x32x16_bf16 v[144:159], v[224:227], v[40:43], 0
    v_exp_f32 v168, v168
    v_exp_f32 v169, v169
    v_exp_f32 v170, v170
    v_exp_f32 v171, v171
    v_smfmac_f32_32x32x32_bf16 v[112:127], v[216:219], v[160:167], v246
    v_exp_f32 v172, v172
    v_exp_f32 v173, v173
    v_exp_f32 v174, v174
    v_exp_f32 v175, v175
    v_mfma_f32_32x32x16_bf16 v[144:159], v[228:231], v[44:47], v[144:159]
    v_exp_f32 v128, v128
    v_exp_f32 v129, v129
    v_exp_f32 v130, v130
    v_exp_f32 v131, v131
    v_smfmac_f32_32x32x32_bf16 v[112:127], v[220:223], v[168:175], v246
    s_xor_b32 s69, s39, 16384
    buffer_load_dwordx4 v[208:211], v1, s[4:7], s69 offen offset:0 sc1
    v_exp_f32 v132, v132
    v_exp_f32 v133, v133
    v_exp_f32 v134, v134
    v_exp_f32 v135, v135
    v_mfma_f32_32x32x16_bf16 v[160:175], v[224:227], v[48:51], 0
    v_exp_f32 v136, v136
    v_exp_f32 v137, v137
    v_exp_f32 v138, v138
    v_exp_f32_e64 v139, v139
    s_waitcnt vmcnt(9)
    v_smfmac_f32_32x32x32_bf16 v[64:79], v[232:235], v[128:135], v246
    v_exp_f32 v140, v140
    v_exp_f32 v141, v141
    v_exp_f32 v142, v142
    v_exp_f32 v143, v143
    v_mfma_f32_32x32x16_bf16 v[160:175], v[228:231], v[52:55], v[160:175]
    buffer_load_dwordx4 v[212:215], v1, s[4:7], s69 offen offset:1024 sc1
    v_exp_f32 v144, v144
    v_exp_f32 v145, v145
    v_exp_f32 v146, v146
    v_exp_f32 v147, v147
    v_smfmac_f32_32x32x32_bf16 v[64:79], v[236:239], v[136:143], v246
    v_exp_f32 v148, v148
    v_exp_f32 v149, v149
    v_exp_f32 v150, v150
    v_exp_f32 v151, v151
    v_mfma_f32_32x32x16_bf16 v[128:143], v[224:227], v[56:59], 0
    v_exp_f32 v152, v152
    v_exp_f32 v153, v153
    v_exp_f32 v154, v154
    v_exp_f32 v155, v155
    v_smfmac_f32_32x32x32_bf16 v[80:95], v[232:235], v[144:151], v246
    v_exp_f32 v156, v156
    v_exp_f32 v157, v157
    v_exp_f32 v158, v158
    v_exp_f32 v159, v159
    v_mfma_f32_32x32x16_bf16 v[128:143], v[228:231], v[60:63], v[128:143]
    buffer_load_dwordx4 v[216:219], v1, s[4:7], s69 offen offset:2048 sc1
    v_exp_f32 v160, v160
    v_exp_f32 v161, v161
    v_exp_f32 v162, v162
    v_exp_f32 v163, v163
    v_smfmac_f32_32x32x32_bf16 v[80:95], v[236:239], v[152:159], v246
    v_exp_f32 v164, v164
    v_exp_f32 v165, v165
    v_exp_f32 v166, v166
    v_exp_f32_e64 v167, v167
    s_waitcnt vmcnt(9)
    v_mfma_f32_32x32x16_bf16 v[144:159], v[176:179], v[32:35], 0
    v_exp_f32 v168, v168
    v_exp_f32 v169, v169
    v_exp_f32 v170, v170
    v_exp_f32 v171, v171
    v_smfmac_f32_32x32x32_bf16 v[96:111], v[232:235], v[160:167], v246
    v_exp_f32 v172, v172
    v_exp_f32 v173, v173
    v_exp_f32 v174, v174
    v_exp_f32 v175, v175
    v_mfma_f32_32x32x16_bf16 v[144:159], v[180:183], v[36:39], v[144:159]
    buffer_load_dwordx4 v[220:223], v1, s[4:7], s69 offen offset:3072 sc1
    v_exp_f32 v128, v128
    v_exp_f32 v129, v129
    v_exp_f32 v130, v130
    v_exp_f32 v131, v131
    v_smfmac_f32_32x32x32_bf16 v[96:111], v[236:239], v[168:175], v246
    v_exp_f32 v132, v132
    v_exp_f32 v133, v133
    v_exp_f32 v134, v134
    v_exp_f32 v135, v135
    v_mfma_f32_32x32x16_bf16 v[160:175], v[176:179], v[40:43], 0
    v_and_b32 v2, 15, v0
    v_lshlrev_b32 v2, 7, v2
    s_mul_i32 s67, s13, 1792
    s_add_u32 s67, s67, s33
    v_mov_b32 v3, s67
    v_mov_b32_e64 v4, s35
    v_cndmask_b32 v3, v3, v4, s[54:55]
    s_and_b32 s67, s60, 1
    s_lshl_b32 s67, s67, 8
    s_add_u32 s67, s67, s58
    v_add_u32 v2, v2, v3
    v_writelane_b32 v2, s67, 16
    s_add_u32 s67, s67, 128
    v_writelane_b32 v2, s67, 17
    buffer_load_dword v6, v2, s[4:7], 0 offen sc1
    v_exp_f32 v136, v136
    v_exp_f32 v137, v137
    v_exp_f32 v138, v138
    v_exp_f32 v139, v139
    v_smfmac_f32_32x32x32_bf16 v[112:127], v[232:235], v[128:135], v246
    v_exp_f32 v140, v140
    v_exp_f32 v141, v141
    v_exp_f32 v142, v142
    v_exp_f32 v143, v143
    v_mfma_f32_32x32x16_bf16 v[160:175], v[180:183], v[44:47], v[160:175]
    v_exp_f32 v144, v144
    v_exp_f32 v145, v145
    v_exp_f32 v146, v146
    v_exp_f32 v147, v147
    v_smfmac_f32_32x32x32_bf16 v[112:127], v[236:239], v[136:143], v246
    v_exp_f32 v148, v148
    v_exp_f32 v149, v149
    v_exp_f32 v150, v150
    v_exp_f32 v151, v151
    v_mfma_f32_32x32x16_bf16 v[128:143], v[176:179], v[48:51], 0
    s_getpc_b64 s[28:29]
L_pc_73:
    s_lshr_b32 s67, s2, 3
    s_lshl_b32 s67, s67, 2
    s_add_u32 s67, s67, s14
    s_lshl_b32 s67, s67, 7
    s_add_u32 s67, s67, 1024
    s_min_u32 s67, s67, interleave_layers__linear_kernel_hedgehog__mha_block__prompt_kernel_last-L_pc_73-4
    v_mov_b32 v2, s67
    global_load_dword v6, v2, s[28:29]
    v_exp_f32 v152, v152
    v_exp_f32 v153, v153
    v_exp_f32 v154, v154
    v_exp_f32_e64 v155, v155
    s_waitcnt vmcnt(10)
    v_smfmac_f32_32x32x32_bf16 v[64:79], v[184:187], v[144:151], v246
    v_exp_f32 v156, v156
    v_exp_f32 v157, v157
    v_exp_f32 v158, v158
    v_exp_f32 v159, v159
    v_mfma_f32_32x32x16_bf16 v[128:143], v[180:183], v[52:55], v[128:143]
    v_exp_f32 v160, v160
    v_exp_f32 v161, v161
    v_exp_f32 v162, v162
    v_exp_f32 v163, v163
    v_smfmac_f32_32x32x32_bf16 v[64:79], v[188:191], v[152:159], v246
    v_exp_f32 v164, v164
    v_exp_f32 v165, v165
    v_exp_f32 v166, v166
    v_exp_f32 v167, v167
    v_mfma_f32_32x32x16_bf16 v[144:159], v[176:179], v[56:59], 0
    v_exp_f32 v168, v168
    v_exp_f32 v169, v169
    v_exp_f32 v170, v170
    v_exp_f32 v171, v171
    v_smfmac_f32_32x32x32_bf16 v[80:95], v[184:187], v[160:167], v246
    v_exp_f32 v172, v172
    v_exp_f32 v173, v173
    v_exp_f32 v174, v174
    v_exp_f32 v175, v175
    v_mfma_f32_32x32x16_bf16 v[144:159], v[180:183], v[60:63], v[144:159]
    v_exp_f32 v128, v128
    v_exp_f32 v129, v129
    v_exp_f32 v130, v130
    v_exp_f32 v131, v131
    v_smfmac_f32_32x32x32_bf16 v[80:95], v[188:191], v[168:175], v246
    v_exp_f32 v132, v132
    v_exp_f32 v133, v133
    v_exp_f32 v134, v134
    v_exp_f32_e64 v135, v135
    s_waitcnt vmcnt(8)
    v_mfma_f32_32x32x16_bf16 v[160:175], v[192:195], v[32:35], 0
    v_exp_f32 v136, v136
    v_exp_f32 v137, v137
    v_exp_f32 v138, v138
    v_exp_f32 v139, v139
    v_smfmac_f32_32x32x32_bf16 v[96:111], v[184:187], v[128:135], v246
    v_exp_f32 v140, v140
    v_exp_f32 v141, v141
    v_exp_f32 v142, v142
    v_exp_f32 v143, v143
    v_mfma_f32_32x32x16_bf16 v[160:175], v[196:199], v[36:39], v[160:175]
    v_exp_f32 v144, v144
    v_exp_f32 v145, v145
    v_exp_f32 v146, v146
    v_exp_f32 v147, v147
    v_smfmac_f32_32x32x32_bf16 v[96:111], v[188:191], v[136:143], v246
    v_exp_f32 v148, v148
    v_exp_f32 v149, v149
    v_exp_f32 v150, v150
    v_exp_f32_e64 v151, v151
    s_waitcnt vmcnt(4)
    v_mfma_f32_32x32x16_bf16 v[128:143], v[208:211], v[32:35], 0
    v_exp_f32 v152, v152
    v_exp_f32 v153, v153
    v_exp_f32 v154, v154
    v_exp_f32 v155, v155
    v_smfmac_f32_32x32x32_bf16 v[112:127], v[184:187], v[144:151], v246
    v_exp_f32 v156, v156
    v_exp_f32 v157, v157
    v_exp_f32 v158, v158
    v_exp_f32 v159, v159
    v_mfma_f32_32x32x16_bf16 v[128:143], v[212:215], v[36:39], v[128:143]
    v_exp_f32 v160, v160
    v_exp_f32 v161, v161
    v_exp_f32 v162, v162
    v_exp_f32 v163, v163
    v_smfmac_f32_32x32x32_bf16 v[112:127], v[188:191], v[152:159], v246
    v_exp_f32 v164, v164
    v_exp_f32 v165, v165
    v_exp_f32 v166, v166
    v_exp_f32 v167, v167
    v_mfma_f32_32x32x16_bf16 v[144:159], v[192:195], v[40:43], 0
    v_exp_f32 v168, v168
    v_exp_f32 v169, v169
    v_exp_f32 v170, v170
    v_exp_f32 v171, v171
    v_smfmac_f32_32x32x32_bf16 v[64:79], v[200:203], v[160:167], v246
    v_exp_f32 v172, v172
    v_exp_f32 v173, v173
    v_exp_f32 v174, v174
    v_exp_f32 v175, v175
    v_mfma_f32_32x32x16_bf16 v[144:159], v[196:199], v[44:47], v[144:159]
    v_exp_f32 v128, v128
    v_exp_f32 v129, v129
    v_exp_f32 v130, v130
    v_exp_f32 v131, v131
    v_smfmac_f32_32x32x32_bf16 v[64:79], v[204:207], v[168:175], v246
    v_exp_f32 v132, v132
    v_exp_f32 v133, v133
    v_exp_f32 v134, v134
    v_exp_f32 v135, v135
    v_mfma_f32_32x32x16_bf16 v[160:175], v[208:211], v[40:43], 0
    v_exp_f32 v136, v136
    v_exp_f32 v137, v137
    v_exp_f32 v138, v138
    v_exp_f32_e64 v139, v139
    s_waitcnt vmcnt(2)
    v_smfmac_f32_32x32x32_bf16 v[64:79], v[216:219], v[128:135], v246
    v_exp_f32 v140, v140
    v_exp_f32 v141, v141
    v_exp_f32 v142, v142
    v_exp_f32 v143, v143
    v_mfma_f32_32x32x16_bf16 v[160:175], v[212:215], v[44:47], v[160:175]
    v_exp_f32 v144, v144
    v_exp_f32 v145, v145
    v_exp_f32 v146, v146
    v_exp_f32 v147, v147
    v_smfmac_f32_32x32x32_bf16 v[64:79], v[220:223], v[136:143], v246
    v_exp_f32 v148, v148
    v_exp_f32 v149, v149
    v_exp_f32 v150, v150
    v_exp_f32 v151, v151
    v_mfma_f32_32x32x16_bf16 v[128:143], v[192:195], v[48:51], 0
    v_exp_f32 v152, v152
    v_exp_f32 v153, v153
    v_exp_f32 v154, v154
    v_exp_f32 v155, v155
    v_smfmac_f32_32x32x32_bf16 v[80:95], v[200:203], v[144:151], v246
    v_exp_f32 v156, v156
    v_exp_f32 v157, v157
    v_exp_f32 v158, v158
    v_exp_f32 v159, v159
    v_mfma_f32_32x32x16_bf16 v[128:143], v[196:199], v[52:55], v[128:143]
    v_exp_f32 v160, v160
    v_exp_f32 v161, v161
    v_exp_f32 v162, v162
    v_exp_f32 v163, v163
    v_smfmac_f32_32x32x32_bf16 v[80:95], v[204:207], v[152:159], v246
    v_exp_f32 v164, v164
    v_exp_f32 v165, v165
    v_exp_f32 v166, v166
    v_exp_f32 v167, v167
    v_mfma_f32_32x32x16_bf16 v[144:159], v[208:211], v[48:51], 0
    ds_write_b128 v251, v[64:67] offset:0
    v_exp_f32 v168, v168
    v_exp_f32 v169, v169
    v_exp_f32 v170, v170
    v_exp_f32 v171, v171
    v_smfmac_f32_32x32x32_bf16 v[80:95], v[216:219], v[160:167], v246
    v_exp_f32 v172, v172
    v_exp_f32 v173, v173
    v_exp_f32 v174, v174
    v_exp_f32 v175, v175
    v_mfma_f32_32x32x16_bf16 v[144:159], v[212:215], v[52:55], v[144:159]
    ds_write_b128 v251, v[68:71] offset:1024
    v_exp_f32 v128, v128
    v_exp_f32 v129, v129
    v_exp_f32 v130, v130
    v_exp_f32 v131, v131
    v_smfmac_f32_32x32x32_bf16 v[80:95], v[220:223], v[168:175], v246
    v_exp_f32 v132, v132
    v_exp_f32 v133, v133
    v_exp_f32 v134, v134
    v_exp_f32 v135, v135
    v_mfma_f32_32x32x16_bf16 v[160:175], v[192:195], v[56:59], 0
    ds_write_b128 v251, v[72:75] offset:2048
    v_exp_f32 v136, v136
    v_exp_f32 v137, v137
    v_exp_f32 v138, v138
    v_exp_f32 v139, v139
    v_smfmac_f32_32x32x32_bf16 v[96:111], v[200:203], v[128:135], v246
    v_exp_f32 v140, v140
    v_exp_f32 v141, v141
    v_exp_f32 v142, v142
    v_exp_f32 v143, v143
    v_mfma_f32_32x32x16_bf16 v[160:175], v[196:199], v[60:63], v[160:175]
    ds_write_b128 v251, v[76:79] offset:3072
    v_exp_f32 v144, v144
    v_exp_f32 v145, v145
    v_exp_f32 v146, v146
    v_exp_f32 v147, v147
    v_smfmac_f32_32x32x32_bf16 v[96:111], v[204:207], v[136:143], v246
    v_exp_f32 v148, v148
    v_exp_f32 v149, v149
    v_exp_f32 v150, v150
    v_exp_f32 v151, v151
    v_mfma_f32_32x32x16_bf16 v[128:143], v[208:211], v[56:59], 0
    ds_write_b128 v252, v[80:83] offset:0
    v_exp_f32 v152, v152
    v_exp_f32 v153, v153
    v_exp_f32 v154, v154
    v_exp_f32 v155, v155
    v_smfmac_f32_32x32x32_bf16 v[96:111], v[216:219], v[144:151], v246
    v_exp_f32 v156, v156
    v_exp_f32 v157, v157
    v_exp_f32 v158, v158
    v_exp_f32 v159, v159
    v_mfma_f32_32x32x16_bf16 v[128:143], v[212:215], v[60:63], v[128:143]
    ds_write_b128 v252, v[84:87] offset:1024
    v_exp_f32 v160, v160
    v_exp_f32 v161, v161
    v_exp_f32 v162, v162
    v_exp_f32 v163, v163
    v_smfmac_f32_32x32x32_bf16 v[96:111], v[220:223], v[152:159], v246
    v_exp_f32 v164, v164
    v_exp_f32 v165, v165
    v_exp_f32 v166, v166
    v_exp_f32 v167, v167
    ds_write_b128 v252, v[88:91] offset:2048
    v_exp_f32 v168, v168
    v_exp_f32 v169, v169
    v_exp_f32 v170, v170
    v_exp_f32 v171, v171
    v_smfmac_f32_32x32x32_bf16 v[112:127], v[200:203], v[160:167], v246
    v_exp_f32 v172, v172
    v_exp_f32 v173, v173
    v_exp_f32 v174, v174
    v_exp_f32 v175, v175
    ds_write_b128 v252, v[92:95] offset:3072
    v_exp_f32 v128, v128
    v_exp_f32 v129, v129
    v_exp_f32 v130, v130
    v_exp_f32 v131, v131
    v_smfmac_f32_32x32x32_bf16 v[112:127], v[204:207], v[168:175], v246
    v_exp_f32 v132, v132
    v_exp_f32 v133, v133
    v_exp_f32 v134, v134
    v_exp_f32 v135, v135
    ds_write_b128 v253, v[96:99] offset:0
    v_exp_f32 v136, v136
    v_exp_f32 v137, v137
    v_exp_f32 v138, v138
    v_exp_f32 v139, v139
    v_smfmac_f32_32x32x32_bf16 v[112:127], v[216:219], v[128:135], v246
    v_exp_f32 v140, v140
    v_exp_f32 v141, v141
    v_exp_f32 v142, v142
    v_exp_f32 v143, v143
    ds_write_b128 v253, v[100:103] offset:1024
    s_nop 0
    v_smfmac_f32_32x32x32_bf16 v[112:127], v[220:223], v[136:143], v246
    ds_write_b128 v253, v[104:107] offset:2048
    ds_write_b128 v253, v[108:111] offset:3072
    s_lshl_b32 s18, s14, 2
    s_add_u32 s18, s18, 139264
    v_mov_b32_e64 v13, s18
    v_mov_b32 v14, 139264
    v_max3_f32 v2, v76, v92, v108
    s_nop 4
    v_max_f32 v2, v2, v124
    v_cmp_ngt_f32 vcc, 1602224128, v2
    s_nop 0
    s_and_b64 vcc, vcc, s[54:55]
    s_cselect_b32 s18, 1, 0
    v_mov_b32 v3, s18
    ds_write_b32 v13, v3
    s_waitcnt lgkmcnt(0)
    s_barrier
    ds_read_b128 v[2:5], v14
    ds_read_b128 v[64:67], v254 offset:0
    ds_read_b128 v[68:71], v254 offset:1024
    ds_read_b128 v[72:75], v254 offset:2048
    ds_read_b128 v[76:79], v254 offset:3072
    ds_read_b128 v[80:83], v254 offset:4096
    ds_read_b128 v[84:87], v254 offset:5120
    ds_read_b128 v[88:91], v254 offset:6144
    ds_read_b128 v[92:95], v254 offset:7168
    ds_read_b128 v[96:99], v254 offset:8192
    ds_read_b128 v[100:103], v254 offset:9216
    ds_read_b128 v[104:107], v254 offset:10240
    ds_read_b128 v[108:111], v254 offset:11264
    v_accvgpr_read_b32 v128, a112
    v_accvgpr_read_b32 v129, a113
    v_accvgpr_read_b32 v130, a114
    s_waitcnt lgkmcnt(12)
    v_or3_b32 v2, v2, v3, v4
    v_or_b32_e64 v2, v2, v5
    v_cmp_lt_u32 vcc, s70, v2
    s_cbranch_vccnz L_slowmax_74
    s_waitcnt lgkmcnt(8)
    v_pk_add_f32 v[112:113], v[112:113], v[64:65]
    v_pk_add_f32 v[114:115], v[114:115], v[66:67]
    v_pk_add_f32 v[116:117], v[116:117], v[68:69]
    v_pk_add_f32 v[118:119], v[118:119], v[70:71]
    v_pk_add_f32 v[120:121], v[120:121], v[72:73]
    v_pk_add_f32 v[122:123], v[122:123], v[74:75]
    v_pk_add_f32 v[124:125], v[124:125], v[76:77]
    v_pk_add_f32 v[126:127], v[126:127], v[78:79]
    s_waitcnt lgkmcnt(4)
    v_pk_add_f32 v[112:113], v[112:113], v[80:81]
    v_pk_add_f32 v[114:115], v[114:115], v[82:83]
    v_pk_add_f32 v[116:117], v[116:117], v[84:85]
    v_pk_add_f32 v[118:119], v[118:119], v[86:87]
    v_pk_add_f32 v[120:121], v[120:121], v[88:89]
    v_pk_add_f32 v[122:123], v[122:123], v[90:91]
    v_pk_add_f32 v[124:125], v[124:125], v[92:93]
    v_pk_add_f32 v[126:127], v[126:127], v[94:95]
    s_waitcnt lgkmcnt(0)
    v_pk_add_f32 v[112:113], v[112:113], v[96:97]
    v_pk_add_f32 v[114:115], v[114:115], v[98:99]
    v_pk_add_f32 v[116:117], v[116:117], v[100:101]
    v_pk_add_f32 v[118:119], v[118:119], v[102:103]
    v_pk_add_f32 v[120:121], v[120:121], v[104:105]
    v_pk_add_f32 v[122:123], v[122:123], v[106:107]
    v_pk_add_f32 v[124:125], v[124:125], v[108:109]
    v_pk_add_f32 v[126:127], v[126:127], v[110:111]
    v_mov_b32 v2, v124
    v_mov_b32 v3, v124
    s_nop 1
    v_permlane32_swap_b32 v2, v3
    v_rcp_f32 v10, v3
    s_nop 0
    v_pk_mul_f32 v[112:113], v[112:113], v[10:11] op_sel_hi:[1,0]
    v_pk_mul_f32 v[114:115], v[114:115], v[10:11] op_sel_hi:[1,0]
    v_pk_mul_f32 v[116:117], v[116:117], v[10:11] op_sel_hi:[1,0]
    v_pk_mul_f32 v[118:119], v[118:119], v[10:11] op_sel_hi:[1,0]
    v_pk_mul_f32 v[120:121], v[120:121], v[10:11] op_sel_hi:[1,0]
    v_pk_mul_f32 v[122:123], v[122:123], v[10:11] op_sel_hi:[1,0]
    v_pk_mul_f32 v[124:125], v[124:125], v[10:11] op_sel_hi:[1,0]
    v_pk_mul_f32 v[126:127], v[126:127], v[10:11] op_sel_hi:[1,0]
    v_cvt_pk_bf16_f32 v208, v112, v113
    v_cvt_pk_bf16_f32 v209, v114, v115
    v_cvt_pk_bf16_f32 v210, v116, v117
    v_cvt_pk_bf16_f32 v211, v118, v119
    v_cvt_pk_bf16_f32 v212, v120, v121
    v_cvt_pk_bf16_f32 v213, v122, v123
    v_cvt_pk_bf16_f32 v214, v124, v125
    v_cvt_pk_bf16_f32 v215, v126, v127
    s_cmp_eq_u32 s16, 0
    s_cbranch_scc0 L_slow_76
    buffer_store_dwordx2 v[208:209], v128, s[4:7], s33 offen
    buffer_store_dwordx2 v[210:211], v129, s[4:7], s33 offen
    buffer_store_dwordx2 v[212:213], v128, s[4:7], s33 offen offset:1024
    buffer_store_dwordx2 v[214:215], v130, s[4:7], s33 offen offset:1024
L_join_77:
    s_add_u32 s57, s56, 4
    v_mov_b32 v9, s57
    v_and_b32 v13, 3, v0
    v_lshlrev_b32 v13, 2, v13
    s_mul_i32 s19, s14, 7168
    s_add_u32 s19, s19, 114688
    v_add_u32 v12, 114688, v1
    s_waitcnt vmcnt(0)
    s_mov_b64 exec, 1
    s_cmp_eq_u32 s16, 0
    s_cbranch_scc0 L_slow_78
    buffer_store_dword v9, off, s[4:7], s44
L_join_79:
    s_mov_b64 exec, -1
    s_barrier
    s_add_u32 s57, s56, 4
L_poll_80:
    buffer_load_dword v5, v13, s[4:7], s45 offen sc1
    s_waitcnt vmcnt(0)
    v_cmp_ne_u32 vcc, s57, v5
    s_cbranch_vccnz L_retry_81
    s_add_u32 m0, s19, 0
    s_add_u32 s18, s34, 0
    buffer_load_dwordx4 v1, s[4:7], s18 offen offset:0 sc1 lds
    buffer_load_dwordx4 v1, s[4:7], s18 offen offset:1024 sc1 lds
    buffer_load_dwordx4 v1, s[4:7], s18 offen offset:2048 sc1 lds
    buffer_load_dwordx4 v1, s[4:7], s18 offen offset:3072 sc1 lds
    s_add_u32 m0, s19, 4096
    s_add_u32 s18, s34, 4096
    buffer_load_dwordx4 v1, s[4:7], s18 offen offset:0 sc1 lds
    buffer_load_dwordx4 v1, s[4:7], s18 offen offset:1024 sc1 lds
    buffer_load_dwordx4 v1, s[4:7], s18 offen offset:2048 sc1 lds
    s_add_u32 s17, s14, 0
    s_and_b32 s17, s17, 3
    s_add_u32 s17, s17, 0
    s_mul_i32 s17, s17, 7168
    v_add_u32_e64 v192, s17, v12
    s_add_u32 s17, s14, 1
    s_and_b32 s17, s17, 3
    s_add_u32 s17, s17, 0
    s_mul_i32 s17, s17, 7168
    v_add_u32 v193, s17, v12
    s_add_u32 s17, s14, 2
    s_and_b32 s17, s17, 3
    s_add_u32 s17, s17, 0
    s_mul_i32 s17, s17, 7168
    v_add_u32 v194, s17, v12
    s_add_u32 s17, s14, 3
    s_and_b32 s17, s17, 3
    s_add_u32 s17, s17, 0
    s_mul_i32 s17, s17, 7168
    v_add_u32 v195, s17, v12
    s_cmp_ge_u32 s36, 14
    s_cbranch_scc1 L_woskip_82
    s_waitcnt vmcnt(6)
    ds_read_b128 v[176:179], v192 offset:0
    s_waitcnt vmcnt(5)
    ds_read_b128 v[180:183], v192 offset:1024
    s_waitcnt vmcnt(4)
    ds_read_b128 v[184:187], v192 offset:2048
    s_waitcnt lgkmcnt(2)
    v_mfma_f32_32x32x16_bf16 v[16:31], a[128:131], v[176:179], v[16:31]
    s_waitcnt vmcnt(3)
    ds_read_b128 v[188:191], v192 offset:3072
    s_waitcnt lgkmcnt(2)
    v_mfma_f32_32x32x16_bf16 v[16:31], a[132:135], v[180:183], v[16:31]
    s_waitcnt vmcnt(2)
    ds_read_b128 v[176:179], v192 offset:4096
    s_waitcnt lgkmcnt(2)
    v_mfma_f32_32x32x16_bf16 v[16:31], a[136:139], v[184:187], v[16:31]
    s_waitcnt vmcnt(1)
    ds_read_b128 v[180:183], v192 offset:5120
    s_waitcnt lgkmcnt(2)
    v_mfma_f32_32x32x16_bf16 v[16:31], a[140:143], v[188:191], v[16:31]
    s_waitcnt vmcnt(0)
    ds_read_b128 v[184:187], v192 offset:6144
    s_waitcnt lgkmcnt(2)
    v_mfma_f32_32x32x16_bf16 v[16:31], a[144:147], v[176:179], v[16:31]
    s_barrier
    ds_read_b128 v[188:191], v193 offset:0
    s_waitcnt lgkmcnt(2)
    v_mfma_f32_32x32x16_bf16 v[16:31], a[148:151], v[180:183], v[16:31]
    ds_read_b128 v[176:179], v193 offset:1024
    s_waitcnt lgkmcnt(2)
    v_mfma_f32_32x32x16_bf16 v[16:31], a[152:155], v[184:187], v[16:31]
    ds_read_b128 v[180:183], v193 offset:2048
    s_waitcnt lgkmcnt(2)
    v_mfma_f32_32x32x16_bf16 v[16:31], a[156:159], v[188:191], v[16:31]
    ds_read_b128 v[184:187], v193 offset:3072
    s_waitcnt lgkmcnt(2)
    v_mfma_f32_32x32x16_bf16 v[16:31], a[160:163], v[176:179], v[16:31]
    ds_read_b128 v[188:191], v193 offset:4096
    s_waitcnt lgkmcnt(2)
    v_mfma_f32_32x32x16_bf16 v[16:31], a[164:167], v[180:183], v[16:31]
    ds_read_b128 v[176:179], v193 offset:5120
    s_waitcnt lgkmcnt(2)
    v_mfma_f32_32x32x16_bf16 v[16:31], a[168:171], v[184:187], v[16:31]
    ds_read_b128 v[180:183], v193 offset:6144
    s_waitcnt lgkmcnt(2)
    v_mfma_f32_32x32x16_bf16 v[16:31], a[172:175], v[188:191], v[16:31]
    ds_read_b128 v[184:187], v194 offset:0
    s_waitcnt lgkmcnt(2)
    v_mfma_f32_32x32x16_bf16 v[16:31], a[176:179], v[176:179], v[16:31]
    ds_read_b128 v[188:191], v194 offset:1024
    s_waitcnt lgkmcnt(2)
    v_mfma_f32_32x32x16_bf16 v[16:31], a[180:183], v[180:183], v[16:31]
    ds_read_b128 v[176:179], v194 offset:2048
    s_waitcnt lgkmcnt(2)
    v_mfma_f32_32x32x16_bf16 v[16:31], a[184:187], v[184:187], v[16:31]
    ds_read_b128 v[180:183], v194 offset:3072
    s_waitcnt lgkmcnt(2)
    v_mfma_f32_32x32x16_bf16 v[16:31], a[188:191], v[188:191], v[16:31]
    ds_read_b128 v[184:187], v194 offset:4096
    s_waitcnt lgkmcnt(2)
    v_mfma_f32_32x32x16_bf16 v[16:31], a[192:195], v[176:179], v[16:31]
    ds_read_b128 v[188:191], v194 offset:5120
    s_waitcnt lgkmcnt(2)
    v_mfma_f32_32x32x16_bf16 v[16:31], a[196:199], v[180:183], v[16:31]
    ds_read_b128 v[176:179], v194 offset:6144
    s_waitcnt lgkmcnt(2)
    v_mfma_f32_32x32x16_bf16 v[16:31], a[200:203], v[184:187], v[16:31]
    ds_read_b128 v[180:183], v195 offset:0
    s_waitcnt lgkmcnt(2)
    v_mfma_f32_32x32x16_bf16 v[16:31], a[204:207], v[188:191], v[16:31]
    ds_read_b128 v[184:187], v195 offset:1024
    s_waitcnt lgkmcnt(2)
    v_mfma_f32_32x32x16_bf16 v[16:31], a[208:211], v[176:179], v[16:31]
    ds_read_b128 v[188:191], v195 offset:2048
    s_waitcnt lgkmcnt(2)
    v_mfma_f32_32x32x16_bf16 v[16:31], a[212:215], v[180:183], v[16:31]
    ds_read_b128 v[176:179], v195 offset:3072
    s_waitcnt lgkmcnt(2)
    v_mfma_f32_32x32x16_bf16 v[16:31], a[216:219], v[184:187], v[16:31]
    ds_read_b128 v[180:183], v195 offset:4096
    s_waitcnt lgkmcnt(2)
    v_mfma_f32_32x32x16_bf16 v[16:31], a[220:223], v[188:191], v[16:31]
    ds_read_b128 v[184:187], v195 offset:5120
    s_waitcnt lgkmcnt(2)
    v_mfma_f32_32x32x16_bf16 v[16:31], a[224:227], v[176:179], v[16:31]
    ds_read_b128 v[188:191], v195 offset:6144
    s_waitcnt lgkmcnt(2)
    v_mfma_f32_32x32x16_bf16 v[16:31], a[228:231], v[180:183], v[16:31]
    s_waitcnt lgkmcnt(1)
    v_mfma_f32_32x32x16_bf16 v[16:31], a[232:235], v[184:187], v[16:31]
    s_waitcnt lgkmcnt(0)
    v_mfma_f32_32x32x16_bf16 v[16:31], a[236:239], v[188:191], v[16:31]
    s_mov_b32 s8, s84
    s_mov_b32 s9, s85
    s_mov_b32 s10, 1835008
    v_and_b32 v2, 31, v0
    v_mul_u32_u24 v2, 896, v2
    v_lshrrev_b32_e64 v3, 5, v0
    v_lshl_add_u32 v2, v3, 4, v2
    s_nop 4
    v_cvt_pk_bf16_f32 v208, v16, v17
    v_cvt_pk_bf16_f32 v209, v18, v19
    v_cvt_pk_bf16_f32 v210, v20, v21
    v_cvt_pk_bf16_f32 v211, v22, v23
    v_cvt_pk_bf16_f32 v212, v24, v25
    v_cvt_pk_bf16_f32 v213, v26, v27
    v_cvt_pk_bf16_f32 v214, v28, v29
    v_cvt_pk_bf16_f32 v215, v30, v31
    v_permlane32_swap_b32 v208, v210
    v_permlane32_swap_b32 v209, v211
    v_permlane32_swap_b32 v212, v214
    v_permlane32_swap_b32 v213, v215
    buffer_store_dwordx4 v[208:211], v2, s[8:11], s65 offen
    buffer_store_dwordx4 v[212:215], v2, s[8:11], s65 offen offset:32
L_wojoin_83:
    s_add_u32 s17, s2, s14
    s_cmp_lg_u32 s17, 0
    s_cbranch_scc1 interleave_layers__linear_kernel_hedgehog__mha_block__prompt_kernel_end
    s_mov_b64 exec, 1
    v_mov_b32 v2, s56
    s_mov_b32 s17, 61440
    buffer_store_dword v2, off, s[4:7], s17
interleave_layers__linear_kernel_hedgehog__mha_block__prompt_kernel_end:
    s_endpgm
L_slowmax_31:
    s_waitcnt vmcnt(0) lgkmcnt(0)
    s_mov_b32 s70, 1
    s_mov_b32 s19, 0
    v_mov_b32 v64, 0xff800000
    v_mov_b32 v65, 0xff800000
    v_mov_b32 v66, 0xff800000
    v_mov_b32 v67, 0xff800000
L_smx_84:
    s_xor_b32 s69, s39, s19
    buffer_load_dwordx4 v[176:179], v1, s[4:7], s69 offen sc1
    buffer_load_dwordx4 v[180:183], v1, s[4:7], s69 offen offset:1024 sc1
    s_waitcnt vmcnt(0)
    v_mfma_f32_32x32x16_bf16 v[128:143], v[176:179], v[32:35], 0
    v_mfma_f32_32x32x16_bf16 v[128:143], v[180:183], v[36:39], v[128:143]
    s_nop 11
    v_max3_f32 v64, v64, v128, v129
    v_max3_f32 v64, v64, v130, v131
    v_max3_f32 v64, v64, v132, v133
    v_max3_f32 v64, v64, v134, v135
    v_max3_f32 v64, v64, v136, v137
    v_max3_f32 v64, v64, v138, v139
    v_max3_f32 v64, v64, v140, v141
    v_max3_f32 v64, v64, v142, v143
    v_mfma_f32_32x32x16_bf16 v[128:143], v[176:179], v[40:43], 0
    v_mfma_f32_32x32x16_bf16 v[128:143], v[180:183], v[44:47], v[128:143]
    s_nop 11
    v_max3_f32 v65, v65, v128, v129
    v_max3_f32 v65, v65, v130, v131
    v_max3_f32 v65, v65, v132, v133
    v_max3_f32 v65, v65, v134, v135
    v_max3_f32 v65, v65, v136, v137
    v_max3_f32 v65, v65, v138, v139
    v_max3_f32 v65, v65, v140, v141
    v_max3_f32 v65, v65, v142, v143
    v_mfma_f32_32x32x16_bf16 v[128:143], v[176:179], v[48:51], 0
    v_mfma_f32_32x32x16_bf16 v[128:143], v[180:183], v[52:55], v[128:143]
    s_nop 11
    v_max3_f32 v66, v66, v128, v129
    v_max3_f32 v66, v66, v130, v131
    v_max3_f32 v66, v66, v132, v133
    v_max3_f32 v66, v66, v134, v135
    v_max3_f32 v66, v66, v136, v137
    v_max3_f32 v66, v66, v138, v139
    v_max3_f32 v66, v66, v140, v141
    v_max3_f32 v66, v66, v142, v143
    v_mfma_f32_32x32x16_bf16 v[128:143], v[176:179], v[56:59], 0
    v_mfma_f32_32x32x16_bf16 v[128:143], v[180:183], v[60:63], v[128:143]
    s_nop 11
    v_max3_f32 v67, v67, v128, v129
    v_max3_f32 v67, v67, v130, v131
    v_max3_f32 v67, v67, v132, v133
    v_max3_f32 v67, v67, v134, v135
    v_max3_f32 v67, v67, v136, v137
    v_max3_f32 v67, v67, v138, v139
    v_max3_f32 v67, v67, v140, v141
    v_max3_f32 v67, v67, v142, v143
    s_add_u32 s19, s19, 0x4000
    s_cmp_lt_u32 s19, 0x40000
    s_cbranch_scc1 L_smx_84
    s_add_u32 s17, s14, 1
    s_and_b32 s17, s17, 3
    s_lshl_b32 s17, s17, 10
    s_add_u32 s17, s17, 140288
    v_lshl_add_u32 v2, v0, 2, s17
    ds_write_b32 v2, v64
    s_add_u32 s17, s14, 2
    s_and_b32 s17, s17, 3
    s_lshl_b32 s17, s17, 10
    s_add_u32 s17, s17, 140544
    v_lshl_add_u32 v2, v0, 2, s17
    ds_write_b32 v2, v65
    s_add_u32 s17, s14, 3
    s_and_b32 s17, s17, 3
    s_lshl_b32 s17, s17, 10
    s_add_u32 s17, s17, 140800
    v_lshl_add_u32 v2, v0, 2, s17
    ds_write_b32 v2, v66
    s_add_u32 s17, s14, 4
    s_and_b32 s17, s17, 3
    s_lshl_b32 s17, s17, 10
    s_add_u32 s17, s17, 141056
    v_lshl_add_u32 v2, v0, 2, s17
    ds_write_b32 v2, v67
    s_lshl_b32 s17, s14, 10
    s_add_u32 s17, s17, 140288
    v_lshl_add_u32 v2, v0, 2, s17
    s_waitcnt lgkmcnt(0)
    s_barrier
    ds_read_b32 v68, v2 offset:0
    ds_read_b32 v69, v2 offset:256
    ds_read_b32 v70, v2 offset:512
    ds_read_b32 v71, v2 offset:768
    buffer_load_dwordx4 v[224:227], v1, s[4:7], s39 offen offset:0 sc1
    buffer_load_dwordx4 v[228:231], v1, s[4:7], s39 offen offset:1024 sc1
    buffer_load_dwordx4 v[232:235], v1, s[4:7], s39 offen offset:2048 sc1
    buffer_load_dwordx4 v[236:239], v1, s[4:7], s39 offen offset:3072 sc1
    s_waitcnt vmcnt(0) lgkmcnt(0)
    v_max3_f32 v2, v68, v69, v70
    v_max_f32 v2, v2, v71
    v_mov_b32 v3, v2
    s_nop 1
    v_permlane32_swap_b32 v2, v3
    v_max_f32 v2, v2, v3
    v_add_f32 v240, v240, v2
    v_mov_b32 v64, 0
    v_mov_b32 v65, 0
    v_mov_b32 v66, 0
    v_mov_b32 v67, 0
    v_mov_b32 v68, 0
    v_mov_b32 v69, 0
    v_mov_b32 v70, 0
    v_mov_b32 v71, 0
    v_mov_b32 v72, 0
    v_mov_b32 v73, 0
    v_mov_b32 v74, 0
    v_mov_b32 v75, 0
    v_mov_b32 v76, 0
    v_mov_b32 v77, 0
    v_mov_b32 v78, 0
    v_mov_b32 v79, 0
    v_mov_b32 v80, 0
    v_mov_b32 v81, 0
    v_mov_b32 v82, 0
    v_mov_b32 v83, 0
    v_mov_b32 v84, 0
    v_mov_b32 v85, 0
    v_mov_b32 v86, 0
    v_mov_b32 v87, 0
    v_mov_b32 v88, 0
    v_mov_b32 v89, 0
    v_mov_b32 v90, 0
    v_mov_b32 v91, 0
    v_mov_b32 v92, 0
    v_mov_b32 v93, 0
    v_mov_b32 v94, 0
    v_mov_b32 v95, 0
    v_mov_b32 v96, 0
    v_mov_b32 v97, 0
    v_mov_b32 v98, 0
    v_mov_b32 v99, 0
    v_mov_b32 v100, 0
    v_mov_b32 v101, 0
    v_mov_b32 v102, 0
    v_mov_b32 v103, 0
    v_mov_b32 v104, 0
    v_mov_b32 v105, 0
    v_mov_b32 v106, 0
    v_mov_b32 v107, 0
    v_mov_b32 v108, 0
    v_mov_b32 v109, 0
    v_mov_b32 v110, 0
    v_mov_b32 v111, 0
    v_mov_b32 v112, 0
    v_mov_b32 v113, 0
    v_mov_b32 v114, 0
    v_mov_b32 v115, 0
    v_mov_b32 v116, 0
    v_mov_b32 v117, 0
    v_mov_b32 v118, 0
    v_mov_b32 v119, 0
    v_mov_b32 v120, 0
    v_mov_b32 v121, 0
    v_mov_b32 v122, 0
    v_mov_b32 v123, 0
    v_mov_b32 v124, 0
    v_mov_b32 v125, 0
    v_mov_b32 v126, 0
    v_mov_b32_e64 v127, 0
    s_branch L_attn_25
L_slowmax_74:
    s_waitcnt vmcnt(0) lgkmcnt(0)
    s_mov_b32 s70, 1
    s_mov_b32 s19, 0
    v_mov_b32 v64, 0xff800000
    v_mov_b32 v65, 0xff800000
    v_mov_b32 v66, 0xff800000
    v_mov_b32 v67, 0xff800000
L_smx_85:
    s_xor_b32 s69, s39, s19
    buffer_load_dwordx4 v[176:179], v1, s[4:7], s69 offen sc1
    buffer_load_dwordx4 v[180:183], v1, s[4:7], s69 offen offset:1024 sc1
    s_waitcnt vmcnt(0)
    v_mfma_f32_32x32x16_bf16 v[128:143], v[176:179], v[32:35], 0
    v_mfma_f32_32x32x16_bf16 v[128:143], v[180:183], v[36:39], v[128:143]
    s_nop 11
    v_max3_f32 v64, v64, v128, v129
    v_max3_f32 v64, v64, v130, v131
    v_max3_f32 v64, v64, v132, v133
    v_max3_f32 v64, v64, v134, v135
    v_max3_f32 v64, v64, v136, v137
    v_max3_f32 v64, v64, v138, v139
    v_max3_f32 v64, v64, v140, v141
    v_max3_f32 v64, v64, v142, v143
    v_mfma_f32_32x32x16_bf16 v[128:143], v[176:179], v[40:43], 0
    v_mfma_f32_32x32x16_bf16 v[128:143], v[180:183], v[44:47], v[128:143]
    s_nop 11
    v_max3_f32 v65, v65, v128, v129
    v_max3_f32 v65, v65, v130, v131
    v_max3_f32 v65, v65, v132, v133
    v_max3_f32 v65, v65, v134, v135
    v_max3_f32 v65, v65, v136, v137
    v_max3_f32 v65, v65, v138, v139
    v_max3_f32 v65, v65, v140, v141
    v_max3_f32 v65, v65, v142, v143
    v_mfma_f32_32x32x16_bf16 v[128:143], v[176:179], v[48:51], 0
    v_mfma_f32_32x32x16_bf16 v[128:143], v[180:183], v[52:55], v[128:143]
    s_nop 11
    v_max3_f32 v66, v66, v128, v129
    v_max3_f32 v66, v66, v130, v131
    v_max3_f32 v66, v66, v132, v133
    v_max3_f32 v66, v66, v134, v135
    v_max3_f32 v66, v66, v136, v137
    v_max3_f32 v66, v66, v138, v139
    v_max3_f32 v66, v66, v140, v141
    v_max3_f32 v66, v66, v142, v143
    v_mfma_f32_32x32x16_bf16 v[128:143], v[176:179], v[56:59], 0
    v_mfma_f32_32x32x16_bf16 v[128:143], v[180:183], v[60:63], v[128:143]
    s_nop 11
    v_max3_f32 v67, v67, v128, v129
    v_max3_f32 v67, v67, v130, v131
    v_max3_f32 v67, v67, v132, v133
    v_max3_f32 v67, v67, v134, v135
    v_max3_f32 v67, v67, v136, v137
    v_max3_f32 v67, v67, v138, v139
    v_max3_f32 v67, v67, v140, v141
    v_max3_f32 v67, v67, v142, v143
    s_add_u32 s19, s19, 0x4000
    s_cmp_lt_u32 s19, 0x40000
    s_cbranch_scc1 L_smx_85
    s_add_u32 s17, s14, 1
    s_and_b32 s17, s17, 3
    s_lshl_b32 s17, s17, 10
    s_add_u32 s17, s17, 140288
    v_lshl_add_u32 v2, v0, 2, s17
    ds_write_b32 v2, v64
    s_add_u32 s17, s14, 2
    s_and_b32 s17, s17, 3
    s_lshl_b32 s17, s17, 10
    s_add_u32 s17, s17, 140544
    v_lshl_add_u32 v2, v0, 2, s17
    ds_write_b32 v2, v65
    s_add_u32 s17, s14, 3
    s_and_b32 s17, s17, 3
    s_lshl_b32 s17, s17, 10
    s_add_u32 s17, s17, 140800
    v_lshl_add_u32 v2, v0, 2, s17
    ds_write_b32 v2, v66
    s_add_u32 s17, s14, 4
    s_and_b32 s17, s17, 3
    s_lshl_b32 s17, s17, 10
    s_add_u32 s17, s17, 141056
    v_lshl_add_u32 v2, v0, 2, s17
    ds_write_b32 v2, v67
    s_lshl_b32 s17, s14, 10
    s_add_u32 s17, s17, 140288
    v_lshl_add_u32 v2, v0, 2, s17
    s_waitcnt lgkmcnt(0)
    s_barrier
    ds_read_b32 v68, v2 offset:0
    ds_read_b32 v69, v2 offset:256
    ds_read_b32 v70, v2 offset:512
    ds_read_b32 v71, v2 offset:768
    buffer_load_dwordx4 v[224:227], v1, s[4:7], s39 offen offset:0 sc1
    buffer_load_dwordx4 v[228:231], v1, s[4:7], s39 offen offset:1024 sc1
    buffer_load_dwordx4 v[232:235], v1, s[4:7], s39 offen offset:2048 sc1
    buffer_load_dwordx4 v[236:239], v1, s[4:7], s39 offen offset:3072 sc1
    s_waitcnt vmcnt(0) lgkmcnt(0)
    v_max3_f32 v2, v68, v69, v70
    v_max_f32 v2, v2, v71
    v_mov_b32 v3, v2
    s_nop 1
    v_permlane32_swap_b32 v2, v3
    v_max_f32 v2, v2, v3
    v_add_f32 v240, v240, v2
    v_mov_b32 v64, 0
    v_mov_b32 v65, 0
    v_mov_b32 v66, 0
    v_mov_b32 v67, 0
    v_mov_b32 v68, 0
    v_mov_b32 v69, 0
    v_mov_b32 v70, 0
    v_mov_b32 v71, 0
    v_mov_b32 v72, 0
    v_mov_b32 v73, 0
    v_mov_b32 v74, 0
    v_mov_b32 v75, 0
    v_mov_b32 v76, 0
    v_mov_b32 v77, 0
    v_mov_b32 v78, 0
    v_mov_b32 v79, 0
    v_mov_b32 v80, 0
    v_mov_b32 v81, 0
    v_mov_b32 v82, 0
    v_mov_b32 v83, 0
    v_mov_b32 v84, 0
    v_mov_b32 v85, 0
    v_mov_b32 v86, 0
    v_mov_b32 v87, 0
    v_mov_b32 v88, 0
    v_mov_b32 v89, 0
    v_mov_b32 v90, 0
    v_mov_b32 v91, 0
    v_mov_b32 v92, 0
    v_mov_b32 v93, 0
    v_mov_b32 v94, 0
    v_mov_b32 v95, 0
    v_mov_b32 v96, 0
    v_mov_b32 v97, 0
    v_mov_b32 v98, 0
    v_mov_b32 v99, 0
    v_mov_b32 v100, 0
    v_mov_b32 v101, 0
    v_mov_b32 v102, 0
    v_mov_b32 v103, 0
    v_mov_b32 v104, 0
    v_mov_b32 v105, 0
    v_mov_b32 v106, 0
    v_mov_b32 v107, 0
    v_mov_b32 v108, 0
    v_mov_b32 v109, 0
    v_mov_b32 v110, 0
    v_mov_b32 v111, 0
    v_mov_b32 v112, 0
    v_mov_b32 v113, 0
    v_mov_b32 v114, 0
    v_mov_b32 v115, 0
    v_mov_b32 v116, 0
    v_mov_b32 v117, 0
    v_mov_b32 v118, 0
    v_mov_b32 v119, 0
    v_mov_b32 v120, 0
    v_mov_b32 v121, 0
    v_mov_b32 v122, 0
    v_mov_b32 v123, 0
    v_mov_b32 v124, 0
    v_mov_b32 v125, 0
    v_mov_b32 v126, 0
    v_mov_b32 v127, 0
    s_branch L_attn_68
interleave_layers__linear_kernel_hedgehog__mha_block__prompt_kernel_tid:
    v_mov_b32 v160, v168
    v_mov_b32 v161, v169
    v_mov_b32 v162, v170
    v_mov_b32 v163, v171
    v_mov_b32 v164, v172
    v_mov_b32 v165, v173
    v_mov_b32 v166, v174
    v_mov_b32 v167, v175
    s_nop 1
    s_branch interleave_layers__linear_kernel_hedgehog__mha_block__prompt_kernel_tb
L_g1wait_1:
L_poll_86:
    buffer_load_dword v5, v191, s[4:7], s27 offen sc1
    s_waitcnt vmcnt(0)
    v_cmp_ne_u32 vcc, s56, v5
    s_cbranch_vccnz L_retry_87
    s_branch L_g1ok_2
L_g2again_5:
    s_sleep 4
    s_sub_u32 s51, s51, 1
    s_cmp_eq_u32 s51, 0
    s_cbranch_scc1 interleave_layers__linear_kernel_hedgehog__mha_block__prompt_kernel_end
    s_mov_b32 s67, 3997696
    buffer_load_dwordx2 v[240:241], v242, s[4:7], s67 offen sc1
    s_waitcnt vmcnt(0)
    s_branch L_g2_4
L_kvpwait_8:
L_poll_88:
    buffer_load_dword v5, v182, s[4:7], s41 offen sc1
    s_waitcnt vmcnt(0)
    v_cmp_ne_u32 vcc, s56, v5
    s_cbranch_vccnz L_retry_89
    s_branch L_kvpok_7
L_slow_9:
    buffer_store_dwordx2 v[208:209], v192, s[4:7], s33 offen sc1
    buffer_store_dwordx2 v[210:211], v193, s[4:7], s33 offen sc1
    buffer_store_dwordx2 v[212:213], v192, s[4:7], s33 offen offset:1024 sc1
    buffer_store_dwordx2 v[214:215], v194, s[4:7], s33 offen offset:1024 sc1
    s_branch L_join_10
L_slow_11:
    buffer_store_dword v9, off, s[4:7], s44 sc1
    s_branch L_join_12
L_retry_14:
    s_sub_u32 s51, s51, 1
    s_cmp_lg_u32 s51, 0
    s_cbranch_scc1 L_poll_13
    s_endpgm
L_slow_17:
    buffer_store_dwordx4 v[208:211], v1, s[4:7], s35 offen sc1
    buffer_store_dwordx4 v[212:215], v1, s[4:7], s35 offen offset:1024 sc1
    s_branch L_join_18
L_slow_19:
    buffer_store_dwordx2 v[4:5], v13, s[4:7], s58 offen sc1
    s_branch L_join_20
L_slow_21:
    buffer_store_dword v9, off, s[4:7], s46 sc1
    s_branch L_join_22
L_woskip_15:
    s_waitcnt vmcnt(0)
    s_barrier
    s_add_u32 m0, s50, 57344
    s_add_u32 s67, s32, 50176
    buffer_load_dwordx4 v15, s[4:7], s67 offen sc1 lds
    s_add_u32 m0, s50, 61440
    s_add_u32 s67, s32, 53760
    buffer_load_dwordx4 v15, s[4:7], s67 offen sc1 lds
    s_add_u32 m0, s50, 65536
    s_add_u32 s67, s32, 57344
    buffer_load_dwordx4 v15, s[4:7], s67 offen sc1 lds
    s_add_u32 m0, s50, 69632
    s_add_u32 s67, s32, 60928
    buffer_load_dwordx4 v15, s[4:7], s67 offen sc1 lds
    s_add_u32 m0, s50, 73728
    s_add_u32 s67, s32, 64512
    buffer_load_dwordx4 v15, s[4:7], s67 offen sc1 lds
    s_add_u32 m0, s50, 77824
    s_add_u32 s67, s32, 68096
    buffer_load_dwordx4 v15, s[4:7], s67 offen sc1 lds
    s_add_u32 m0, s50, 81920
    s_add_u32 s67, s32, 71680
    buffer_load_dwordx4 v15, s[4:7], s67 offen sc1 lds
    s_waitcnt vmcnt(0)
    s_branch L_wojoin_16
L_retry_24:
    s_sub_u32 s51, s51, 1
    s_cmp_lg_u32 s51, 0
    s_cbranch_scc1 L_poll_23
    s_endpgm
L_kvwait_27:
L_poll_90:
    buffer_load_dword v5, v241, s[4:7], s43 offen sc1
    s_waitcnt vmcnt(0)
    v_cmp_ne_u32 vcc, s56, v5
    s_cbranch_vccnz L_retry_91
    s_branch L_kvok_26
L_kvwait_29:
L_poll_92:
    buffer_load_dword v5, v247, s[4:7], s43 offen sc1
    s_waitcnt vmcnt(0)
    v_cmp_ne_u32 vcc, s56, v5
    s_cbranch_vccnz L_retry_93
    s_branch L_kvok_28
L_slow_33:
    buffer_store_dwordx2 v[208:209], v128, s[4:7], s33 offen sc1
    buffer_store_dwordx2 v[210:211], v129, s[4:7], s33 offen sc1
    buffer_store_dwordx2 v[212:213], v128, s[4:7], s33 offen offset:1024 sc1
    buffer_store_dwordx2 v[214:215], v130, s[4:7], s33 offen offset:1024 sc1
    s_branch L_join_34
L_slow_35:
    buffer_store_dword v9, off, s[4:7], s44 sc1
    s_branch L_join_36
L_retry_38:
    s_sub_u32 s51, s51, 1
    s_cmp_lg_u32 s51, 0
    s_cbranch_scc1 L_poll_37
    s_endpgm
L_slow_41:
    buffer_store_dwordx4 v[208:211], v1, s[4:7], s35 offen sc1
    buffer_store_dwordx4 v[212:215], v1, s[4:7], s35 offen offset:1024 sc1
    s_branch L_join_42
L_slow_43:
    buffer_store_dwordx2 v[4:5], v13, s[4:7], s58 offen sc1
    s_branch L_join_44
L_slow_45:
    buffer_store_dword v9, off, s[4:7], s46 sc1
    s_branch L_join_46
L_woskip_39:
    s_waitcnt vmcnt(0)
    s_barrier
    s_waitcnt vmcnt(0)
    s_branch L_wojoin_40
L_retry_48:
    s_sub_u32 s51, s51, 1
    s_cmp_lg_u32 s51, 0
    s_cbranch_scc1 L_poll_47
    s_endpgm
L_kvpwait_51:
L_poll_94:
    buffer_load_dword v5, v182, s[4:7], s41 offen sc1
    s_waitcnt vmcnt(0)
    v_cmp_ne_u32 vcc, s56, v5
    s_cbranch_vccnz L_retry_95
    s_branch L_kvpok_50
L_slow_52:
    buffer_store_dwordx2 v[208:209], v192, s[4:7], s33 offen sc1
    buffer_store_dwordx2 v[210:211], v193, s[4:7], s33 offen sc1
    buffer_store_dwordx2 v[212:213], v192, s[4:7], s33 offen offset:1024 sc1
    buffer_store_dwordx2 v[214:215], v194, s[4:7], s33 offen offset:1024 sc1
    s_branch L_join_53
L_slow_54:
    buffer_store_dword v9, off, s[4:7], s44 sc1
    s_branch L_join_55
L_retry_57:
    s_sub_u32 s51, s51, 1
    s_cmp_lg_u32 s51, 0
    s_cbranch_scc1 L_poll_56
    s_endpgm
L_slow_60:
    buffer_store_dwordx4 v[208:211], v1, s[4:7], s35 offen sc1
    buffer_store_dwordx4 v[212:215], v1, s[4:7], s35 offen offset:1024 sc1
    s_branch L_join_61
L_slow_62:
    buffer_store_dwordx2 v[4:5], v13, s[4:7], s58 offen sc1
    s_branch L_join_63
L_slow_64:
    buffer_store_dword v9, off, s[4:7], s46 sc1
    s_branch L_join_65
L_woskip_58:
    s_waitcnt vmcnt(0)
    s_barrier
    s_add_u32 m0, s50, 73728
    s_add_u32 s67, s32, 64512
    buffer_load_dwordx4 v15, s[4:7], s67 offen sc1 lds
    s_add_u32 m0, s50, 77824
    s_add_u32 s67, s32, 68096
    buffer_load_dwordx4 v15, s[4:7], s67 offen sc1 lds
    s_add_u32 m0, s50, 81920
    s_add_u32 s67, s32, 71680
    buffer_load_dwordx4 v15, s[4:7], s67 offen sc1 lds
    s_waitcnt vmcnt(0)
    s_branch L_wojoin_59
L_retry_67:
    s_sub_u32 s51, s51, 1
    s_cmp_lg_u32 s51, 0
    s_cbranch_scc1 L_poll_66
    s_endpgm
L_kvwait_70:
L_poll_96:
    buffer_load_dword v5, v241, s[4:7], s43 offen sc1
    s_waitcnt vmcnt(0)
    v_cmp_ne_u32 vcc, s56, v5
    s_cbranch_vccnz L_retry_97
    s_branch L_kvok_69
L_kvwait_72:
L_poll_98:
    buffer_load_dword v5, v247, s[4:7], s43 offen sc1
    s_waitcnt vmcnt(0)
    v_cmp_ne_u32 vcc, s56, v5
    s_cbranch_vccnz L_retry_99
    s_branch L_kvok_71
L_slow_76:
    buffer_store_dwordx2 v[208:209], v128, s[4:7], s33 offen sc1
    buffer_store_dwordx2 v[210:211], v129, s[4:7], s33 offen sc1
    buffer_store_dwordx2 v[212:213], v128, s[4:7], s33 offen offset:1024 sc1
    buffer_store_dwordx2 v[214:215], v130, s[4:7], s33 offen offset:1024 sc1
    s_branch L_join_77
L_slow_78:
    buffer_store_dword v9, off, s[4:7], s44 sc1
    s_branch L_join_79
L_retry_81:
    s_sub_u32 s51, s51, 1
    s_cmp_lg_u32 s51, 0
    s_cbranch_scc1 L_poll_80
    s_endpgm
L_woskip_82:
    s_waitcnt vmcnt(0)
    s_barrier
    s_branch L_wojoin_83
L_retry_87:
    s_sleep 2
    s_sub_u32 s51, s51, 1
    s_cmp_lg_u32 s51, 0
    s_cbranch_scc1 L_poll_86
    s_endpgm
L_retry_89:
    s_sub_u32 s51, s51, 1
    s_cmp_lg_u32 s51, 0
    s_cbranch_scc1 L_poll_88
    s_endpgm
L_retry_91:
    s_sub_u32 s51, s51, 1
    s_cmp_lg_u32 s51, 0
    s_cbranch_scc1 L_poll_90
    s_endpgm
L_retry_93:
    s_sub_u32 s51, s51, 1
    s_cmp_lg_u32 s51, 0
    s_cbranch_scc1 L_poll_92
    s_endpgm
L_retry_95:
    s_sub_u32 s51, s51, 1
    s_cmp_lg_u32 s51, 0
    s_cbranch_scc1 L_poll_94
    s_endpgm
L_retry_97:
    s_sub_u32 s51, s51, 1
    s_cmp_lg_u32 s51, 0
    s_cbranch_scc1 L_poll_96
    s_endpgm
L_retry_99:
    s_sub_u32 s51, s51, 1
    s_cmp_lg_u32 s51, 0
    s_cbranch_scc1 L_poll_98
    s_endpgm
interleave_layers__linear_kernel_hedgehog__mha_block__prompt_kernel_last:
.section .rodata,"a"
.p2align 6
.amdhsa_kernel interleave_layers__linear_kernel_hedgehog__mha_block__prompt_kernel
  .amdhsa_next_free_vgpr 512
  .amdhsa_next_free_sgpr 102
  .amdhsa_accum_offset 256
  .amdhsa_group_segment_fixed_size 0
  .amdhsa_kernarg_size 80
  .amdhsa_user_sgpr_count 2
  .amdhsa_user_sgpr_kernarg_segment_ptr 1
  .amdhsa_system_sgpr_workgroup_id_x 1
.end_amdhsa_kernel
```
